```python
import torch

def _softmax(x, axis=-1):
    return torch.softmax(x, dim=axis)

def _gelu(x):
    return torch.nn.functional.gelu(x, approximate='tanh')

def _silu(x):
    return torch.nn.functional.silu(x)

def _sigmoid(x):
    return torch.sigmoid(x)

def _layernorm(x, axis=-1, eps=1e-05):
    m = x.mean(dim=axis, keepdim=True)
    v = x.var(dim=axis, keepdim=True, unbiased=False)
    return (x - m) / torch.sqrt(v + eps)

def _scatter_add(tgt, idx, src, axis=0):
    return tgt.clone().index_add_(axis, idx, src)

def _segment_sum(src, seg, n):
    out = torch.zeros((n,) + src.shape[1:], dtype=src.dtype)
    return out.index_add_(0, seg, src)

def _pad(x, pw):
    flat = tuple((v for pair in reversed(pw) for v in pair))
    return torch.nn.functional.pad(x, flat)
kernel_name = 'adaLN_cond__ssm_conv_s4d__mixer_s_mlp__prompt'

def setup_inputs():

    _w = lambda a: (lambda t: t.to(torch.bfloat16) if t.is_floating_point() else t)(torch.as_tensor(a))

    def _A_setup():
        Bsz, L, D, N = (1, 2048, 640, 192)
        return {'u': _w((lambda *s: torch.randn(*s, dtype=torch.bfloat16) * 0.05)(Bsz, L, D)), 'log_A_real': _w((lambda *s: torch.randn(*s, dtype=torch.bfloat16) * 3.2)(D, N) * 0.5), 'A_imag': _w((lambda *s: torch.randn(*s, dtype=torch.bfloat16) * 0.1)(D, N) * 3.14), 'C_real': _w((lambda *s: torch.randn(*s, dtype=torch.bfloat16) * 0.8)(D, N) / N ** 0.5), 'C_imag': _w((lambda *s: torch.randn(*s, dtype=torch.bfloat16) * 0.8)(D, N) / N ** 0.5), 'log_dt': _w((lambda *s: torch.randn(*s, dtype=torch.bfloat16) * 0.1)(D) * 0.5 - 4.0), 'D_skip': _w((lambda *s: torch.randn(*s, dtype=torch.bfloat16) * 0.2)(D))}
    _A_in = _A_setup()

    def _B_setup():
        B, S, D, F = (1, 2048, 640, 1536)
        return {'x': _w((lambda *s: torch.randn(*s, dtype=torch.bfloat16) * 0.05)(B, S, D)), 'w1': _w((lambda *s: torch.randn(*s, dtype=torch.bfloat16) * 3.2)(D, D) * D ** (-0.5)), 'w2': _w((lambda *s: torch.randn(*s, dtype=torch.bfloat16) * 3.2)(D, D) * D ** (-0.5)), 'w3': _w((lambda *s: torch.randn(*s, dtype=torch.bfloat16) * 3.2)(D, F) * D ** (-0.5)), 'w4': _w((lambda *s: torch.randn(*s, dtype=torch.bfloat16) * 3.2)(F, D) * F ** (-0.5))}
    _B_in = _B_setup()
    return {'A_u': _A_in['u'], 'A_log_A_real': _A_in['log_A_real'], 'A_A_imag': _A_in['A_imag'], 'A_C_real': _A_in['C_real'], 'A_C_imag': _A_in['C_imag'], 'A_log_dt': _A_in['log_dt'], 'A_D_skip': _A_in['D_skip'], 'B_x': _B_in['x'], 'B_w1': _B_in['w1'], 'B_w2': _B_in['w2'], 'B_w3': _B_in['w3'], 'B_w4': _B_in['w4'], 'c': _w((lambda *s: torch.randn(*s, dtype=torch.bfloat16) * 0.1)(1, 640) * 8.0), 'w_mod': _w((lambda *s: torch.randn(*s, dtype=torch.bfloat16) * 0.1)(640, 6 * 640) * 640 ** (-0.5) * 8.0)}

def reference(A_u, A_log_A_real, A_A_imag, A_C_real, A_C_imag, A_log_dt, A_D_skip, B_x, B_w1, B_w2, B_w3, B_w4, c, w_mod):

    def _A_ref(u, log_A_real, A_imag, C_real, C_imag, log_dt, D_skip):
        L = u.shape[1]
        dt = torch.exp(log_dt)
        A = -torch.exp(log_A_real) + 1j * A_imag
        C = (C_real + 1j * C_imag) * dt[:, None]
        pos = (lambda x, dt: x.to(dt))(torch.arange(L), log_dt.dtype)
        P = torch.exp((A * dt[:, None])[:, :, None] * pos[None, None, :])
        K = 2.0 * torch.einsum('dn,dnl->dl', C, P).real
        L2 = 2 * L
        u_t = (lambda x, *d: x.permute(*d))(u, 0, 2, 1)
        Kf = (lambda x, *a, **k: torch.fft.rfft(x.float(), *a, **k))(K, L2)
        Uf = (lambda x, *a, **k: torch.fft.rfft(x.float(), *a, **k))(u_t, L2)
        y = (lambda x, *a, **k: torch.fft.irfft(x, *a, **k).to(torch.bfloat16))(Uf * Kf[None, :, :], L2)[:, :, :L]
        y = (lambda x, *d: x.permute(*d))(y, 0, 2, 1)
        return y + u * D_skip[None, None, :]

    def _B_ref(x, w1, w2, w3, w4):
        B, S, D = x.shape
        h = _gelu(_layernorm(x, axis=-1) @ w1)
        c = D // 4
        g0 = _pad(h[:, :, 0 * c:1 * c], ((0, 0), (1, 0), (0, 0)))[:, :S, :]
        g1 = _pad(h[:, :, 1 * c:2 * c], ((0, 0), (0, 1), (0, 0)))[:, 1:, :]
        g2 = _pad(h[:, :, 2 * c:3 * c], ((0, 0), (2, 0), (0, 0)))[:, :S, :]
        g3 = _pad(h[:, :, 3 * c:], ((0, 0), (0, 2), (0, 0)))[:, 2:, :]
        hs = torch.concatenate([g0, g1, g2, g3], axis=-1) @ w2
        x1 = x + hs
        h2 = _gelu(_layernorm(x1, axis=-1) @ w3) @ w4
        return x1 + h2
    x = A_u
    mod = (_silu(c) @ w_mod).reshape(c.shape[0], 6, 1, -1)
    sa, ca, ga, sb, cb, gb = (mod[:, 0].clone(), mod[:, 1].clone(), mod[:, 2].clone(), mod[:, 3].clone(), mod[:, 4].clone(), mod[:, 5].clone())
    h = _layernorm(x, axis=-1) * (1 + ca) + sa
    x = x + ga * _A_ref(h, A_log_A_real, A_A_imag, A_C_real, A_C_imag, A_log_dt, A_D_skip)
    h = _layernorm(x, axis=-1) * (1 + cb) + sb
    x = x + gb * _B_ref(h, B_w1, B_w2, B_w3, B_w4)
    return x
```

```asm
; @launch grid=(256,1,1) block=(256,1,1) lds=163840
.amdgcn_target "amdgcn-amd-amdhsa--gfx950"
.text
.globl adaLN_cond__ssm_conv_s4d__mixer_s_mlp__prompt_kernel
.p2align 8
.type adaLN_cond__ssm_conv_s4d__mixer_s_mlp__prompt_kernel,@function
adaLN_cond__ssm_conv_s4d__mixer_s_mlp__prompt_kernel:
    s_cmp_ge_u32 s2, 256
    s_cbranch_scc1 L_END
    s_load_dwordx16 s[4:19], s[0:1], 0
    s_load_dwordx16 s[20:35], s[0:1], 64
    s_load_dwordx2 s[36:37], s[0:1], 128
    s_memrealtime s[46:47]
    s_getpc_b64 s[48:49]
L_CPF0:
    s_mov_b32 s50, CODE_END-L_CPF0
    s_mov_b32 s51, 0x20000
    s_lshr_b32 s38, s2, 3
    s_lshl_b32 s39, s38, 11
    v_lshrrev_b32 v7, 4, v0
    v_lshlrev_b32 v22, 7, v7
    buffer_load_dword v255, v22, s[48:51], s39 offen
    s_and_b32 s3, s2, 7
    s_lshl_b32 s57, s3, 4
    s_lshr_b32 s39, s38, 1
    s_add_u32 s57, s57, s39
    s_and_b32 s58, s38, 1
    s_mul_i32 s55, s57, 5
    s_mul_i32 s39, s58, 3
    s_add_u32 s55, s55, s39
    v_lshlrev_b32 v5, 3, v0
    v_and_b32 v2, 15, v0
    v_mul_u32_u24 v7, 1280, v7
    v_lshl_add_u32 v7, v2, 4, v7
    s_mul_i32 s39, s55, 384
    s_mul_i32 s60, s57, 20480
    v_mul_u32_u24 v6, 1366, v0
    v_lshrrev_b32 v6, 16, v6
    v_lshlrev_b32 v6, 1, v6
    v_mov_b32 v64, 0
    s_lshl_b32 s59, s55, 1
    s_waitcnt lgkmcnt(0)
    s_mov_b64 s[48:49], s[6:7]
    s_mov_b32 s50, 245760
    buffer_load_dwordx2 v[56:57], v5, s[48:51], s39 offen nt
    s_mov_b64 s[48:49], s[8:9]
    buffer_load_dwordx2 v[58:59], v5, s[48:51], s39 offen nt
    s_mov_b64 s[48:49], s[10:11]
    buffer_load_dwordx2 v[60:61], v5, s[48:51], s39 offen nt
    s_mov_b64 s[48:49], s[12:13]
    buffer_load_dwordx2 v[62:63], v5, s[48:51], s39 offen nt
    s_mov_b64 s[48:49], s[14:15]
    s_mov_b32 s50, 1280
    buffer_load_short_d16_hi v64, v6, s[48:51], s59 offen
    s_mov_b64 s[48:49], s[4:5]
    s_mul_i32 s50, s58, 2621440
    buffer_load_dwordx4 v[36:39], v7, s[48:51], s60 offen offset:0 nt
    buffer_load_dwordx4 v[40:43], v7, s[48:51], s60 offen offset:256 nt
    buffer_load_dwordx4 v[44:47], v7, s[48:51], s60 offen offset:512 nt
    buffer_load_dwordx4 v[48:51], v7, s[48:51], s60 offen offset:768 nt
    buffer_load_dwordx4 v[52:55], v7, s[48:51], s60 offen offset:1024 nt
    v_and_b32 v1, 63, v0
    v_lshrrev_b32 v3, 6, v0
    v_mov_b32 v21, 0
    v_mov_b32 v33, 0
    v_readfirstlane_b32 s52, v3
    v_lshrrev_b32 v3, 4, v1
    v_lshlrev_b32 v4, 4, v1
    s_add_u32 s61, s2, s52
    s_cmp_lg_u32 s61, 0
    s_cbranch_scc1 L_NZ
    s_or_b32 s46, s46, 1
    v_mov_b32 v22, s46
    global_store_dword v21, v22, s[34:35] sc1
L_NZ:
    s_mov_b64 s[48:49], s[16:17]
    s_mov_b32 s50, 1280
    v_and_b32 v31, 3, v1
    v_lshlrev_b32 v6, 1, v31
    buffer_load_short_d16_hi v33, v6, s[48:51], s59 offen
    s_lshl_b32 s13, s58, 7
    s_add_u32 s13, s13, s57
    s_and_b32 s60, s13, 3
    s_mul_i32 s61, s60, 320
    s_mov_b64 s[48:49], s[28:29]
    s_mov_b32 s50, 1280
    v_lshlrev_b32 v6, 3, v1
    buffer_load_dwordx2 v[192:193], v6, s[48:51], s61 offen
    v_lshlrev_b32 v6, 1, v3
    v_and_b32 v7, 7, v1
    v_xor_b32 v6, v6, v7
    v_lshrrev_b32 v7, 3, v1
    v_mul_u32_u24 v7, 7680, v7
    v_lshl_add_u32 v71, v6, 4, v7
    s_mul_i32 s18, s60, 1228800
    s_lshr_b32 s61, s13, 2
    s_lshl_b32 s61, s61, 7
    s_add_u32 s18, s18, s61
    s_mov_b64 s[44:45], s[30:31]
    s_mov_b32 s47, 0x20000
    s_cmp_lt_u32 s13, 240
    s_cselect_b32 s46, 4915200, 0
    s_sub_u32 s60, s52, s58
    s_cmp_lg_u32 s60, 3
    s_cbranch_scc1 L_NG0
    s_mov_b32 s19, 91648
L_GDa:
    s_mov_b32 m0, s19
    s_add_u32 s19, s19, 4096
    buffer_load_dwordx4 v71, s[44:47], s18 offen offset:0 nt lds
    s_add_u32 s18, s18, 60416
    buffer_load_dwordx4 v71, s[44:47], s18 offen offset:1024 nt lds
    s_add_u32 s18, s18, 60416
    buffer_load_dwordx4 v71, s[44:47], s18 offen offset:2048 nt lds
    s_add_u32 s18, s18, 60416
    buffer_load_dwordx4 v71, s[44:47], s18 offen offset:3072 nt lds
    s_add_u32 s18, s18, 64512
    s_cmp_lt_u32 s19, 112128
    s_cbranch_scc1 L_GDa
L_NG0:
    s_mov_b32 s40, s36
    s_mov_b32 s41, s37
    s_mov_b32 s42, 15728640
    s_mov_b32 s43, 0x20000
    v_mov_b32 v23, 0
    v_mov_b32 v24, 0
    v_mov_b32 v29, 0
    v_mov_b32 v32, 0
    v_mov_b32 v65, 0
    v_mov_b32 v116, 0
    v_mov_b32 v117, 0
    v_mov_b32 v118, 0
    v_mov_b32 v119, 0
    s_lshl_b32 s39, s2, 9
    s_add_u32 s39, s39, 14680064
    s_lshl_b32 s60, s52, 7
    s_add_u32 s39, s39, s60
    s_and_b32 s60, s39, 0xff80
    v_mov_b32 v5, s39
    s_and_b32 s61, s39, 0x3f80
    s_add_u32 s61, s61, 65536
    v_writelane_b32 v5, s60, 1
    v_writelane_b32 v5, s61, 2
    buffer_load_dword v254, v5, s[40:43], 0 offen
    s_lshr_b32 s39, s38, 3
    s_lshl_b32 s53, s3, 2
    s_add_u32 s53, s53, s39
    s_and_b32 s54, s38, 7
    s_sub_u32 s56, 3, s58
    s_lshl_b32 s39, s53, 2
    s_add_u32 s39, s39, s52
    s_lshl_b32 s39, s39, 12
    s_lshl_b32 s59, s54, 9
    s_add_u32 s12, s39, s59
    s_add_u32 s12, s12, 524288
    s_mov_b64 s[28:29], s[24:25]
    s_mov_b64 s[30:31], s[26:27]
    s_mov_b64 s[16:17], s[34:35]
    s_mov_b64 s[36:37], s[22:23]
    v_lshlrev_b32 v27, 4, v0
    v_lshrrev_b32 v5, 2, v1
    v_lshlrev_b32 v68, 7, v5
    v_lshl_add_u32 v68, v31, 3, v68
    v_bfe_u32 v6, v1, 3, 2
    v_lshl_add_u32 v68, v6, 5, v68
    v_add_u32 v68, 91648, v68
    v_lshlrev_b32 v69, 3, v3
    v_add_u32 v69, 146688, v69
    v_lshlrev_b32 v28, 8, v5
    v_and_b32 v6, 7, v5
    v_lshl_add_u32 v28, v6, 5, v28
    v_lshl_add_u32 v28, v31, 3, v28
    v_lshlrev_b32 v34, 2, v1
    v_add_u32 v35, 137472, v34
    s_mul_i32 s4, s13, 3
    s_add_u32 s4, s4, s52
    s_lshl_b32 s26, s52, 13
    s_cmp_ge_u32 s4, 100
    s_cbranch_scc1 L_Pa1
    s_mov_b64 s[48:49], s[20:21]
    s_mov_b32 s50, 819200
    s_sub_u32 s6, s4, 0
    s_mul_i32 s5, s6, 13108
    s_lshr_b32 s5, s5, 16
    s_mul_i32 s39, s5, 5
    s_sub_u32 s6, s6, s39
    s_mov_b32 s7, 1280
    s_mul_i32 s59, s5, 13108
    s_lshr_b32 s59, s59, 16
    s_mul_i32 s60, s59, 5
    s_sub_u32 s60, s5, s60
    s_lshl_b32 s60, s60, 2
    s_mul_i32 s59, s59, 10
    s_lshr_b32 s39, 0x47520, s60
    s_lshr_b32 s61, 0x98631, s60
    s_branch L_PCa
L_Pa1:
    s_cmp_ge_u32 s4, 200
    s_cbranch_scc1 L_Pa2
    s_mov_b64 s[48:49], s[36:37]
    s_mov_b32 s50, 819200
    s_sub_u32 s6, s4, 100
    s_mul_i32 s5, s6, 13108
    s_lshr_b32 s5, s5, 16
    s_mul_i32 s39, s5, 5
    s_sub_u32 s6, s6, s39
    s_mov_b32 s7, 1280
    s_mul_i32 s59, s5, 13108
    s_lshr_b32 s59, s59, 16
    s_mul_i32 s60, s59, 5
    s_sub_u32 s60, s5, s60
    s_lshl_b32 s60, s60, 2
    s_mul_i32 s59, s59, 10
    s_lshr_b32 s39, 0x47520, s60
    s_lshr_b32 s61, 0x98631, s60
    s_branch L_PCa
L_Pa2:
    s_cmp_ge_u32 s4, 440
    s_cbranch_scc1 L_Pa3
    s_mov_b64 s[48:49], s[28:29]
    s_mov_b32 s50, 1966080
    s_sub_u32 s6, s4, 200
    s_mul_i32 s5, s6, 5462
    s_lshr_b32 s5, s5, 16
    s_mul_i32 s39, s5, 12
    s_sub_u32 s6, s6, s39
    s_mov_b32 s7, 3072
    s_mul_i32 s59, s5, 13108
    s_lshr_b32 s59, s59, 16
    s_mul_i32 s60, s59, 5
    s_sub_u32 s60, s5, s60
    s_lshl_b32 s60, s60, 2
    s_mul_i32 s59, s59, 10
    s_lshr_b32 s39, 0x47520, s60
    s_lshr_b32 s61, 0x98631, s60
    s_branch L_PCa
L_Pa3:
    s_mov_b64 s[48:49], s[30:31]
    s_mov_b32 s50, 1966080
    s_sub_u32 s6, s4, 440
    s_mul_i32 s5, s6, 13108
    s_lshr_b32 s5, s5, 16
    s_mul_i32 s39, s5, 5
    s_sub_u32 s6, s6, s39
    s_mov_b32 s7, 1280
    s_mul_i32 s59, s5, 10923
    s_lshr_b32 s59, s59, 16
    s_mul_i32 s60, s59, 6
    s_sub_u32 s60, s5, s60
    s_lshl_b32 s60, s60, 2
    s_mul_i32 s59, s59, 12
    s_lshr_b32 s39, 0x829630, s60
    s_lshr_b32 s61, 0xb5a741, s60
L_PCa:
    s_mov_b32 s51, 0x20000
    s_and_b32 s39, s39, 15
    s_and_b32 s61, s61, 15
    s_add_u32 s15, s59, s61
    s_add_u32 s14, s59, s39
    s_lshl_b32 s39, s7, 4
    s_mul_i32 s14, s14, s39
    s_mul_i32 s15, s15, s39
    s_lshl_b32 s39, s6, 8
    s_add_u32 s14, s14, s39
    s_add_u32 s15, s15, s39
    v_mul_lo_u32 v5, v3, s7
    v_lshlrev_b32 v6, 1, v3
    v_xor_b32 v6, v6, v2
    v_lshl_add_u32 v66, v6, 4, v5
    v_xor_b32 v6, 8, v6
    v_lshl_add_u32 v67, v6, 4, v5
    s_lshl_b32 s7, s7, 2
    s_cmp_lt_u32 s4, 680
    s_cselect_b32 s50, s50, 0
    s_sub_u32 s60, s52, s58
    s_cmp_eq_u32 s60, 3
    s_cbranch_scc1 L_NPT
    s_mov_b32 s59, 0x3fb8aa3b
    s_mov_b32 s39, 0x32a57060
    s_waitcnt vmcnt(8)
    v_mul_f32 v5, s59, v64
    v_fma_f32 v6, v64, s59, -v5
    v_fma_f32 v6, v64, s39, v6
    v_exp_f32 v5, v5
    v_mul_f32 v6, 0x3f317218, v6
    v_fma_f32 v5, v5, v6, v5
    v_cvt_pk_bf16_f32 v64, v5, v5
    v_and_b32 v64, 0xffff0000, v64
    v_mul_f32 v5, 0xbfb8aa3b, v64
    v_mul_f32 v6, 0.15915494, v64
    v_add_f32 v7, v64, v64
    v_lshlrev_b32 v72, 16, v56
    v_and_b32 v73, 0xffff0000, v56
    v_lshlrev_b32 v74, 16, v57
    v_and_b32 v75, 0xffff0000, v57
    v_lshlrev_b32 v76, 16, v58
    v_and_b32 v77, 0xffff0000, v58
    v_lshlrev_b32 v78, 16, v59
    v_and_b32 v79, 0xffff0000, v59
    v_lshlrev_b32 v80, 16, v60
    v_and_b32 v81, 0xffff0000, v60
    v_lshlrev_b32 v82, 16, v61
    v_and_b32 v83, 0xffff0000, v61
    v_lshlrev_b32 v84, 16, v62
    v_and_b32 v85, 0xffff0000, v62
    v_lshlrev_b32 v86, 16, v63
    v_and_b32 v87, 0xffff0000, v63
    v_mul_f32 v72, s59, v72
    v_mul_f32 v73, s59, v73
    v_mul_f32 v74, s59, v74
    v_mul_f32 v75, s59, v75
    v_exp_f32 v72, v72
    v_exp_f32 v73, v73
    v_exp_f32 v74, v74
    v_exp_f32 v75, v75
    v_cvt_pk_bf16_f32 v72, v72, v72
    v_and_b32 v72, 0xffff0000, v72
    v_cvt_pk_bf16_f32 v73, v73, v73
    v_and_b32 v73, 0xffff0000, v73
    v_cvt_pk_bf16_f32 v74, v74, v74
    v_and_b32 v74, 0xffff0000, v74
    v_cvt_pk_bf16_f32 v75, v75, v75
    v_and_b32 v75, 0xffff0000, v75
    v_mul_f32 v72, v72, v5
    v_mul_f32 v76, v76, v6
    v_mul_f32 v80, v80, v7
    v_mul_f32 v84, v84, -v7
    v_mul_f32 v73, v73, v5
    v_mul_f32 v77, v77, v6
    v_mul_f32 v81, v81, v7
    v_mul_f32 v85, v85, -v7
    v_mul_f32 v74, v74, v5
    v_mul_f32 v78, v78, v6
    v_mul_f32 v82, v82, v7
    v_mul_f32 v86, v86, -v7
    v_mul_f32 v75, v75, v5
    v_mul_f32 v79, v79, v6
    v_mul_f32 v83, v83, v7
    v_mul_f32 v87, v87, -v7
    v_add_u32 v5, 137472, v27
    v_cmp_gt_u32 vcc, 144, v0
    s_nop 0
    s_and_saveexec_b64 s[60:61], vcc
    ds_write_b128 v5, v[72:75] offset:0
    ds_write_b128 v5, v[76:79] offset:2304
    ds_write_b128 v5, v[80:83] offset:4608
    ds_write_b128 v5, v[84:87] offset:6912
    s_mov_b64 exec, s[60:61]
L_NPT:
    global_load_dword v29, v21, s[16:17]
    s_cmp_eq_u32 s58, 1
    s_cbranch_scc1 L_LN
    s_waitcnt lgkmcnt(0)
    s_barrier
    s_mov_b32 s27, 0
    s_cmp_eq_u32 s52, 3
    s_cbranch_scc1 L_H03
    s_sub_u32 s7, s7, 1024
    s_add_u32 m0, s26, 112896
    s_nop 0
    buffer_load_dwordx4 v66, s[48:51], s14 offen offset:0 nt lds
    s_add_u32 s14, s14, s7
    buffer_load_dwordx4 v67, s[48:51], s14 offen offset:1024 nt lds
    s_add_u32 s14, s14, s7
    buffer_load_dwordx4 v66, s[48:51], s14 offen offset:2048 nt lds
    s_add_u32 s14, s14, s7
    buffer_load_dwordx4 v67, s[48:51], s14 offen offset:3072 nt lds
    s_add_u32 m0, s26, 116992
    s_nop 0
    buffer_load_dwordx4 v66, s[48:51], s15 offen offset:0 nt lds
    s_add_u32 s15, s15, s7
    buffer_load_dwordx4 v67, s[48:51], s15 offen offset:1024 nt lds
    s_add_u32 s15, s15, s7
    buffer_load_dwordx4 v66, s[48:51], s15 offen offset:2048 nt lds
    s_add_u32 s15, s15, s7
    buffer_load_dwordx4 v67, s[48:51], s15 offen offset:3072 nt lds
    s_branch L_NSJ
L_H03:
    s_waitcnt vmcnt(0)
    v_lshlrev_b32 v72, 16, v192
    v_and_b32 v73, 0xffff0000, v192
    v_lshlrev_b32 v74, 16, v193
    v_and_b32 v75, 0xffff0000, v193
    v_mul_f32 v76, 0xbfb8aa3b, v72
    v_mul_f32 v77, 0xbfb8aa3b, v73
    v_mul_f32 v78, 0xbfb8aa3b, v74
    v_mul_f32 v79, 0xbfb8aa3b, v75
    v_exp_f32 v76, v76
    v_exp_f32 v77, v77
    v_exp_f32 v78, v78
    v_exp_f32 v79, v79
    v_add_f32 v76, 1.0, v76
    v_add_f32 v77, 1.0, v77
    v_add_f32 v78, 1.0, v78
    v_add_f32 v79, 1.0, v79
    v_rcp_f32 v76, v76
    v_rcp_f32 v77, v77
    v_rcp_f32 v78, v78
    v_rcp_f32 v79, v79
    v_mul_f32 v76, v72, v76
    v_mul_f32 v77, v73, v77
    v_mul_f32 v78, v74, v78
    v_mul_f32 v79, v75, v79
    v_cvt_pk_bf16_f32 v72, v76, v77
    v_cvt_pk_bf16_f32 v73, v78, v79
    v_lshlrev_b32 v6, 3, v1
    v_add_u32 v6, 146688, v6
    ds_write_b64 v6, v[72:73]
    ds_read_b64 v[92:93], v69 offset:0
    ds_read_b64 v[94:95], v69 offset:32
    ds_read_b64 v[96:97], v69 offset:64
    ds_read_b64 v[98:99], v69 offset:96
    ds_read_b64 v[100:101], v69 offset:128
    ds_read_b64 v[102:103], v69 offset:160
    ds_read_b64 v[104:105], v69 offset:192
    ds_read_b64 v[106:107], v69 offset:224
    ds_read_b64 v[108:109], v69 offset:256
    ds_read_b64 v[110:111], v69 offset:288
    s_and_b32 s39, s13, 3
    s_mul_i32 s39, s39, 15360
    s_lshr_b32 s59, s13, 2
    s_lshl_b32 s59, s59, 8
    s_add_u32 s39, s39, s59
    s_add_u32 s39, s39, 0
    s_cmp_lt_u32 s13, 240
    s_cselect_b32 s39, s39, 0x40000000
    v_lshlrev_b32 v7, 6, v2
    v_lshl_add_u32 v7, v3, 4, v7
    v_add_u32 v7, s39, v7
    s_waitcnt lgkmcnt(4)
    v_xor_b32 v5, 0, v68
    ds_read_b64_tr_b16 v[72:73], v5 offset:0
    ds_read_b64_tr_b16 v[74:75], v5 offset:2048
    ds_read_b64_tr_b16 v[76:77], v5 offset:4096
    ds_read_b64_tr_b16 v[78:79], v5 offset:6144
    ds_read_b64_tr_b16 v[80:81], v5 offset:8192
    ds_read_b64_tr_b16 v[82:83], v5 offset:10240
    ds_read_b64_tr_b16 v[84:85], v5 offset:12288
    ds_read_b64_tr_b16 v[86:87], v5 offset:14336
    ds_read_b64_tr_b16 v[88:89], v5 offset:16384
    ds_read_b64_tr_b16 v[90:91], v5 offset:18432
    s_waitcnt lgkmcnt(0)
    v_xor_b32 v5, 32, v68
    ds_read_b64_tr_b16 v[160:161], v5 offset:0
    ds_read_b64_tr_b16 v[162:163], v5 offset:2048
    ds_read_b64_tr_b16 v[164:165], v5 offset:4096
    ds_read_b64_tr_b16 v[166:167], v5 offset:6144
    ds_read_b64_tr_b16 v[168:169], v5 offset:8192
    ds_read_b64_tr_b16 v[170:171], v5 offset:10240
    ds_read_b64_tr_b16 v[172:173], v5 offset:12288
    ds_read_b64_tr_b16 v[174:175], v5 offset:14336
    ds_read_b64_tr_b16 v[176:177], v5 offset:16384
    ds_read_b64_tr_b16 v[178:179], v5 offset:18432
    v_mfma_f32_16x16x32_bf16 v[196:199], v[72:75], v[92:95], 0
    v_mfma_f32_16x16x32_bf16 v[196:199], v[76:79], v[96:99], v[196:199]
    v_mfma_f32_16x16x32_bf16 v[196:199], v[80:83], v[100:103], v[196:199]
    v_mfma_f32_16x16x32_bf16 v[196:199], v[84:87], v[104:107], v[196:199]
    v_mfma_f32_16x16x32_bf16 v[196:199], v[88:91], v[108:111], v[196:199]
    s_waitcnt lgkmcnt(0)
    v_xor_b32 v5, 64, v68
    ds_read_b64_tr_b16 v[72:73], v5 offset:0
    ds_read_b64_tr_b16 v[74:75], v5 offset:2048
    ds_read_b64_tr_b16 v[76:77], v5 offset:4096
    ds_read_b64_tr_b16 v[78:79], v5 offset:6144
    ds_read_b64_tr_b16 v[80:81], v5 offset:8192
    ds_read_b64_tr_b16 v[82:83], v5 offset:10240
    ds_read_b64_tr_b16 v[84:85], v5 offset:12288
    ds_read_b64_tr_b16 v[86:87], v5 offset:14336
    ds_read_b64_tr_b16 v[88:89], v5 offset:16384
    ds_read_b64_tr_b16 v[90:91], v5 offset:18432
    v_mfma_f32_16x16x32_bf16 v[200:203], v[160:163], v[92:95], 0
    v_mfma_f32_16x16x32_bf16 v[200:203], v[164:167], v[96:99], v[200:203]
    v_mfma_f32_16x16x32_bf16 v[200:203], v[168:171], v[100:103], v[200:203]
    v_mfma_f32_16x16x32_bf16 v[200:203], v[172:175], v[104:107], v[200:203]
    v_mfma_f32_16x16x32_bf16 v[200:203], v[176:179], v[108:111], v[200:203]
    s_waitcnt lgkmcnt(0)
    v_xor_b32 v5, 96, v68
    ds_read_b64_tr_b16 v[160:161], v5 offset:0
    ds_read_b64_tr_b16 v[162:163], v5 offset:2048
    ds_read_b64_tr_b16 v[164:165], v5 offset:4096
    ds_read_b64_tr_b16 v[166:167], v5 offset:6144
    ds_read_b64_tr_b16 v[168:169], v5 offset:8192
    ds_read_b64_tr_b16 v[170:171], v5 offset:10240
    ds_read_b64_tr_b16 v[172:173], v5 offset:12288
    ds_read_b64_tr_b16 v[174:175], v5 offset:14336
    ds_read_b64_tr_b16 v[176:177], v5 offset:16384
    ds_read_b64_tr_b16 v[178:179], v5 offset:18432
    v_mfma_f32_16x16x32_bf16 v[204:207], v[72:75], v[92:95], 0
    v_mfma_f32_16x16x32_bf16 v[204:207], v[76:79], v[96:99], v[204:207]
    v_mfma_f32_16x16x32_bf16 v[204:207], v[80:83], v[100:103], v[204:207]
    v_mfma_f32_16x16x32_bf16 v[204:207], v[84:87], v[104:107], v[204:207]
    v_mfma_f32_16x16x32_bf16 v[204:207], v[88:91], v[108:111], v[204:207]
    s_waitcnt lgkmcnt(0)
    v_mfma_f32_16x16x32_bf16 v[208:211], v[160:163], v[92:95], 0
    v_mfma_f32_16x16x32_bf16 v[208:211], v[164:167], v[96:99], v[208:211]
    v_mfma_f32_16x16x32_bf16 v[208:211], v[168:171], v[100:103], v[208:211]
    v_mfma_f32_16x16x32_bf16 v[208:211], v[172:175], v[104:107], v[208:211]
    v_mfma_f32_16x16x32_bf16 v[208:211], v[176:179], v[108:111], v[208:211]
    v_cmp_eq_u32 vcc, 1, v2
    s_nop 1
    v_cndmask_b32 v196, v196, v200, vcc
    v_cndmask_b32 v197, v197, v201, vcc
    v_cndmask_b32 v198, v198, v202, vcc
    v_cndmask_b32 v199, v199, v203, vcc
    v_cmp_eq_u32 vcc, 2, v2
    s_nop 1
    v_cndmask_b32 v196, v196, v204, vcc
    v_cndmask_b32 v197, v197, v205, vcc
    v_cndmask_b32 v198, v198, v206, vcc
    v_cndmask_b32 v199, v199, v207, vcc
    v_cmp_eq_u32 vcc, 3, v2
    s_nop 1
    v_cndmask_b32 v196, v196, v208, vcc
    v_cndmask_b32 v197, v197, v209, vcc
    v_cndmask_b32 v198, v198, v210, vcc
    v_cndmask_b32 v199, v199, v211, vcc
    s_mov_b32 exec_lo, 0xf000f
    s_mov_b32 exec_hi, 0xf000f
    buffer_store_dwordx4 v[196:199], v7, s[40:43], 0 offen sc1
    s_mov_b64 exec, -1
    s_branch L_NSJ
L_LN:
    s_waitcnt vmcnt(4)
    v_lshrrev_b32 v6, 4, v0
    v_mul_u32_u24 v5, 1312, v6
    v_lshrrev_b32 v6, 3, v6
    v_lshl_add_u32 v5, v6, 7, v5
    v_lshl_add_u32 v5, v2, 4, v5
    v_add_u32 v5, 45824, v5
    ds_write_b128 v5, v[36:39] offset:0
    ds_write_b128 v5, v[40:43] offset:256
    ds_write_b128 v5, v[44:47] offset:512
    ds_write_b128 v5, v[48:51] offset:768
    ds_write_b128 v5, v[52:55] offset:1024
    v_and_b32 v6, 1, v3
    v_mul_u32_u24 v5, 10624, v6
    v_lshrrev_b32 v7, 1, v3
    v_lshl_add_u32 v5, v7, 5, v5
    v_bfe_u32 v160, v1, 2, 2
    v_mul_u32_u24 v160, 1312, v160
    v_add_u32 v5, v5, v160
    v_lshl_add_u32 v5, v31, 3, v5
    s_mul_i32 s39, s52, 320
    s_add_u32 s39, s39, 45824
    v_add_u32 v5, s39, v5
    v_mul_u32_u24 v32, 10240, v6
    v_lshl_add_u32 v32, v7, 8, v32
    v_lshl_add_u32 v32, v2, 4, v32
    s_mul_i32 s39, s57, 20480
    s_mul_i32 s59, s52, 2560
    s_add_u32 s39, s39, s59
    s_add_u32 s39, s39, 3670016
    s_waitcnt lgkmcnt(0)
    s_barrier
    ds_read_b64_tr_b16 v[168:169], v5 offset:0
    ds_read_b64_tr_b16 v[170:171], v5 offset:5248
    ds_read_b64_tr_b16 v[172:173], v5 offset:64
    ds_read_b64_tr_b16 v[174:175], v5 offset:5312
    ds_read_b64_tr_b16 v[176:177], v5 offset:128
    ds_read_b64_tr_b16 v[178:179], v5 offset:5376
    ds_read_b64_tr_b16 v[180:181], v5 offset:192
    ds_read_b64_tr_b16 v[182:183], v5 offset:5440
    ds_read_b64_tr_b16 v[184:185], v5 offset:256
    ds_read_b64_tr_b16 v[186:187], v5 offset:5504
    v_lshlrev_b32 v120, 16, v36
    v_and_b32 v121, 0xffff0000, v36
    v_lshlrev_b32 v122, 16, v37
    v_and_b32 v123, 0xffff0000, v37
    v_lshlrev_b32 v124, 16, v38
    v_and_b32 v125, 0xffff0000, v38
    v_lshlrev_b32 v126, 16, v39
    v_and_b32 v127, 0xffff0000, v39
    s_waitcnt lgkmcnt(8)
    buffer_store_dwordx4 v[168:171], v32, s[40:43], s39 offen offset:0 sc1
    v_lshlrev_b32 v128, 16, v40
    v_and_b32 v129, 0xffff0000, v40
    v_lshlrev_b32 v130, 16, v41
    v_and_b32 v131, 0xffff0000, v41
    v_lshlrev_b32 v132, 16, v42
    v_and_b32 v133, 0xffff0000, v42
    v_lshlrev_b32 v134, 16, v43
    v_and_b32 v135, 0xffff0000, v43
    s_waitcnt lgkmcnt(6)
    buffer_store_dwordx4 v[172:175], v32, s[40:43], s39 offen offset:512 sc1
    v_lshlrev_b32 v136, 16, v44
    v_and_b32 v137, 0xffff0000, v44
    v_lshlrev_b32 v138, 16, v45
    v_and_b32 v139, 0xffff0000, v45
    v_lshlrev_b32 v140, 16, v46
    v_and_b32 v141, 0xffff0000, v46
    v_lshlrev_b32 v142, 16, v47
    v_and_b32 v143, 0xffff0000, v47
    s_waitcnt lgkmcnt(4)
    buffer_store_dwordx4 v[176:179], v32, s[40:43], s39 offen offset:1024 sc1
    v_lshlrev_b32 v144, 16, v48
    v_and_b32 v145, 0xffff0000, v48
    v_lshlrev_b32 v146, 16, v49
    v_and_b32 v147, 0xffff0000, v49
    v_lshlrev_b32 v148, 16, v50
    v_and_b32 v149, 0xffff0000, v50
    v_lshlrev_b32 v150, 16, v51
    v_and_b32 v151, 0xffff0000, v51
    s_waitcnt lgkmcnt(2)
    buffer_store_dwordx4 v[180:183], v32, s[40:43], s39 offen offset:1536 sc1
    v_lshlrev_b32 v152, 16, v52
    v_and_b32 v153, 0xffff0000, v52
    v_lshlrev_b32 v154, 16, v53
    v_and_b32 v155, 0xffff0000, v53
    v_lshlrev_b32 v156, 16, v54
    v_and_b32 v157, 0xffff0000, v54
    v_lshlrev_b32 v158, 16, v55
    v_and_b32 v159, 0xffff0000, v55
    s_waitcnt lgkmcnt(0)
    buffer_store_dwordx4 v[184:187], v32, s[40:43], s39 offen offset:2048 sc1
    v_pk_add_f32 v[160:161], v[120:121], v[122:123]
    v_pk_mul_f32 v[162:163], v[120:121], v[120:121]
    v_pk_add_f32 v[164:165], v[124:125], v[126:127]
    v_pk_mul_f32 v[166:167], v[124:125], v[124:125]
    v_pk_fma_f32 v[162:163], v[122:123], v[122:123], v[162:163]
    v_pk_fma_f32 v[166:167], v[126:127], v[126:127], v[166:167]
    v_pk_add_f32 v[160:161], v[160:161], v[128:129]
    v_pk_fma_f32 v[162:163], v[128:129], v[128:129], v[162:163]
    v_pk_add_f32 v[164:165], v[164:165], v[130:131]
    v_pk_fma_f32 v[166:167], v[130:131], v[130:131], v[166:167]
    v_pk_add_f32 v[160:161], v[160:161], v[132:133]
    v_pk_fma_f32 v[162:163], v[132:133], v[132:133], v[162:163]
    v_pk_add_f32 v[164:165], v[164:165], v[134:135]
    v_pk_fma_f32 v[166:167], v[134:135], v[134:135], v[166:167]
    v_pk_add_f32 v[160:161], v[160:161], v[136:137]
    v_pk_fma_f32 v[162:163], v[136:137], v[136:137], v[162:163]
    v_pk_add_f32 v[164:165], v[164:165], v[138:139]
    v_pk_fma_f32 v[166:167], v[138:139], v[138:139], v[166:167]
    v_pk_add_f32 v[160:161], v[160:161], v[140:141]
    v_pk_fma_f32 v[162:163], v[140:141], v[140:141], v[162:163]
    v_pk_add_f32 v[164:165], v[164:165], v[142:143]
    v_pk_fma_f32 v[166:167], v[142:143], v[142:143], v[166:167]
    v_pk_add_f32 v[160:161], v[160:161], v[144:145]
    v_pk_fma_f32 v[162:163], v[144:145], v[144:145], v[162:163]
    v_pk_add_f32 v[164:165], v[164:165], v[146:147]
    v_pk_fma_f32 v[166:167], v[146:147], v[146:147], v[166:167]
    v_pk_add_f32 v[160:161], v[160:161], v[148:149]
    v_pk_fma_f32 v[162:163], v[148:149], v[148:149], v[162:163]
    v_pk_add_f32 v[164:165], v[164:165], v[150:151]
    v_pk_fma_f32 v[166:167], v[150:151], v[150:151], v[166:167]
    v_pk_add_f32 v[160:161], v[160:161], v[152:153]
    v_pk_fma_f32 v[162:163], v[152:153], v[152:153], v[162:163]
    v_pk_add_f32 v[164:165], v[164:165], v[154:155]
    v_pk_fma_f32 v[166:167], v[154:155], v[154:155], v[166:167]
    v_pk_add_f32 v[160:161], v[160:161], v[156:157]
    v_pk_fma_f32 v[162:163], v[156:157], v[156:157], v[162:163]
    v_pk_add_f32 v[164:165], v[164:165], v[158:159]
    v_pk_fma_f32 v[166:167], v[158:159], v[158:159], v[166:167]
    v_pk_add_f32 v[160:161], v[160:161], v[164:165]
    v_pk_add_f32 v[162:163], v[162:163], v[166:167]
    v_add_f32 v160, v160, v161
    v_add_f32 v161, v162, v163
    s_nop 0
    v_add_f32_dpp v160, v160, v160 row_ror:8 row_mask:0xf bank_mask:0xf
    v_add_f32_dpp v161, v161, v161 row_ror:8 row_mask:0xf bank_mask:0xf
    s_nop 0
    v_add_f32_dpp v160, v160, v160 row_ror:4 row_mask:0xf bank_mask:0xf
    v_add_f32_dpp v161, v161, v161 row_ror:4 row_mask:0xf bank_mask:0xf
    s_nop 0
    v_add_f32_dpp v160, v160, v160 row_ror:2 row_mask:0xf bank_mask:0xf
    v_add_f32_dpp v161, v161, v161 row_ror:2 row_mask:0xf bank_mask:0xf
    s_nop 0
    v_add_f32_dpp v160, v160, v160 row_ror:1 row_mask:0xf bank_mask:0xf
    v_add_f32_dpp v161, v161, v161 row_ror:1 row_mask:0xf bank_mask:0xf
    v_mul_f32 v163, 0x3acccccd, v160
    v_mul_f32 v162, 0x3acccccd, v161
    v_fma_f32 v162, -v163, v163, v162
    v_max_f32 v162, 0, v162
    v_add_f32 v162, 0x3727c5ac, v162
    v_rsq_f32 v162, v162
    v_lshlrev_b32 v5, 13, v2
    v_lshl_add_u32 v5, v3, 2, v5
    v_mul_f32 v163, -v163, v162
    s_and_b32 s39, s52, 1
    s_lshl_b32 s39, s39, 12
    s_lshr_b32 s59, s52, 1
    s_lshl_b32 s59, s59, 4
    s_add_u32 s39, s39, s59
    s_lshl_b32 s59, s57, 5
    s_add_u32 s39, s39, s59
    s_add_u32 s39, s39, 65536
    v_cmp_eq_u32 vcc, 0, v2
    s_nop 1
    v_cndmask_b32 v162, v163, v162, vcc
    s_mov_b32 exec_lo, 0x30003
    s_mov_b32 exec_hi, 0x30003
    buffer_store_dword v162, v5, s[40:43], s39 offen sc1
    s_mov_b64 exec, -1
    s_mov_b32 s27, 1
    v_cmp_lt_u32 vcc, 231, v0
    s_nop 1
    v_cndmask_b32 v6, 0, 64, vcc
    v_mov_b32 v7, 131
    v_cmp_lt_u32 vcc, 240, v0
    s_nop 1
    v_cndmask_b32 v6, v6, v7, vcc
    v_lshlrev_b32 v5, 3, v0
    v_sub_u32 v5, v6, v5
    v_add_u32 v5, 2047, v5
    v_cvt_f32_u32 v5, v5
    v_lshlrev_b32 v6, 1, v6
    v_sub_u32 v6, 103440, v6
    v_subrev_f32 v8, 0x00000000, v5
    v_subrev_f32 v7, 0x3f800000, v5
    v_cvt_pk_bf16_f32 v7, v8, v7
    v_and_b32 v8, 0xffff, v7
    v_lshl_add_u32 v8, v8, 1, v6
    v_lshrrev_b32 v7, 16, v7
    v_lshl_add_u32 v9, v7, 1, v6
    v_subrev_f32 v10, 0x40000000, v5
    v_subrev_f32 v7, 0x40400000, v5
    v_cvt_pk_bf16_f32 v7, v10, v7
    v_and_b32 v10, 0xffff, v7
    v_lshl_add_u32 v10, v10, 1, v6
    v_lshrrev_b32 v7, 16, v7
    v_lshl_add_u32 v11, v7, 1, v6
    v_subrev_f32 v12, 0x40800000, v5
    v_subrev_f32 v7, 0x40a00000, v5
    v_cvt_pk_bf16_f32 v7, v12, v7
    v_and_b32 v12, 0xffff, v7
    v_lshl_add_u32 v12, v12, 1, v6
    v_lshrrev_b32 v7, 16, v7
    v_lshl_add_u32 v13, v7, 1, v6
    v_subrev_f32 v14, 0x40c00000, v5
    v_subrev_f32 v7, 0x40e00000, v5
    v_cvt_pk_bf16_f32 v7, v14, v7
    v_and_b32 v14, 0xffff, v7
    v_lshl_add_u32 v14, v14, 1, v6
    v_lshrrev_b32 v7, 16, v7
    v_lshl_add_u32 v15, v7, 1, v6
    v_subrev_f32 v16, 0x41000000, v5
    v_subrev_f32 v7, 0x41100000, v5
    v_cvt_pk_bf16_f32 v7, v16, v7
    v_and_b32 v16, 0xffff, v7
    v_lshl_add_u32 v16, v16, 1, v6
    v_lshrrev_b32 v7, 16, v7
    v_lshl_add_u32 v17, v7, 1, v6
    v_subrev_f32 v18, 0x41200000, v5
    v_subrev_f32 v7, 0x41300000, v5
    v_cvt_pk_bf16_f32 v7, v18, v7
    v_and_b32 v18, 0xffff, v7
    v_lshl_add_u32 v18, v18, 1, v6
    v_subrev_u32 v5, 30, v1
    v_lshrrev_b32 v26, 1, v5
    v_mul_u32_u24 v26, 4160, v26
    v_and_b32 v5, 1, v5
    v_lshl_add_u32 v26, v5, 4, v26
    v_add_u32 v26, 8704, v26
    v_cmp_gt_u32 vcc, 30, v1
    s_nop 1
    v_cndmask_b32 v26, v26, v4, vcc
    s_min_u32 s39, s52, 2
    s_mul_i32 s22, s39, 45824
    v_add_u32 v26, s22, v26
    v_lshrrev_b32 v5, 3, v1
    v_mul_u32_u24 v23, 20480, v5
    v_bfe_u32 v7, v1, 2, 1
    v_mul_u32_u24 v7, 10240, v7
    v_add_u32 v23, v23, v7
    v_lshl_add_u32 v23, v31, 4, v23
    v_cmp_gt_u32 s[24:25], s56, v31
    s_nop 1
    v_cndmask_b32 v23, 2.0, v23, s[24:25]
    v_bfe_u32 v5, v1, 2, 2
    v_lshlrev_b32 v5, 2, v5
    s_movk_i32 s59, 0x4210
    v_lshrrev_b32 v24, v5, s59
    v_and_b32 v24, 15, v24
    v_mul_u32_u24 v6, 15360, v3
    v_lshl_add_u32 v6, v31, 2, v6
    v_mul_u32_u24 v24, 2560, v24
    v_add_u32 v24, v24, v6
    v_sub_u32 v19, 3, v2
    v_and_b32 v19, 3, v19
    v_mul_u32_u24 v19, 4160, v19
    v_lshrrev_b32 v20, 2, v2
    v_lshlrev_b32 v20, 3, v20
    v_sub_u32 v19, v19, v20
    v_lshl_add_u32 v19, v3, 4, v19
    v_add_u32 v19, 4632, v19
    v_lshlrev_b32 v20, 5, v2
    v_lshl_add_u32 v20, v3, 4, v20
    s_waitcnt vmcnt(0) lgkmcnt(0)
    s_mov_b32 s39, 0
L_S1Pl:
    v_cmp_ne_u32 vcc, 0, v29
    s_cbranch_vccnz L_S1Xl
    global_load_dword v29, v21, s[16:17] sc1
    s_add_u32 s39, s39, 1
    s_cmp_gt_u32 s39, 0x100000
    s_waitcnt vmcnt(0)
    s_cbranch_scc0 L_S1Pl
L_S1Xl:
    v_readfirstlane_b32 s38, v29
    s_barrier
    s_cmp_lg_u32 s52, 3
    s_cbranch_scc1 L_NA0
    s_and_b32 s39, s2, 63
    s_lshl_b32 s39, s39, 7
    s_lshr_b32 s59, s2, 6
    s_lshl_b32 s59, s59, 2
    s_add_u32 s39, s39, s59
    s_add_u32 s39, s39, 14680064
    v_lshlrev_b32 v21, 13, v1
    v_mov_b32 v22, s38
    s_mov_b64 exec, 0xff
    buffer_store_dword v22, v21, s[40:43], s39 offen sc1
    s_mov_b64 exec, -1
L_NA0:
    s_cmp_lg_u32 s52, 3
    s_cbranch_scc1 L_PKDb
    s_mov_b32 s19, 91648
L_GDb:
    s_mov_b32 m0, s19
    s_add_u32 s19, s19, 4096
    buffer_load_dwordx4 v71, s[44:47], s18 offen offset:0 nt lds
    s_add_u32 s18, s18, 60416
    buffer_load_dwordx4 v71, s[44:47], s18 offen offset:1024 nt lds
    s_add_u32 s18, s18, 60416
    buffer_load_dwordx4 v71, s[44:47], s18 offen offset:2048 nt lds
    s_add_u32 s18, s18, 60416
    buffer_load_dwordx4 v71, s[44:47], s18 offen offset:3072 nt lds
    s_add_u32 s18, s18, 64512
    s_cmp_lt_u32 s19, 112128
    s_cbranch_scc1 L_GDb
    s_branch L_NSJ
L_PKDb:
    s_sub_u32 s7, s7, 1024
    s_add_u32 m0, s26, 112896
    s_nop 0
    buffer_load_dwordx4 v66, s[48:51], s14 offen offset:0 nt lds
    s_add_u32 s14, s14, s7
    buffer_load_dwordx4 v67, s[48:51], s14 offen offset:1024 nt lds
    s_add_u32 s14, s14, s7
    buffer_load_dwordx4 v66, s[48:51], s14 offen offset:2048 nt lds
    s_add_u32 s14, s14, s7
    buffer_load_dwordx4 v67, s[48:51], s14 offen offset:3072 nt lds
    s_add_u32 m0, s26, 116992
    s_nop 0
    buffer_load_dwordx4 v66, s[48:51], s15 offen offset:0 nt lds
    s_add_u32 s15, s15, s7
    buffer_load_dwordx4 v67, s[48:51], s15 offen offset:1024 nt lds
    s_add_u32 s15, s15, s7
    buffer_load_dwordx4 v66, s[48:51], s15 offen offset:2048 nt lds
    s_add_u32 s15, s15, s7
    buffer_load_dwordx4 v67, s[48:51], s15 offen offset:3072 nt lds
    s_branch L_NSJ
L_GEN:
    s_cmp_lg_u32 s27, 1
    s_cbranch_scc1 L_ST2
    s_cmp_lg_u32 s52, 3
    s_cbranch_scc1 L_H1
    s_waitcnt vmcnt(0)
    s_mov_b32 s39, 0
L_S1Ph:
    v_cmp_ne_u32 vcc, 0, v29
    s_cbranch_vccnz L_S1Xh
    global_load_dword v29, v21, s[16:17] sc1
    s_add_u32 s39, s39, 1
    s_cmp_gt_u32 s39, 0x100000
    s_waitcnt vmcnt(0)
    s_cbranch_scc0 L_S1Ph
L_S1Xh:
    v_readfirstlane_b32 s38, v29
    s_and_b32 s39, s2, 63
    s_lshl_b32 s39, s39, 7
    s_lshr_b32 s59, s2, 6
    s_lshl_b32 s59, s59, 2
    s_add_u32 s39, s39, s59
    s_add_u32 s39, s39, 14680064
    v_lshlrev_b32 v21, 13, v1
    v_mov_b32 v22, s38
    s_mov_b64 exec, 0xff
    buffer_store_dword v22, v21, s[40:43], s39 offen sc1
    s_mov_b64 exec, -1
L_H1:
    v_cmp_lt_u32 vcc, 231, v0
    s_nop 1
    v_cndmask_b32 v6, 0, 64, vcc
    v_mov_b32 v7, 131
    v_cmp_lt_u32 vcc, 240, v0
    s_nop 1
    v_cndmask_b32 v6, v6, v7, vcc
    v_lshlrev_b32 v5, 3, v0
    v_sub_u32 v5, v6, v5
    v_add_u32 v5, 2047, v5
    v_cvt_f32_u32 v5, v5
    v_lshlrev_b32 v6, 1, v6
    v_sub_u32 v6, 103440, v6
    v_subrev_f32 v8, 0x00000000, v5
    v_subrev_f32 v7, 0x3f800000, v5
    v_cvt_pk_bf16_f32 v7, v8, v7
    v_and_b32 v8, 0xffff, v7
    v_lshl_add_u32 v8, v8, 1, v6
    v_lshrrev_b32 v7, 16, v7
    v_lshl_add_u32 v9, v7, 1, v6
    v_subrev_f32 v10, 0x40000000, v5
    v_subrev_f32 v7, 0x40400000, v5
    v_cvt_pk_bf16_f32 v7, v10, v7
    v_and_b32 v10, 0xffff, v7
    v_lshl_add_u32 v10, v10, 1, v6
    v_lshrrev_b32 v7, 16, v7
    v_lshl_add_u32 v11, v7, 1, v6
    v_subrev_f32 v12, 0x40800000, v5
    v_subrev_f32 v7, 0x40a00000, v5
    v_cvt_pk_bf16_f32 v7, v12, v7
    v_and_b32 v12, 0xffff, v7
    v_lshl_add_u32 v12, v12, 1, v6
    v_lshrrev_b32 v7, 16, v7
    v_lshl_add_u32 v13, v7, 1, v6
    v_subrev_f32 v14, 0x40c00000, v5
    v_subrev_f32 v7, 0x40e00000, v5
    v_cvt_pk_bf16_f32 v7, v14, v7
    v_and_b32 v14, 0xffff, v7
    v_lshl_add_u32 v14, v14, 1, v6
    v_lshrrev_b32 v7, 16, v7
    v_lshl_add_u32 v15, v7, 1, v6
    v_subrev_f32 v16, 0x41000000, v5
    v_subrev_f32 v7, 0x41100000, v5
    v_cvt_pk_bf16_f32 v7, v16, v7
    v_and_b32 v16, 0xffff, v7
    v_lshl_add_u32 v16, v16, 1, v6
    v_lshrrev_b32 v7, 16, v7
    v_lshl_add_u32 v17, v7, 1, v6
    v_subrev_f32 v18, 0x41200000, v5
    v_subrev_f32 v7, 0x41300000, v5
    v_cvt_pk_bf16_f32 v7, v18, v7
    v_and_b32 v18, 0xffff, v7
    v_lshl_add_u32 v18, v18, 1, v6
    v_subrev_u32 v5, 30, v1
    v_lshrrev_b32 v26, 1, v5
    v_mul_u32_u24 v26, 4160, v26
    v_and_b32 v5, 1, v5
    v_lshl_add_u32 v26, v5, 4, v26
    v_add_u32 v26, 8704, v26
    v_cmp_gt_u32 vcc, 30, v1
    s_nop 1
    v_cndmask_b32 v26, v26, v4, vcc
    s_min_u32 s39, s52, 2
    s_mul_i32 s22, s39, 45824
    v_add_u32 v26, s22, v26
    v_lshrrev_b32 v5, 3, v1
    v_mul_u32_u24 v23, 20480, v5
    v_bfe_u32 v7, v1, 2, 1
    v_mul_u32_u24 v7, 10240, v7
    v_add_u32 v23, v23, v7
    v_lshl_add_u32 v23, v31, 4, v23
    v_cmp_gt_u32 s[24:25], s56, v31
    s_nop 1
    v_cndmask_b32 v23, 2.0, v23, s[24:25]
    v_bfe_u32 v5, v1, 2, 2
    v_lshlrev_b32 v5, 2, v5
    s_movk_i32 s59, 0x4210
    v_lshrrev_b32 v24, v5, s59
    v_and_b32 v24, 15, v24
    v_mul_u32_u24 v6, 15360, v3
    v_lshl_add_u32 v6, v31, 2, v6
    v_mul_u32_u24 v24, 2560, v24
    v_add_u32 v24, v24, v6
    v_sub_u32 v19, 3, v2
    v_and_b32 v19, 3, v19
    v_mul_u32_u24 v19, 4160, v19
    v_lshrrev_b32 v20, 2, v2
    v_lshlrev_b32 v20, 3, v20
    v_sub_u32 v19, v19, v20
    v_lshl_add_u32 v19, v3, 4, v19
    v_add_u32 v19, 4632, v19
    v_lshlrev_b32 v20, 5, v2
    v_lshl_add_u32 v20, v3, 4, v20
    s_cmp_eq_u32 s52, 3
    s_cbranch_scc1 L_NSJ
    s_waitcnt vmcnt(0)
    s_mov_b32 s39, 0
L_S1Pg:
    v_cmp_ne_u32 vcc, 0, v29
    s_cbranch_vccnz L_S1Xg
    global_load_dword v29, v21, s[16:17] sc1
    s_add_u32 s39, s39, 1
    s_cmp_gt_u32 s39, 0x100000
    s_waitcnt vmcnt(0)
    s_cbranch_scc0 L_S1Pg
L_S1Xg:
    v_readfirstlane_b32 s38, v29
    s_cmp_ge_u32 s4, 680
    s_cbranch_scc1 L_SJEl
    s_cmp_ge_u32 s4, 100
    s_cbranch_scc1 L_Pjl1
    s_sub_u32 s6, s4, 0
    s_mul_i32 s5, s6, 13108
    s_lshr_b32 s5, s5, 16
    s_mul_i32 s39, s5, 5
    s_sub_u32 s6, s6, s39
    s_mov_b32 s8, 5
    s_mov_b32 s9, 100
    s_mov_b32 s10, 6291456
    s_mov_b32 s11, 13108
    s_branch L_PCjl
L_Pjl1:
    s_cmp_ge_u32 s4, 200
    s_cbranch_scc1 L_Pjl2
    s_sub_u32 s6, s4, 100
    s_mul_i32 s5, s6, 13108
    s_lshr_b32 s5, s5, 16
    s_mul_i32 s39, s5, 5
    s_sub_u32 s6, s6, s39
    s_mov_b32 s8, 5
    s_mov_b32 s9, 100
    s_mov_b32 s10, 7110656
    s_mov_b32 s11, 13108
    s_branch L_PCjl
L_Pjl2:
    s_cmp_ge_u32 s4, 440
    s_cbranch_scc1 L_Pjl3
    s_sub_u32 s6, s4, 200
    s_mul_i32 s5, s6, 5462
    s_lshr_b32 s5, s5, 16
    s_mul_i32 s39, s5, 12
    s_sub_u32 s6, s6, s39
    s_mov_b32 s8, 3
    s_mov_b32 s9, 60
    s_mov_b32 s10, 7929856
    s_mov_b32 s11, 21846
    s_branch L_PCjl
L_Pjl3:
    s_sub_u32 s6, s4, 440
    s_mul_i32 s5, s6, 13108
    s_lshr_b32 s5, s5, 16
    s_mul_i32 s39, s5, 5
    s_sub_u32 s6, s6, s39
    s_mov_b32 s8, 5
    s_mov_b32 s9, 240
    s_mov_b32 s10, 9895936
    s_mov_b32 s11, 13108
L_PCjl:
    s_mul_i32 s5, s5, s8
    s_lshl_b32 s6, s6, 3
    s_add_u32 s39, s26, 112896
    v_add_u32 v65, s39, v28
    s_mul_i32 s59, s6, s11
    s_lshr_b32 s59, s59, 16
    s_mul_i32 s60, s59, s8
    s_sub_u32 s60, s6, s60
    s_mul_i32 s59, s59, s9
    s_add_u32 s39, s60, s59
    s_add_u32 s39, s39, s5
    s_lshl_b32 s39, s39, 10
    s_add_u32 s39, s39, s10
    s_sub_u32 s59, s9, s8
    s_add_u32 s59, s59, 1
    s_lshl_b32 s59, s59, 10
    v_xor_b32 v5, 0, v65
    ds_read_b64_tr_b16 v[72:73], v5
    ds_read_b64_tr_b16 v[74:75], v5 offset:4096
    v_xor_b32 v5, 32, v65
    ds_read_b64_tr_b16 v[76:77], v5
    ds_read_b64_tr_b16 v[78:79], v5 offset:4096
    v_xor_b32 v5, 64, v65
    ds_read_b64_tr_b16 v[80:81], v5
    ds_read_b64_tr_b16 v[82:83], v5 offset:4096
    v_xor_b32 v5, 96, v65
    ds_read_b64_tr_b16 v[84:85], v5
    ds_read_b64_tr_b16 v[86:87], v5 offset:4096
    v_xor_b32 v5, 128, v65
    ds_read_b64_tr_b16 v[88:89], v5
    ds_read_b64_tr_b16 v[90:91], v5 offset:4096
    v_xor_b32 v5, 160, v65
    ds_read_b64_tr_b16 v[92:93], v5
    ds_read_b64_tr_b16 v[94:95], v5 offset:4096
    s_waitcnt lgkmcnt(10)
    buffer_store_dwordx4 v[72:75], v4, s[40:43], s39 offen sc1
    v_xor_b32 v5, 192, v65
    ds_read_b64_tr_b16 v[96:97], v5
    ds_read_b64_tr_b16 v[98:99], v5 offset:4096
    s_add_u32 s60, s60, 1
    s_cmp_eq_u32 s60, s8
    s_cselect_b32 s61, s59, 1024
    s_cselect_b32 s60, 0, s60
    s_add_u32 s39, s39, s61
    s_waitcnt lgkmcnt(10)
    buffer_store_dwordx4 v[76:79], v4, s[40:43], s39 offen sc1
    v_xor_b32 v5, 224, v65
    ds_read_b64_tr_b16 v[100:101], v5
    ds_read_b64_tr_b16 v[102:103], v5 offset:4096
    s_add_u32 s60, s60, 1
    s_cmp_eq_u32 s60, s8
    s_cselect_b32 s61, s59, 1024
    s_cselect_b32 s60, 0, s60
    s_add_u32 s39, s39, s61
    s_waitcnt lgkmcnt(10)
    buffer_store_dwordx4 v[80:83], v4, s[40:43], s39 offen sc1
    s_add_u32 s60, s60, 1
    s_cmp_eq_u32 s60, s8
    s_cselect_b32 s61, s59, 1024
    s_cselect_b32 s60, 0, s60
    s_add_u32 s39, s39, s61
    s_waitcnt lgkmcnt(8)
    buffer_store_dwordx4 v[84:87], v4, s[40:43], s39 offen sc1
    s_add_u32 s60, s60, 1
    s_cmp_eq_u32 s60, s8
    s_cselect_b32 s61, s59, 1024
    s_cselect_b32 s60, 0, s60
    s_add_u32 s39, s39, s61
    s_waitcnt lgkmcnt(6)
    buffer_store_dwordx4 v[88:91], v4, s[40:43], s39 offen sc1
    s_add_u32 s60, s60, 1
    s_cmp_eq_u32 s60, s8
    s_cselect_b32 s61, s59, 1024
    s_cselect_b32 s60, 0, s60
    s_add_u32 s39, s39, s61
    s_waitcnt lgkmcnt(4)
    buffer_store_dwordx4 v[92:95], v4, s[40:43], s39 offen sc1
    s_add_u32 s60, s60, 1
    s_cmp_eq_u32 s60, s8
    s_cselect_b32 s61, s59, 1024
    s_cselect_b32 s60, 0, s60
    s_add_u32 s39, s39, s61
    s_waitcnt lgkmcnt(2)
    buffer_store_dwordx4 v[96:99], v4, s[40:43], s39 offen sc1
    s_add_u32 s60, s60, 1
    s_cmp_eq_u32 s60, s8
    s_cselect_b32 s61, s59, 1024
    s_cselect_b32 s60, 0, s60
    s_add_u32 s39, s39, s61
    s_waitcnt lgkmcnt(0)
    buffer_store_dwordx4 v[100:103], v4, s[40:43], s39 offen sc1
L_SJEl:
    s_branch L_NSJ
L_ST2:
    s_cmp_eq_u32 s58, 1
    s_cbranch_scc1 L_NA1
    s_waitcnt vmcnt(0)
    s_barrier
    s_cmp_lg_u32 s52, 3
    s_cbranch_scc1 L_NA1
    s_and_b32 s39, s2, 63
    s_lshl_b32 s39, s39, 7
    s_lshr_b32 s59, s2, 6
    s_lshl_b32 s59, s59, 2
    s_add_u32 s39, s39, s59
    s_add_u32 s39, s39, 14745600
    v_lshlrev_b32 v21, 13, v1
    s_getreg_b32 s59, hwreg(HW_REG_XCC_ID, 0, 3)
    s_add_u32 s59, s59, s38
    v_mov_b32 v22, s59
    s_mov_b64 exec, 0xff
    buffer_store_dword v22, v21, s[40:43], s39 offen sc1
    s_mov_b64 exec, -1
L_NA1:
    s_cmp_eq_u32 s52, 3
    s_cbranch_scc1 L_NSJ
    s_lshl_b32 s39, s53, 5
    s_lshl_b32 s59, s54, 2
    s_add_u32 s39, s39, s59
    s_add_u32 s39, s39, s52
    s_lshl_b32 s39, s39, 7
    v_min_u32 v5, 4, v1
    v_lshlrev_b32 v5, 17, v5
    v_add_u32 v5, 14811136, v5
    v_lshlrev_b32 v6, 17, v1
    v_add_u32 v6, -524288, v6
    v_cmp_lt_u32 vcc, 7, v1
    s_nop 1
    v_cndmask_b32 v5, v5, v6, vcc
    v_mov_b32 v6, 131072
    v_cmp_lt_u32 vcc, 11, v1
    s_nop 1
    v_cndmask_b32 v5, v5, v6, vcc
    buffer_load_dword v254, v5, s[40:43], s39 offen
L_NSJ:
    ds_read_b32 v120, v35 offset:0
    ds_read_b32 v121, v35 offset:256
    ds_read_b32 v122, v35 offset:512
    ds_read_b32 v123, v35 offset:2304
    ds_read_b32 v124, v35 offset:2560
    ds_read_b32 v125, v35 offset:2816
    s_cmp_eq_u32 s52, 2
    s_cbranch_scc1 L_G2
    s_cmp_eq_u32 s52, 3
    s_cbranch_scc1 L_G3
    s_cmp_eq_u32 s52, 1
    s_cbranch_scc1 L_G1
    ds_read_b32 v138, v35 offset:4608
    ds_read_b32 v139, v35 offset:6912
    ds_read_b32 v140, v35 offset:4864
    ds_read_b32 v141, v35 offset:7168
    ds_read_b32 v142, v35 offset:5120
    ds_read_b32 v143, v35 offset:7424
    s_waitcnt lgkmcnt(6)
    v_mul_f32 v144, 0x41800000, v120
    v_mul_f32 v147, 0xc1800000, v123
    v_mul_f32 v145, 0x41800000, v121
    v_mul_f32 v148, 0xc1800000, v124
    v_mul_f32 v146, 0x41800000, v122
    v_mul_f32 v149, 0xc1800000, v125
    v_fract_f32 v147, v147
    v_exp_f32 v144, v144
    v_fract_f32 v148, v148
    v_exp_f32 v145, v145
    v_fract_f32 v149, v149
    v_exp_f32 v146, v146
    v_cos_f32 v126, v147
    v_sin_f32 v127, v147
    v_cos_f32 v128, v148
    v_sin_f32 v129, v148
    v_cos_f32 v130, v149
    v_sin_f32 v131, v149
    v_mul_f32 v126, v126, v144
    v_mul_f32 v127, v127, v144
    v_mul_f32 v128, v128, v145
    v_mul_f32 v129, v129, v145
    v_mul_f32 v130, v130, v146
    v_mul_f32 v131, v131, v146
    v_mov_b32 v156, v34
    s_waitcnt lgkmcnt(0)
    s_branch L_G01
L_G1:
    s_waitcnt lgkmcnt(0)
    v_mul_f32 v144, 0x3f800000, v120
    v_mul_f32 v147, 0x3f800000, v123
    v_mul_f32 v145, 0x3f800000, v121
    v_mul_f32 v148, 0x3f800000, v124
    v_mul_f32 v146, 0x3f800000, v122
    v_mul_f32 v149, 0x3f800000, v125
    v_fract_f32 v147, v147
    v_exp_f32 v144, v144
    v_fract_f32 v148, v148
    v_exp_f32 v145, v145
    v_fract_f32 v149, v149
    v_exp_f32 v146, v146
    v_cos_f32 v126, v147
    v_sin_f32 v127, v147
    v_cos_f32 v128, v148
    v_sin_f32 v129, v148
    v_cos_f32 v130, v149
    v_sin_f32 v131, v149
    v_mul_f32 v126, v126, v144
    v_mul_f32 v127, v127, v144
    v_mul_f32 v128, v128, v145
    v_mul_f32 v129, v129, v145
    v_mul_f32 v130, v130, v146
    v_mul_f32 v131, v131, v146
    v_mov_b32 v138, 1.0
    v_mov_b32 v139, 0
    v_mov_b32 v140, 1.0
    v_mov_b32 v141, 0
    v_mov_b32 v142, 1.0
    v_mov_b32 v143, 0
    v_add_u32 v156, 12800, v34
L_G01:
.p2align 3
    v_cvt_pk_bf16_f32 v150, v138, v139
    v_cvt_pk_bf16_f32 v151, v140, v141
    v_cvt_pk_bf16_f32 v152, v142, v143
    v_pk_mul_f32 v[144:145], v[138:139], v[126:127] op_sel:[1,1] op_sel_hi:[0,1] neg_lo:[1,0]
    v_pk_mul_f32 v[146:147], v[140:141], v[128:129] op_sel:[1,1] op_sel_hi:[0,1] neg_lo:[1,0]
    v_pk_mul_f32 v[148:149], v[142:143], v[130:131] op_sel:[1,1] op_sel_hi:[0,1] neg_lo:[1,0]
    v_pk_fma_f32 v[138:139], v[138:139], v[126:127], v[144:145] op_sel_hi:[1,0,1]
    v_pk_fma_f32 v[140:141], v[140:141], v[128:129], v[146:147] op_sel_hi:[1,0,1]
    v_pk_fma_f32 v[142:143], v[142:143], v[130:131], v[148:149] op_sel_hi:[1,0,1]
    ds_write_b32 v156, v150 offset:0
    ds_write_b32 v156, v151 offset:256
    ds_write_b32 v156, v152 offset:512
    v_cvt_pk_bf16_f32 v153, v138, v139
    v_cvt_pk_bf16_f32 v154, v140, v141
    v_cvt_pk_bf16_f32 v155, v142, v143
    v_pk_mul_f32 v[144:145], v[138:139], v[126:127] op_sel:[1,1] op_sel_hi:[0,1] neg_lo:[1,0]
    v_pk_mul_f32 v[146:147], v[140:141], v[128:129] op_sel:[1,1] op_sel_hi:[0,1] neg_lo:[1,0]
    v_pk_mul_f32 v[148:149], v[142:143], v[130:131] op_sel:[1,1] op_sel_hi:[0,1] neg_lo:[1,0]
    v_pk_fma_f32 v[138:139], v[138:139], v[126:127], v[144:145] op_sel_hi:[1,0,1]
    v_pk_fma_f32 v[140:141], v[140:141], v[128:129], v[146:147] op_sel_hi:[1,0,1]
    v_pk_fma_f32 v[142:143], v[142:143], v[130:131], v[148:149] op_sel_hi:[1,0,1]
    ds_write_b32 v156, v153 offset:800
    ds_write_b32 v156, v154 offset:1056
    ds_write_b32 v156, v155 offset:1312
    v_cvt_pk_bf16_f32 v150, v138, v139
    v_cvt_pk_bf16_f32 v151, v140, v141
    v_cvt_pk_bf16_f32 v152, v142, v143
    v_pk_mul_f32 v[144:145], v[138:139], v[126:127] op_sel:[1,1] op_sel_hi:[0,1] neg_lo:[1,0]
    v_pk_mul_f32 v[146:147], v[140:141], v[128:129] op_sel:[1,1] op_sel_hi:[0,1] neg_lo:[1,0]
    v_pk_mul_f32 v[148:149], v[142:143], v[130:131] op_sel:[1,1] op_sel_hi:[0,1] neg_lo:[1,0]
    v_pk_fma_f32 v[138:139], v[138:139], v[126:127], v[144:145] op_sel_hi:[1,0,1]
    v_pk_fma_f32 v[140:141], v[140:141], v[128:129], v[146:147] op_sel_hi:[1,0,1]
    v_pk_fma_f32 v[142:143], v[142:143], v[130:131], v[148:149] op_sel_hi:[1,0,1]
    ds_write_b32 v156, v150 offset:1600
    ds_write_b32 v156, v151 offset:1856
    ds_write_b32 v156, v152 offset:2112
    v_cvt_pk_bf16_f32 v153, v138, v139
    v_cvt_pk_bf16_f32 v154, v140, v141
    v_cvt_pk_bf16_f32 v155, v142, v143
    v_pk_mul_f32 v[144:145], v[138:139], v[126:127] op_sel:[1,1] op_sel_hi:[0,1] neg_lo:[1,0]
    v_pk_mul_f32 v[146:147], v[140:141], v[128:129] op_sel:[1,1] op_sel_hi:[0,1] neg_lo:[1,0]
    v_pk_mul_f32 v[148:149], v[142:143], v[130:131] op_sel:[1,1] op_sel_hi:[0,1] neg_lo:[1,0]
    v_pk_fma_f32 v[138:139], v[138:139], v[126:127], v[144:145] op_sel_hi:[1,0,1]
    v_pk_fma_f32 v[140:141], v[140:141], v[128:129], v[146:147] op_sel_hi:[1,0,1]
    v_pk_fma_f32 v[142:143], v[142:143], v[130:131], v[148:149] op_sel_hi:[1,0,1]
    ds_write_b32 v156, v153 offset:2400
    ds_write_b32 v156, v154 offset:2656
    ds_write_b32 v156, v155 offset:2912
    v_cvt_pk_bf16_f32 v150, v138, v139
    v_cvt_pk_bf16_f32 v151, v140, v141
    v_cvt_pk_bf16_f32 v152, v142, v143
    v_pk_mul_f32 v[144:145], v[138:139], v[126:127] op_sel:[1,1] op_sel_hi:[0,1] neg_lo:[1,0]
    v_pk_mul_f32 v[146:147], v[140:141], v[128:129] op_sel:[1,1] op_sel_hi:[0,1] neg_lo:[1,0]
    v_pk_mul_f32 v[148:149], v[142:143], v[130:131] op_sel:[1,1] op_sel_hi:[0,1] neg_lo:[1,0]
    v_pk_fma_f32 v[138:139], v[138:139], v[126:127], v[144:145] op_sel_hi:[1,0,1]
    v_pk_fma_f32 v[140:141], v[140:141], v[128:129], v[146:147] op_sel_hi:[1,0,1]
    v_pk_fma_f32 v[142:143], v[142:143], v[130:131], v[148:149] op_sel_hi:[1,0,1]
    ds_write_b32 v156, v150 offset:3200
    ds_write_b32 v156, v151 offset:3456
    ds_write_b32 v156, v152 offset:3712
    v_cvt_pk_bf16_f32 v153, v138, v139
    v_cvt_pk_bf16_f32 v154, v140, v141
    v_cvt_pk_bf16_f32 v155, v142, v143
    v_pk_mul_f32 v[144:145], v[138:139], v[126:127] op_sel:[1,1] op_sel_hi:[0,1] neg_lo:[1,0]
    v_pk_mul_f32 v[146:147], v[140:141], v[128:129] op_sel:[1,1] op_sel_hi:[0,1] neg_lo:[1,0]
    v_pk_mul_f32 v[148:149], v[142:143], v[130:131] op_sel:[1,1] op_sel_hi:[0,1] neg_lo:[1,0]
    v_pk_fma_f32 v[138:139], v[138:139], v[126:127], v[144:145] op_sel_hi:[1,0,1]
    v_pk_fma_f32 v[140:141], v[140:141], v[128:129], v[146:147] op_sel_hi:[1,0,1]
    v_pk_fma_f32 v[142:143], v[142:143], v[130:131], v[148:149] op_sel_hi:[1,0,1]
    ds_write_b32 v156, v153 offset:4000
    ds_write_b32 v156, v154 offset:4256
    ds_write_b32 v156, v155 offset:4512
    v_cvt_pk_bf16_f32 v150, v138, v139
    v_cvt_pk_bf16_f32 v151, v140, v141
    v_cvt_pk_bf16_f32 v152, v142, v143
    v_pk_mul_f32 v[144:145], v[138:139], v[126:127] op_sel:[1,1] op_sel_hi:[0,1] neg_lo:[1,0]
    v_pk_mul_f32 v[146:147], v[140:141], v[128:129] op_sel:[1,1] op_sel_hi:[0,1] neg_lo:[1,0]
    v_pk_mul_f32 v[148:149], v[142:143], v[130:131] op_sel:[1,1] op_sel_hi:[0,1] neg_lo:[1,0]
    v_pk_fma_f32 v[138:139], v[138:139], v[126:127], v[144:145] op_sel_hi:[1,0,1]
    v_pk_fma_f32 v[140:141], v[140:141], v[128:129], v[146:147] op_sel_hi:[1,0,1]
    v_pk_fma_f32 v[142:143], v[142:143], v[130:131], v[148:149] op_sel_hi:[1,0,1]
    ds_write_b32 v156, v150 offset:4800
    ds_write_b32 v156, v151 offset:5056
    ds_write_b32 v156, v152 offset:5312
    v_cvt_pk_bf16_f32 v153, v138, v139
    v_cvt_pk_bf16_f32 v154, v140, v141
    v_cvt_pk_bf16_f32 v155, v142, v143
    v_pk_mul_f32 v[144:145], v[138:139], v[126:127] op_sel:[1,1] op_sel_hi:[0,1] neg_lo:[1,0]
    v_pk_mul_f32 v[146:147], v[140:141], v[128:129] op_sel:[1,1] op_sel_hi:[0,1] neg_lo:[1,0]
    v_pk_mul_f32 v[148:149], v[142:143], v[130:131] op_sel:[1,1] op_sel_hi:[0,1] neg_lo:[1,0]
    v_pk_fma_f32 v[138:139], v[138:139], v[126:127], v[144:145] op_sel_hi:[1,0,1]
    v_pk_fma_f32 v[140:141], v[140:141], v[128:129], v[146:147] op_sel_hi:[1,0,1]
    v_pk_fma_f32 v[142:143], v[142:143], v[130:131], v[148:149] op_sel_hi:[1,0,1]
    ds_write_b32 v156, v153 offset:5600
    ds_write_b32 v156, v154 offset:5856
    ds_write_b32 v156, v155 offset:6112
    v_cvt_pk_bf16_f32 v150, v138, v139
    v_cvt_pk_bf16_f32 v151, v140, v141
    v_cvt_pk_bf16_f32 v152, v142, v143
    v_pk_mul_f32 v[144:145], v[138:139], v[126:127] op_sel:[1,1] op_sel_hi:[0,1] neg_lo:[1,0]
    v_pk_mul_f32 v[146:147], v[140:141], v[128:129] op_sel:[1,1] op_sel_hi:[0,1] neg_lo:[1,0]
    v_pk_mul_f32 v[148:149], v[142:143], v[130:131] op_sel:[1,1] op_sel_hi:[0,1] neg_lo:[1,0]
    v_pk_fma_f32 v[138:139], v[138:139], v[126:127], v[144:145] op_sel_hi:[1,0,1]
    v_pk_fma_f32 v[140:141], v[140:141], v[128:129], v[146:147] op_sel_hi:[1,0,1]
    v_pk_fma_f32 v[142:143], v[142:143], v[130:131], v[148:149] op_sel_hi:[1,0,1]
    ds_write_b32 v156, v150 offset:6400
    ds_write_b32 v156, v151 offset:6656
    ds_write_b32 v156, v152 offset:6912
    v_cvt_pk_bf16_f32 v153, v138, v139
    v_cvt_pk_bf16_f32 v154, v140, v141
    v_cvt_pk_bf16_f32 v155, v142, v143
    v_pk_mul_f32 v[144:145], v[138:139], v[126:127] op_sel:[1,1] op_sel_hi:[0,1] neg_lo:[1,0]
    v_pk_mul_f32 v[146:147], v[140:141], v[128:129] op_sel:[1,1] op_sel_hi:[0,1] neg_lo:[1,0]
    v_pk_mul_f32 v[148:149], v[142:143], v[130:131] op_sel:[1,1] op_sel_hi:[0,1] neg_lo:[1,0]
    v_pk_fma_f32 v[138:139], v[138:139], v[126:127], v[144:145] op_sel_hi:[1,0,1]
    v_pk_fma_f32 v[140:141], v[140:141], v[128:129], v[146:147] op_sel_hi:[1,0,1]
    v_pk_fma_f32 v[142:143], v[142:143], v[130:131], v[148:149] op_sel_hi:[1,0,1]
    ds_write_b32 v156, v153 offset:7200
    ds_write_b32 v156, v154 offset:7456
    ds_write_b32 v156, v155 offset:7712
    v_cvt_pk_bf16_f32 v150, v138, v139
    v_cvt_pk_bf16_f32 v151, v140, v141
    v_cvt_pk_bf16_f32 v152, v142, v143
    v_pk_mul_f32 v[144:145], v[138:139], v[126:127] op_sel:[1,1] op_sel_hi:[0,1] neg_lo:[1,0]
    v_pk_mul_f32 v[146:147], v[140:141], v[128:129] op_sel:[1,1] op_sel_hi:[0,1] neg_lo:[1,0]
    v_pk_mul_f32 v[148:149], v[142:143], v[130:131] op_sel:[1,1] op_sel_hi:[0,1] neg_lo:[1,0]
    v_pk_fma_f32 v[138:139], v[138:139], v[126:127], v[144:145] op_sel_hi:[1,0,1]
    v_pk_fma_f32 v[140:141], v[140:141], v[128:129], v[146:147] op_sel_hi:[1,0,1]
    v_pk_fma_f32 v[142:143], v[142:143], v[130:131], v[148:149] op_sel_hi:[1,0,1]
    ds_write_b32 v156, v150 offset:8000
    ds_write_b32 v156, v151 offset:8256
    ds_write_b32 v156, v152 offset:8512
    v_cvt_pk_bf16_f32 v153, v138, v139
    v_cvt_pk_bf16_f32 v154, v140, v141
    v_cvt_pk_bf16_f32 v155, v142, v143
    v_pk_mul_f32 v[144:145], v[138:139], v[126:127] op_sel:[1,1] op_sel_hi:[0,1] neg_lo:[1,0]
    v_pk_mul_f32 v[146:147], v[140:141], v[128:129] op_sel:[1,1] op_sel_hi:[0,1] neg_lo:[1,0]
    v_pk_mul_f32 v[148:149], v[142:143], v[130:131] op_sel:[1,1] op_sel_hi:[0,1] neg_lo:[1,0]
    v_pk_fma_f32 v[138:139], v[138:139], v[126:127], v[144:145] op_sel_hi:[1,0,1]
    v_pk_fma_f32 v[140:141], v[140:141], v[128:129], v[146:147] op_sel_hi:[1,0,1]
    v_pk_fma_f32 v[142:143], v[142:143], v[130:131], v[148:149] op_sel_hi:[1,0,1]
    ds_write_b32 v156, v153 offset:8800
    ds_write_b32 v156, v154 offset:9056
    ds_write_b32 v156, v155 offset:9312
    v_cvt_pk_bf16_f32 v150, v138, v139
    v_cvt_pk_bf16_f32 v151, v140, v141
    v_cvt_pk_bf16_f32 v152, v142, v143
    v_pk_mul_f32 v[144:145], v[138:139], v[126:127] op_sel:[1,1] op_sel_hi:[0,1] neg_lo:[1,0]
    v_pk_mul_f32 v[146:147], v[140:141], v[128:129] op_sel:[1,1] op_sel_hi:[0,1] neg_lo:[1,0]
    v_pk_mul_f32 v[148:149], v[142:143], v[130:131] op_sel:[1,1] op_sel_hi:[0,1] neg_lo:[1,0]
    v_pk_fma_f32 v[138:139], v[138:139], v[126:127], v[144:145] op_sel_hi:[1,0,1]
    v_pk_fma_f32 v[140:141], v[140:141], v[128:129], v[146:147] op_sel_hi:[1,0,1]
    v_pk_fma_f32 v[142:143], v[142:143], v[130:131], v[148:149] op_sel_hi:[1,0,1]
    ds_write_b32 v156, v150 offset:9600
    ds_write_b32 v156, v151 offset:9856
    ds_write_b32 v156, v152 offset:10112
    v_cvt_pk_bf16_f32 v153, v138, v139
    v_cvt_pk_bf16_f32 v154, v140, v141
    v_cvt_pk_bf16_f32 v155, v142, v143
    v_pk_mul_f32 v[144:145], v[138:139], v[126:127] op_sel:[1,1] op_sel_hi:[0,1] neg_lo:[1,0]
    v_pk_mul_f32 v[146:147], v[140:141], v[128:129] op_sel:[1,1] op_sel_hi:[0,1] neg_lo:[1,0]
    v_pk_mul_f32 v[148:149], v[142:143], v[130:131] op_sel:[1,1] op_sel_hi:[0,1] neg_lo:[1,0]
    v_pk_fma_f32 v[138:139], v[138:139], v[126:127], v[144:145] op_sel_hi:[1,0,1]
    v_pk_fma_f32 v[140:141], v[140:141], v[128:129], v[146:147] op_sel_hi:[1,0,1]
    v_pk_fma_f32 v[142:143], v[142:143], v[130:131], v[148:149] op_sel_hi:[1,0,1]
    ds_write_b32 v156, v153 offset:10400
    ds_write_b32 v156, v154 offset:10656
    ds_write_b32 v156, v155 offset:10912
    v_cvt_pk_bf16_f32 v150, v138, v139
    v_cvt_pk_bf16_f32 v151, v140, v141
    v_cvt_pk_bf16_f32 v152, v142, v143
    v_pk_mul_f32 v[144:145], v[138:139], v[126:127] op_sel:[1,1] op_sel_hi:[0,1] neg_lo:[1,0]
    v_pk_mul_f32 v[146:147], v[140:141], v[128:129] op_sel:[1,1] op_sel_hi:[0,1] neg_lo:[1,0]
    v_pk_mul_f32 v[148:149], v[142:143], v[130:131] op_sel:[1,1] op_sel_hi:[0,1] neg_lo:[1,0]
    v_pk_fma_f32 v[138:139], v[138:139], v[126:127], v[144:145] op_sel_hi:[1,0,1]
    v_pk_fma_f32 v[140:141], v[140:141], v[128:129], v[146:147] op_sel_hi:[1,0,1]
    v_pk_fma_f32 v[142:143], v[142:143], v[130:131], v[148:149] op_sel_hi:[1,0,1]
    ds_write_b32 v156, v150 offset:11200
    ds_write_b32 v156, v151 offset:11456
    ds_write_b32 v156, v152 offset:11712
    v_cvt_pk_bf16_f32 v153, v138, v139
    v_cvt_pk_bf16_f32 v154, v140, v141
    v_cvt_pk_bf16_f32 v155, v142, v143
    ds_write_b32 v156, v153 offset:12000
    ds_write_b32 v156, v154 offset:12256
    ds_write_b32 v156, v155 offset:12512
    s_branch L_GD
L_G2:
    s_waitcnt lgkmcnt(0)
    v_mul_f32 v144, 0x40000000, v120
    v_mul_f32 v147, 0x40000000, v123
    v_mul_f32 v145, 0x40000000, v121
    v_mul_f32 v148, 0x40000000, v124
    v_mul_f32 v146, 0x40000000, v122
    v_mul_f32 v149, 0x40000000, v125
    v_fract_f32 v147, v147
    v_exp_f32 v144, v144
    v_fract_f32 v148, v148
    v_exp_f32 v145, v145
    v_fract_f32 v149, v149
    v_exp_f32 v146, v146
    v_cos_f32 v126, v147
    v_sin_f32 v127, v147
    v_cos_f32 v128, v148
    v_sin_f32 v129, v148
    v_cos_f32 v130, v149
    v_sin_f32 v131, v149
    v_mul_f32 v126, v126, v144
    v_mul_f32 v127, v127, v144
    v_mul_f32 v128, v128, v145
    v_mul_f32 v129, v129, v145
    v_mul_f32 v130, v130, v146
    v_mul_f32 v131, v131, v146
    v_mul_f32 v144, 0x43800000, v120
    v_mul_f32 v147, 0x43800000, v123
    v_mul_f32 v145, 0x43800000, v121
    v_mul_f32 v148, 0x43800000, v124
    v_mul_f32 v146, 0x43800000, v122
    v_mul_f32 v149, 0x43800000, v125
    v_fract_f32 v147, v147
    v_exp_f32 v144, v144
    v_fract_f32 v148, v148
    v_exp_f32 v145, v145
    v_fract_f32 v149, v149
    v_exp_f32 v146, v146
    v_cos_f32 v132, v147
    v_sin_f32 v133, v147
    v_cos_f32 v134, v148
    v_sin_f32 v135, v148
    v_cos_f32 v136, v149
    v_sin_f32 v137, v149
    v_mul_f32 v132, v132, v144
    v_mul_f32 v133, v133, v144
    v_mul_f32 v134, v134, v145
    v_mul_f32 v135, v135, v145
    v_mul_f32 v136, v136, v146
    v_mul_f32 v137, v137, v146
.p2align 3
    v_cvt_pk_bf16_f32 v150, v132, v133
    v_cvt_pk_bf16_f32 v151, v134, v135
    v_cvt_pk_bf16_f32 v152, v136, v137
    v_pk_mul_f32 v[144:145], v[132:133], v[126:127] op_sel:[1,1] op_sel_hi:[0,1] neg_lo:[1,0]
    v_pk_mul_f32 v[146:147], v[134:135], v[128:129] op_sel:[1,1] op_sel_hi:[0,1] neg_lo:[1,0]
    v_pk_mul_f32 v[148:149], v[136:137], v[130:131] op_sel:[1,1] op_sel_hi:[0,1] neg_lo:[1,0]
    v_pk_fma_f32 v[138:139], v[132:133], v[126:127], v[144:145] op_sel_hi:[1,0,1]
    v_pk_fma_f32 v[140:141], v[134:135], v[128:129], v[146:147] op_sel_hi:[1,0,1]
    v_pk_fma_f32 v[142:143], v[136:137], v[130:131], v[148:149] op_sel_hi:[1,0,1]
    ds_write_b32 v34, v150 offset:25600
    ds_write_b32 v34, v151 offset:25856
    ds_write_b32 v34, v152 offset:26112
    v_cvt_pk_bf16_f32 v153, v138, v139
    v_cvt_pk_bf16_f32 v154, v140, v141
    v_cvt_pk_bf16_f32 v155, v142, v143
    v_pk_mul_f32 v[144:145], v[138:139], v[126:127] op_sel:[1,1] op_sel_hi:[0,1] neg_lo:[1,0]
    v_pk_mul_f32 v[146:147], v[140:141], v[128:129] op_sel:[1,1] op_sel_hi:[0,1] neg_lo:[1,0]
    v_pk_mul_f32 v[148:149], v[142:143], v[130:131] op_sel:[1,1] op_sel_hi:[0,1] neg_lo:[1,0]
    v_pk_fma_f32 v[138:139], v[138:139], v[126:127], v[144:145] op_sel_hi:[1,0,1]
    v_pk_fma_f32 v[140:141], v[140:141], v[128:129], v[146:147] op_sel_hi:[1,0,1]
    v_pk_fma_f32 v[142:143], v[142:143], v[130:131], v[148:149] op_sel_hi:[1,0,1]
    ds_write_b32 v34, v153 offset:26400
    ds_write_b32 v34, v154 offset:26656
    ds_write_b32 v34, v155 offset:26912
    v_cvt_pk_bf16_f32 v150, v138, v139
    v_cvt_pk_bf16_f32 v151, v140, v141
    v_cvt_pk_bf16_f32 v152, v142, v143
    v_pk_mul_f32 v[144:145], v[138:139], v[126:127] op_sel:[1,1] op_sel_hi:[0,1] neg_lo:[1,0]
    v_pk_mul_f32 v[146:147], v[140:141], v[128:129] op_sel:[1,1] op_sel_hi:[0,1] neg_lo:[1,0]
    v_pk_mul_f32 v[148:149], v[142:143], v[130:131] op_sel:[1,1] op_sel_hi:[0,1] neg_lo:[1,0]
    v_pk_fma_f32 v[138:139], v[138:139], v[126:127], v[144:145] op_sel_hi:[1,0,1]
    v_pk_fma_f32 v[140:141], v[140:141], v[128:129], v[146:147] op_sel_hi:[1,0,1]
    v_pk_fma_f32 v[142:143], v[142:143], v[130:131], v[148:149] op_sel_hi:[1,0,1]
    ds_write_b32 v34, v150 offset:27200
    ds_write_b32 v34, v151 offset:27456
    ds_write_b32 v34, v152 offset:27712
    v_cvt_pk_bf16_f32 v153, v138, v139
    v_cvt_pk_bf16_f32 v154, v140, v141
    v_cvt_pk_bf16_f32 v155, v142, v143
    v_pk_mul_f32 v[144:145], v[138:139], v[126:127] op_sel:[1,1] op_sel_hi:[0,1] neg_lo:[1,0]
    v_pk_mul_f32 v[146:147], v[140:141], v[128:129] op_sel:[1,1] op_sel_hi:[0,1] neg_lo:[1,0]
    v_pk_mul_f32 v[148:149], v[142:143], v[130:131] op_sel:[1,1] op_sel_hi:[0,1] neg_lo:[1,0]
    v_pk_fma_f32 v[138:139], v[138:139], v[126:127], v[144:145] op_sel_hi:[1,0,1]
    v_pk_fma_f32 v[140:141], v[140:141], v[128:129], v[146:147] op_sel_hi:[1,0,1]
    v_pk_fma_f32 v[142:143], v[142:143], v[130:131], v[148:149] op_sel_hi:[1,0,1]
    ds_write_b32 v34, v153 offset:28000
    ds_write_b32 v34, v154 offset:28256
    ds_write_b32 v34, v155 offset:28512
    v_cvt_pk_bf16_f32 v150, v138, v139
    v_cvt_pk_bf16_f32 v151, v140, v141
    v_cvt_pk_bf16_f32 v152, v142, v143
    v_pk_mul_f32 v[144:145], v[138:139], v[126:127] op_sel:[1,1] op_sel_hi:[0,1] neg_lo:[1,0]
    v_pk_mul_f32 v[146:147], v[140:141], v[128:129] op_sel:[1,1] op_sel_hi:[0,1] neg_lo:[1,0]
    v_pk_mul_f32 v[148:149], v[142:143], v[130:131] op_sel:[1,1] op_sel_hi:[0,1] neg_lo:[1,0]
    v_pk_fma_f32 v[138:139], v[138:139], v[126:127], v[144:145] op_sel_hi:[1,0,1]
    v_pk_fma_f32 v[140:141], v[140:141], v[128:129], v[146:147] op_sel_hi:[1,0,1]
    v_pk_fma_f32 v[142:143], v[142:143], v[130:131], v[148:149] op_sel_hi:[1,0,1]
    ds_write_b32 v34, v150 offset:28800
    ds_write_b32 v34, v151 offset:29056
    ds_write_b32 v34, v152 offset:29312
    v_cvt_pk_bf16_f32 v153, v138, v139
    v_cvt_pk_bf16_f32 v154, v140, v141
    v_cvt_pk_bf16_f32 v155, v142, v143
    v_pk_mul_f32 v[144:145], v[138:139], v[126:127] op_sel:[1,1] op_sel_hi:[0,1] neg_lo:[1,0]
    v_pk_mul_f32 v[146:147], v[140:141], v[128:129] op_sel:[1,1] op_sel_hi:[0,1] neg_lo:[1,0]
    v_pk_mul_f32 v[148:149], v[142:143], v[130:131] op_sel:[1,1] op_sel_hi:[0,1] neg_lo:[1,0]
    v_pk_fma_f32 v[138:139], v[138:139], v[126:127], v[144:145] op_sel_hi:[1,0,1]
    v_pk_fma_f32 v[140:141], v[140:141], v[128:129], v[146:147] op_sel_hi:[1,0,1]
    v_pk_fma_f32 v[142:143], v[142:143], v[130:131], v[148:149] op_sel_hi:[1,0,1]
    ds_write_b32 v34, v153 offset:29600
    ds_write_b32 v34, v154 offset:29856
    ds_write_b32 v34, v155 offset:30112
    v_cvt_pk_bf16_f32 v150, v138, v139
    v_cvt_pk_bf16_f32 v151, v140, v141
    v_cvt_pk_bf16_f32 v152, v142, v143
    v_pk_mul_f32 v[144:145], v[138:139], v[126:127] op_sel:[1,1] op_sel_hi:[0,1] neg_lo:[1,0]
    v_pk_mul_f32 v[146:147], v[140:141], v[128:129] op_sel:[1,1] op_sel_hi:[0,1] neg_lo:[1,0]
    v_pk_mul_f32 v[148:149], v[142:143], v[130:131] op_sel:[1,1] op_sel_hi:[0,1] neg_lo:[1,0]
    v_pk_fma_f32 v[138:139], v[138:139], v[126:127], v[144:145] op_sel_hi:[1,0,1]
    v_pk_fma_f32 v[140:141], v[140:141], v[128:129], v[146:147] op_sel_hi:[1,0,1]
    v_pk_fma_f32 v[142:143], v[142:143], v[130:131], v[148:149] op_sel_hi:[1,0,1]
    ds_write_b32 v34, v150 offset:30400
    ds_write_b32 v34, v151 offset:30656
    ds_write_b32 v34, v152 offset:30912
    v_cvt_pk_bf16_f32 v153, v138, v139
    v_cvt_pk_bf16_f32 v154, v140, v141
    v_cvt_pk_bf16_f32 v155, v142, v143
    ds_write_b32 v34, v153 offset:31200
    ds_write_b32 v34, v154 offset:31456
    ds_write_b32 v34, v155 offset:31712
    v_pk_mul_f32 v[144:145], v[126:127], v[126:127] op_sel:[1,1] op_sel_hi:[0,1] neg_lo:[1,0]
    v_pk_mul_f32 v[146:147], v[128:129], v[128:129] op_sel:[1,1] op_sel_hi:[0,1] neg_lo:[1,0]
    v_pk_mul_f32 v[148:149], v[130:131], v[130:131] op_sel:[1,1] op_sel_hi:[0,1] neg_lo:[1,0]
    v_pk_fma_f32 v[126:127], v[126:127], v[126:127], v[144:145] op_sel_hi:[1,0,1]
    v_pk_fma_f32 v[128:129], v[128:129], v[128:129], v[146:147] op_sel_hi:[1,0,1]
    v_pk_fma_f32 v[130:131], v[130:131], v[130:131], v[148:149] op_sel_hi:[1,0,1]
    v_pk_mul_f32 v[144:145], v[132:133], v[132:133] op_sel:[1,1] op_sel_hi:[0,1] neg_lo:[1,0]
    v_pk_mul_f32 v[146:147], v[134:135], v[134:135] op_sel:[1,1] op_sel_hi:[0,1] neg_lo:[1,0]
    v_pk_mul_f32 v[148:149], v[136:137], v[136:137] op_sel:[1,1] op_sel_hi:[0,1] neg_lo:[1,0]
    v_pk_fma_f32 v[160:161], v[132:133], v[132:133], v[144:145] op_sel_hi:[1,0,1]
    v_pk_fma_f32 v[162:163], v[134:135], v[134:135], v[146:147] op_sel_hi:[1,0,1]
    v_pk_fma_f32 v[164:165], v[136:137], v[136:137], v[148:149] op_sel_hi:[1,0,1]
.p2align 3
    v_cvt_pk_bf16_f32 v150, v160, v161
    v_cvt_pk_bf16_f32 v151, v162, v163
    v_cvt_pk_bf16_f32 v152, v164, v165
    v_pk_mul_f32 v[144:145], v[160:161], v[126:127] op_sel:[1,1] op_sel_hi:[0,1] neg_lo:[1,0]
    v_pk_mul_f32 v[146:147], v[162:163], v[128:129] op_sel:[1,1] op_sel_hi:[0,1] neg_lo:[1,0]
    v_pk_mul_f32 v[148:149], v[164:165], v[130:131] op_sel:[1,1] op_sel_hi:[0,1] neg_lo:[1,0]
    v_pk_fma_f32 v[138:139], v[160:161], v[126:127], v[144:145] op_sel_hi:[1,0,1]
    v_pk_fma_f32 v[140:141], v[162:163], v[128:129], v[146:147] op_sel_hi:[1,0,1]
    v_pk_fma_f32 v[142:143], v[164:165], v[130:131], v[148:149] op_sel_hi:[1,0,1]
    ds_write_b32 v34, v150 offset:32000
    ds_write_b32 v34, v151 offset:32256
    ds_write_b32 v34, v152 offset:32512
    v_cvt_pk_bf16_f32 v153, v138, v139
    v_cvt_pk_bf16_f32 v154, v140, v141
    v_cvt_pk_bf16_f32 v155, v142, v143
    v_pk_mul_f32 v[144:145], v[138:139], v[126:127] op_sel:[1,1] op_sel_hi:[0,1] neg_lo:[1,0]
    v_pk_mul_f32 v[146:147], v[140:141], v[128:129] op_sel:[1,1] op_sel_hi:[0,1] neg_lo:[1,0]
    v_pk_mul_f32 v[148:149], v[142:143], v[130:131] op_sel:[1,1] op_sel_hi:[0,1] neg_lo:[1,0]
    v_pk_fma_f32 v[138:139], v[138:139], v[126:127], v[144:145] op_sel_hi:[1,0,1]
    v_pk_fma_f32 v[140:141], v[140:141], v[128:129], v[146:147] op_sel_hi:[1,0,1]
    v_pk_fma_f32 v[142:143], v[142:143], v[130:131], v[148:149] op_sel_hi:[1,0,1]
    ds_write_b32 v34, v153 offset:32800
    ds_write_b32 v34, v154 offset:33056
    ds_write_b32 v34, v155 offset:33312
    v_cvt_pk_bf16_f32 v150, v138, v139
    v_cvt_pk_bf16_f32 v151, v140, v141
    v_cvt_pk_bf16_f32 v152, v142, v143
    v_pk_mul_f32 v[144:145], v[138:139], v[126:127] op_sel:[1,1] op_sel_hi:[0,1] neg_lo:[1,0]
    v_pk_mul_f32 v[146:147], v[140:141], v[128:129] op_sel:[1,1] op_sel_hi:[0,1] neg_lo:[1,0]
    v_pk_mul_f32 v[148:149], v[142:143], v[130:131] op_sel:[1,1] op_sel_hi:[0,1] neg_lo:[1,0]
    v_pk_fma_f32 v[138:139], v[138:139], v[126:127], v[144:145] op_sel_hi:[1,0,1]
    v_pk_fma_f32 v[140:141], v[140:141], v[128:129], v[146:147] op_sel_hi:[1,0,1]
    v_pk_fma_f32 v[142:143], v[142:143], v[130:131], v[148:149] op_sel_hi:[1,0,1]
    ds_write_b32 v34, v150 offset:33600
    ds_write_b32 v34, v151 offset:33856
    ds_write_b32 v34, v152 offset:34112
    v_cvt_pk_bf16_f32 v153, v138, v139
    v_cvt_pk_bf16_f32 v154, v140, v141
    v_cvt_pk_bf16_f32 v155, v142, v143
    ds_write_b32 v34, v153 offset:34400
    ds_write_b32 v34, v154 offset:34656
    ds_write_b32 v34, v155 offset:34912
    v_pk_mul_f32 v[144:145], v[160:161], v[132:133] op_sel:[1,1] op_sel_hi:[0,1] neg_lo:[1,0]
    v_pk_mul_f32 v[146:147], v[162:163], v[134:135] op_sel:[1,1] op_sel_hi:[0,1] neg_lo:[1,0]
    v_pk_mul_f32 v[148:149], v[164:165], v[136:137] op_sel:[1,1] op_sel_hi:[0,1] neg_lo:[1,0]
    v_pk_fma_f32 v[160:161], v[160:161], v[132:133], v[144:145] op_sel_hi:[1,0,1]
    v_pk_fma_f32 v[162:163], v[162:163], v[134:135], v[146:147] op_sel_hi:[1,0,1]
    v_pk_fma_f32 v[164:165], v[164:165], v[136:137], v[148:149] op_sel_hi:[1,0,1]
.p2align 3
    v_cvt_pk_bf16_f32 v150, v160, v161
    v_cvt_pk_bf16_f32 v151, v162, v163
    v_cvt_pk_bf16_f32 v152, v164, v165
    v_pk_mul_f32 v[144:145], v[160:161], v[126:127] op_sel:[1,1] op_sel_hi:[0,1] neg_lo:[1,0]
    v_pk_mul_f32 v[146:147], v[162:163], v[128:129] op_sel:[1,1] op_sel_hi:[0,1] neg_lo:[1,0]
    v_pk_mul_f32 v[148:149], v[164:165], v[130:131] op_sel:[1,1] op_sel_hi:[0,1] neg_lo:[1,0]
    v_pk_fma_f32 v[138:139], v[160:161], v[126:127], v[144:145] op_sel_hi:[1,0,1]
    v_pk_fma_f32 v[140:141], v[162:163], v[128:129], v[146:147] op_sel_hi:[1,0,1]
    v_pk_fma_f32 v[142:143], v[164:165], v[130:131], v[148:149] op_sel_hi:[1,0,1]
    ds_write_b32 v34, v150 offset:35200
    ds_write_b32 v34, v151 offset:35456
    ds_write_b32 v34, v152 offset:35712
    v_cvt_pk_bf16_f32 v153, v138, v139
    v_cvt_pk_bf16_f32 v154, v140, v141
    v_cvt_pk_bf16_f32 v155, v142, v143
    v_pk_mul_f32 v[144:145], v[138:139], v[126:127] op_sel:[1,1] op_sel_hi:[0,1] neg_lo:[1,0]
    v_pk_mul_f32 v[146:147], v[140:141], v[128:129] op_sel:[1,1] op_sel_hi:[0,1] neg_lo:[1,0]
    v_pk_mul_f32 v[148:149], v[142:143], v[130:131] op_sel:[1,1] op_sel_hi:[0,1] neg_lo:[1,0]
    v_pk_fma_f32 v[138:139], v[138:139], v[126:127], v[144:145] op_sel_hi:[1,0,1]
    v_pk_fma_f32 v[140:141], v[140:141], v[128:129], v[146:147] op_sel_hi:[1,0,1]
    v_pk_fma_f32 v[142:143], v[142:143], v[130:131], v[148:149] op_sel_hi:[1,0,1]
    ds_write_b32 v34, v153 offset:36000
    ds_write_b32 v34, v154 offset:36256
    ds_write_b32 v34, v155 offset:36512
    v_cvt_pk_bf16_f32 v150, v138, v139
    v_cvt_pk_bf16_f32 v151, v140, v141
    v_cvt_pk_bf16_f32 v152, v142, v143
    v_pk_mul_f32 v[144:145], v[138:139], v[126:127] op_sel:[1,1] op_sel_hi:[0,1] neg_lo:[1,0]
    v_pk_mul_f32 v[146:147], v[140:141], v[128:129] op_sel:[1,1] op_sel_hi:[0,1] neg_lo:[1,0]
    v_pk_mul_f32 v[148:149], v[142:143], v[130:131] op_sel:[1,1] op_sel_hi:[0,1] neg_lo:[1,0]
    v_pk_fma_f32 v[138:139], v[138:139], v[126:127], v[144:145] op_sel_hi:[1,0,1]
    v_pk_fma_f32 v[140:141], v[140:141], v[128:129], v[146:147] op_sel_hi:[1,0,1]
    v_pk_fma_f32 v[142:143], v[142:143], v[130:131], v[148:149] op_sel_hi:[1,0,1]
    ds_write_b32 v34, v150 offset:36800
    ds_write_b32 v34, v151 offset:37056
    ds_write_b32 v34, v152 offset:37312
    v_cvt_pk_bf16_f32 v153, v138, v139
    v_cvt_pk_bf16_f32 v154, v140, v141
    v_cvt_pk_bf16_f32 v155, v142, v143
    ds_write_b32 v34, v153 offset:37600
    ds_write_b32 v34, v154 offset:37856
    ds_write_b32 v34, v155 offset:38112
    s_branch L_GD
L_G3:
    s_waitcnt lgkmcnt(0)
    v_mul_f32 v144, 0x43800000, v120
    v_mul_f32 v147, 0x43800000, v123
    v_mul_f32 v145, 0x43800000, v121
    v_mul_f32 v148, 0x43800000, v124
    v_mul_f32 v146, 0x43800000, v122
    v_mul_f32 v149, 0x43800000, v125
    v_fract_f32 v147, v147
    v_exp_f32 v144, v144
    v_fract_f32 v148, v148
    v_exp_f32 v145, v145
    v_fract_f32 v149, v149
    v_exp_f32 v146, v146
    v_cos_f32 v126, v147
    v_sin_f32 v127, v147
    v_cos_f32 v128, v148
    v_sin_f32 v129, v148
    v_cos_f32 v130, v149
    v_sin_f32 v131, v149
    v_mul_f32 v126, v126, v144
    v_mul_f32 v127, v127, v144
    v_mul_f32 v128, v128, v145
    v_mul_f32 v129, v129, v145
    v_mul_f32 v130, v130, v146
    v_mul_f32 v131, v131, v146
    v_mul_f32 v144, 0x41000000, v120
    v_mul_f32 v147, 0x41000000, v123
    v_mul_f32 v145, 0x41000000, v121
    v_mul_f32 v148, 0x41000000, v124
    v_mul_f32 v146, 0x41000000, v122
    v_mul_f32 v149, 0x41000000, v125
    v_fract_f32 v147, v147
    v_exp_f32 v144, v144
    v_fract_f32 v148, v148
    v_exp_f32 v145, v145
    v_fract_f32 v149, v149
    v_exp_f32 v146, v146
    v_cos_f32 v132, v147
    v_sin_f32 v133, v147
    v_cos_f32 v134, v148
    v_sin_f32 v135, v148
    v_cos_f32 v136, v149
    v_sin_f32 v137, v149
    v_mul_f32 v132, v132, v144
    v_mul_f32 v133, v133, v144
    v_mul_f32 v134, v134, v145
    v_mul_f32 v135, v135, v145
    v_mul_f32 v136, v136, v146
    v_mul_f32 v137, v137, v146
    v_pk_mul_f32 v[144:145], v[126:127], v[126:127] op_sel:[1,1] op_sel_hi:[0,1] neg_lo:[1,0]
    v_pk_mul_f32 v[146:147], v[128:129], v[128:129] op_sel:[1,1] op_sel_hi:[0,1] neg_lo:[1,0]
    v_pk_mul_f32 v[148:149], v[130:131], v[130:131] op_sel:[1,1] op_sel_hi:[0,1] neg_lo:[1,0]
    v_pk_fma_f32 v[160:161], v[126:127], v[126:127], v[144:145] op_sel_hi:[1,0,1]
    v_pk_fma_f32 v[162:163], v[128:129], v[128:129], v[146:147] op_sel_hi:[1,0,1]
    v_pk_fma_f32 v[164:165], v[130:131], v[130:131], v[148:149] op_sel_hi:[1,0,1]
    v_pk_mul_f32 v[144:145], v[160:161], v[160:161] op_sel:[1,1] op_sel_hi:[0,1] neg_lo:[1,0]
    v_pk_mul_f32 v[146:147], v[162:163], v[162:163] op_sel:[1,1] op_sel_hi:[0,1] neg_lo:[1,0]
    v_pk_mul_f32 v[148:149], v[164:165], v[164:165] op_sel:[1,1] op_sel_hi:[0,1] neg_lo:[1,0]
    v_pk_fma_f32 v[160:161], v[160:161], v[160:161], v[144:145] op_sel_hi:[1,0,1]
    v_pk_fma_f32 v[162:163], v[162:163], v[162:163], v[146:147] op_sel_hi:[1,0,1]
    v_pk_fma_f32 v[164:165], v[164:165], v[164:165], v[148:149] op_sel_hi:[1,0,1]
    v_pk_mul_f32 v[144:145], v[160:161], v[132:133] op_sel:[1,1] op_sel_hi:[0,1] neg_lo:[1,0]
    v_pk_mul_f32 v[146:147], v[162:163], v[134:135] op_sel:[1,1] op_sel_hi:[0,1] neg_lo:[1,0]
    v_pk_mul_f32 v[148:149], v[164:165], v[136:137] op_sel:[1,1] op_sel_hi:[0,1] neg_lo:[1,0]
    v_pk_fma_f32 v[166:167], v[160:161], v[132:133], v[144:145] op_sel_hi:[1,0,1]
    v_pk_fma_f32 v[168:169], v[162:163], v[134:135], v[146:147] op_sel_hi:[1,0,1]
    v_pk_fma_f32 v[170:171], v[164:165], v[136:137], v[148:149] op_sel_hi:[1,0,1]
    s_cmp_lg_u32 s27, 2
    s_cbranch_scc1 L_NLK
    s_and_b32 s39, s2, 7
    s_lshl_b32 s39, s39, 13
    s_add_u32 s39, s39, 14680064
    v_lshlrev_b32 v21, 7, v1
    buffer_load_dwordx4 v[56:59], v21, s[40:43], s39 offen sc1
L_NLK:
.p2align 3
    v_cvt_pk_bf16_f32 v150, v166, v167
    v_cvt_pk_bf16_f32 v151, v168, v169
    v_cvt_pk_bf16_f32 v152, v170, v171
    v_pk_mul_f32 v[144:145], v[166:167], v[126:127] op_sel:[1,1] op_sel_hi:[0,1] neg_lo:[1,0]
    v_pk_mul_f32 v[146:147], v[168:169], v[128:129] op_sel:[1,1] op_sel_hi:[0,1] neg_lo:[1,0]
    v_pk_mul_f32 v[148:149], v[170:171], v[130:131] op_sel:[1,1] op_sel_hi:[0,1] neg_lo:[1,0]
    v_pk_fma_f32 v[138:139], v[166:167], v[126:127], v[144:145] op_sel_hi:[1,0,1]
    v_pk_fma_f32 v[140:141], v[168:169], v[128:129], v[146:147] op_sel_hi:[1,0,1]
    v_pk_fma_f32 v[142:143], v[170:171], v[130:131], v[148:149] op_sel_hi:[1,0,1]
    ds_write_b32 v34, v150 offset:39200
    ds_write_b32 v34, v151 offset:39456
    ds_write_b32 v34, v152 offset:39712
    v_cvt_pk_bf16_f32 v153, v138, v139
    v_cvt_pk_bf16_f32 v154, v140, v141
    v_cvt_pk_bf16_f32 v155, v142, v143
    v_pk_mul_f32 v[144:145], v[138:139], v[126:127] op_sel:[1,1] op_sel_hi:[0,1] neg_lo:[1,0]
    v_pk_mul_f32 v[146:147], v[140:141], v[128:129] op_sel:[1,1] op_sel_hi:[0,1] neg_lo:[1,0]
    v_pk_mul_f32 v[148:149], v[142:143], v[130:131] op_sel:[1,1] op_sel_hi:[0,1] neg_lo:[1,0]
    v_pk_fma_f32 v[138:139], v[138:139], v[126:127], v[144:145] op_sel_hi:[1,0,1]
    v_pk_fma_f32 v[140:141], v[140:141], v[128:129], v[146:147] op_sel_hi:[1,0,1]
    v_pk_fma_f32 v[142:143], v[142:143], v[130:131], v[148:149] op_sel_hi:[1,0,1]
    ds_write_b32 v34, v153 offset:40800
    ds_write_b32 v34, v154 offset:41056
    ds_write_b32 v34, v155 offset:41312
    v_cvt_pk_bf16_f32 v150, v138, v139
    v_cvt_pk_bf16_f32 v151, v140, v141
    v_cvt_pk_bf16_f32 v152, v142, v143
    v_pk_mul_f32 v[144:145], v[138:139], v[126:127] op_sel:[1,1] op_sel_hi:[0,1] neg_lo:[1,0]
    v_pk_mul_f32 v[146:147], v[140:141], v[128:129] op_sel:[1,1] op_sel_hi:[0,1] neg_lo:[1,0]
    v_pk_mul_f32 v[148:149], v[142:143], v[130:131] op_sel:[1,1] op_sel_hi:[0,1] neg_lo:[1,0]
    v_pk_fma_f32 v[138:139], v[138:139], v[126:127], v[144:145] op_sel_hi:[1,0,1]
    v_pk_fma_f32 v[140:141], v[140:141], v[128:129], v[146:147] op_sel_hi:[1,0,1]
    v_pk_fma_f32 v[142:143], v[142:143], v[130:131], v[148:149] op_sel_hi:[1,0,1]
    ds_write_b32 v34, v150 offset:42400
    ds_write_b32 v34, v151 offset:42656
    ds_write_b32 v34, v152 offset:42912
    v_cvt_pk_bf16_f32 v153, v138, v139
    v_cvt_pk_bf16_f32 v154, v140, v141
    v_cvt_pk_bf16_f32 v155, v142, v143
    ds_write_b32 v34, v153 offset:44000
    ds_write_b32 v34, v154 offset:44256
    ds_write_b32 v34, v155 offset:44512
.p2align 3
    v_cvt_pk_bf16_f32 v150, v160, v161
    v_cvt_pk_bf16_f32 v151, v162, v163
    v_cvt_pk_bf16_f32 v152, v164, v165
    v_pk_mul_f32 v[144:145], v[160:161], v[126:127] op_sel:[1,1] op_sel_hi:[0,1] neg_lo:[1,0]
    v_pk_mul_f32 v[146:147], v[162:163], v[128:129] op_sel:[1,1] op_sel_hi:[0,1] neg_lo:[1,0]
    v_pk_mul_f32 v[148:149], v[164:165], v[130:131] op_sel:[1,1] op_sel_hi:[0,1] neg_lo:[1,0]
    v_pk_fma_f32 v[138:139], v[160:161], v[126:127], v[144:145] op_sel_hi:[1,0,1]
    v_pk_fma_f32 v[140:141], v[162:163], v[128:129], v[146:147] op_sel_hi:[1,0,1]
    v_pk_fma_f32 v[142:143], v[164:165], v[130:131], v[148:149] op_sel_hi:[1,0,1]
    ds_write_b32 v34, v150 offset:38400
    ds_write_b32 v34, v151 offset:38656
    ds_write_b32 v34, v152 offset:38912
    v_cvt_pk_bf16_f32 v153, v138, v139
    v_cvt_pk_bf16_f32 v154, v140, v141
    v_cvt_pk_bf16_f32 v155, v142, v143
    v_pk_mul_f32 v[144:145], v[138:139], v[126:127] op_sel:[1,1] op_sel_hi:[0,1] neg_lo:[1,0]
    v_pk_mul_f32 v[146:147], v[140:141], v[128:129] op_sel:[1,1] op_sel_hi:[0,1] neg_lo:[1,0]
    v_pk_mul_f32 v[148:149], v[142:143], v[130:131] op_sel:[1,1] op_sel_hi:[0,1] neg_lo:[1,0]
    v_pk_fma_f32 v[138:139], v[138:139], v[126:127], v[144:145] op_sel_hi:[1,0,1]
    v_pk_fma_f32 v[140:141], v[140:141], v[128:129], v[146:147] op_sel_hi:[1,0,1]
    v_pk_fma_f32 v[142:143], v[142:143], v[130:131], v[148:149] op_sel_hi:[1,0,1]
    ds_write_b32 v34, v153 offset:40000
    ds_write_b32 v34, v154 offset:40256
    ds_write_b32 v34, v155 offset:40512
    v_cvt_pk_bf16_f32 v150, v138, v139
    v_cvt_pk_bf16_f32 v151, v140, v141
    v_cvt_pk_bf16_f32 v152, v142, v143
    v_pk_mul_f32 v[144:145], v[138:139], v[126:127] op_sel:[1,1] op_sel_hi:[0,1] neg_lo:[1,0]
    v_pk_mul_f32 v[146:147], v[140:141], v[128:129] op_sel:[1,1] op_sel_hi:[0,1] neg_lo:[1,0]
    v_pk_mul_f32 v[148:149], v[142:143], v[130:131] op_sel:[1,1] op_sel_hi:[0,1] neg_lo:[1,0]
    v_pk_fma_f32 v[138:139], v[138:139], v[126:127], v[144:145] op_sel_hi:[1,0,1]
    v_pk_fma_f32 v[140:141], v[140:141], v[128:129], v[146:147] op_sel_hi:[1,0,1]
    v_pk_fma_f32 v[142:143], v[142:143], v[130:131], v[148:149] op_sel_hi:[1,0,1]
    ds_write_b32 v34, v150 offset:41600
    ds_write_b32 v34, v151 offset:41856
    ds_write_b32 v34, v152 offset:42112
    v_cvt_pk_bf16_f32 v153, v138, v139
    v_cvt_pk_bf16_f32 v154, v140, v141
    v_cvt_pk_bf16_f32 v155, v142, v143
    v_pk_mul_f32 v[144:145], v[138:139], v[126:127] op_sel:[1,1] op_sel_hi:[0,1] neg_lo:[1,0]
    v_pk_mul_f32 v[146:147], v[140:141], v[128:129] op_sel:[1,1] op_sel_hi:[0,1] neg_lo:[1,0]
    v_pk_mul_f32 v[148:149], v[142:143], v[130:131] op_sel:[1,1] op_sel_hi:[0,1] neg_lo:[1,0]
    v_pk_fma_f32 v[138:139], v[138:139], v[126:127], v[144:145] op_sel_hi:[1,0,1]
    v_pk_fma_f32 v[140:141], v[140:141], v[128:129], v[146:147] op_sel_hi:[1,0,1]
    v_pk_fma_f32 v[142:143], v[142:143], v[130:131], v[148:149] op_sel_hi:[1,0,1]
    ds_write_b32 v34, v153 offset:43200
    ds_write_b32 v34, v154 offset:43456
    ds_write_b32 v34, v155 offset:43712
    v_cvt_pk_bf16_f32 v150, v138, v139
    v_cvt_pk_bf16_f32 v151, v140, v141
    v_cvt_pk_bf16_f32 v152, v142, v143
    ds_write_b32 v34, v150 offset:44800
    ds_write_b32 v34, v151 offset:45056
    ds_write_b32 v34, v152 offset:45312
    s_cmp_lg_u32 s27, 2
    s_cbranch_scc1 L_GD
    s_waitcnt vmcnt(0)
    v_subrev_u32 v56, s38, v56
    v_subrev_u32 v57, s38, v57
    v_subrev_u32 v58, s38, v58
    v_subrev_u32 v59, s38, v59
    v_or3_b32 v56, v56, v57, v58
    v_or_b32 v56, v56, v59
    v_cmp_lt_u32 vcc, 0, v56
    s_cbranch_vccz L_PDA0
    s_mov_b32 s59, 0
L_PLA0:
    s_and_b32 s39, s2, 7
    s_lshl_b32 s39, s39, 13
    s_add_u32 s39, s39, 14680064
    v_lshlrev_b32 v21, 7, v1
    buffer_load_dwordx4 v[56:59], v21, s[40:43], s39 offen sc1
    s_add_u32 s59, s59, 1
    s_cmp_gt_u32 s59, 0x100000
    s_waitcnt vmcnt(0)
    s_cbranch_scc1 L_PDA0
    v_subrev_u32 v56, s38, v56
    v_subrev_u32 v57, s38, v57
    v_subrev_u32 v58, s38, v58
    v_subrev_u32 v59, s38, v59
    v_or3_b32 v56, v56, v57, v58
    v_or_b32 v56, v56, v59
    v_cmp_lt_u32 vcc, 0, v56
    s_cbranch_vccnz L_PLA0
L_PDA0:
L_GD:
    v_add_u32 v34, 45824, v34
    v_add_u32 v35, 768, v35
    s_add_u32 s27, s27, 1
    s_cmp_lg_u32 s27, 3
    s_cbranch_scc1 L_GEN
    s_cmp_eq_u32 s52, 3
    s_cbranch_scc1 L_GW
    s_waitcnt vmcnt(1)
L_GW:
    s_waitcnt lgkmcnt(0)
    s_barrier
    s_mov_b32 s39, 65536
    s_mov_b32 s59, 73728
    v_add_u32 v5, 4096, v27
    buffer_load_dwordx4 v[228:231], v27, s[40:43], s39 offen sc1
    buffer_load_dwordx4 v[232:235], v5, s[40:43], s39 offen sc1
    buffer_load_dwordx4 v[236:239], v27, s[40:43], s59 offen sc1
    buffer_load_dwordx4 v[240:243], v5, s[40:43], s59 offen sc1
    s_cmp_lt_u32 s52, s56
    s_cbranch_scc1 L_MF
    s_cmp_lg_u32 s52, 2
    s_cbranch_scc1 L_M3
    s_sub_u32 s4, s4, 2
    s_mov_b32 s26, 0
L_M2L:
    s_cmp_ge_u32 s4, 680
    s_cbranch_scc1 L_SJEm
    s_cmp_ge_u32 s4, 100
    s_cbranch_scc1 L_Pjm1
    s_sub_u32 s6, s4, 0
    s_mul_i32 s5, s6, 13108
    s_lshr_b32 s5, s5, 16
    s_mul_i32 s39, s5, 5
    s_sub_u32 s6, s6, s39
    s_mov_b32 s8, 5
    s_mov_b32 s9, 100
    s_mov_b32 s10, 6291456
    s_mov_b32 s11, 13108
    s_branch L_PCjm
L_Pjm1:
    s_cmp_ge_u32 s4, 200
    s_cbranch_scc1 L_Pjm2
    s_sub_u32 s6, s4, 100
    s_mul_i32 s5, s6, 13108
    s_lshr_b32 s5, s5, 16
    s_mul_i32 s39, s5, 5
    s_sub_u32 s6, s6, s39
    s_mov_b32 s8, 5
    s_mov_b32 s9, 100
    s_mov_b32 s10, 7110656
    s_mov_b32 s11, 13108
    s_branch L_PCjm
L_Pjm2:
    s_cmp_ge_u32 s4, 440
    s_cbranch_scc1 L_Pjm3
    s_sub_u32 s6, s4, 200
    s_mul_i32 s5, s6, 5462
    s_lshr_b32 s5, s5, 16
    s_mul_i32 s39, s5, 12
    s_sub_u32 s6, s6, s39
    s_mov_b32 s8, 3
    s_mov_b32 s9, 60
    s_mov_b32 s10, 7929856
    s_mov_b32 s11, 21846
    s_branch L_PCjm
L_Pjm3:
    s_sub_u32 s6, s4, 440
    s_mul_i32 s5, s6, 13108
    s_lshr_b32 s5, s5, 16
    s_mul_i32 s39, s5, 5
    s_sub_u32 s6, s6, s39
    s_mov_b32 s8, 5
    s_mov_b32 s9, 240
    s_mov_b32 s10, 9895936
    s_mov_b32 s11, 13108
L_PCjm:
    s_mul_i32 s5, s5, s8
    s_lshl_b32 s6, s6, 3
    s_add_u32 s39, s26, 112896
    v_add_u32 v65, s39, v28
    s_mul_i32 s59, s6, s11
    s_lshr_b32 s59, s59, 16
    s_mul_i32 s60, s59, s8
    s_sub_u32 s60, s6, s60
    s_mul_i32 s59, s59, s9
    s_add_u32 s39, s60, s59
    s_add_u32 s39, s39, s5
    s_lshl_b32 s39, s39, 10
    s_add_u32 s39, s39, s10
    s_sub_u32 s59, s9, s8
    s_add_u32 s59, s59, 1
    s_lshl_b32 s59, s59, 10
    v_xor_b32 v5, 0, v65
    ds_read_b64_tr_b16 v[72:73], v5
    ds_read_b64_tr_b16 v[74:75], v5 offset:4096
    v_xor_b32 v5, 32, v65
    ds_read_b64_tr_b16 v[76:77], v5
    ds_read_b64_tr_b16 v[78:79], v5 offset:4096
    v_xor_b32 v5, 64, v65
    ds_read_b64_tr_b16 v[80:81], v5
    ds_read_b64_tr_b16 v[82:83], v5 offset:4096
    v_xor_b32 v5, 96, v65
    ds_read_b64_tr_b16 v[84:85], v5
    ds_read_b64_tr_b16 v[86:87], v5 offset:4096
    v_xor_b32 v5, 128, v65
    ds_read_b64_tr_b16 v[88:89], v5
    ds_read_b64_tr_b16 v[90:91], v5 offset:4096
    v_xor_b32 v5, 160, v65
    ds_read_b64_tr_b16 v[92:93], v5
    ds_read_b64_tr_b16 v[94:95], v5 offset:4096
    s_waitcnt lgkmcnt(10)
    buffer_store_dwordx4 v[72:75], v4, s[40:43], s39 offen sc1
    v_xor_b32 v5, 192, v65
    ds_read_b64_tr_b16 v[96:97], v5
    ds_read_b64_tr_b16 v[98:99], v5 offset:4096
    s_add_u32 s60, s60, 1
    s_cmp_eq_u32 s60, s8
    s_cselect_b32 s61, s59, 1024
    s_cselect_b32 s60, 0, s60
    s_add_u32 s39, s39, s61
    s_waitcnt lgkmcnt(10)
    buffer_store_dwordx4 v[76:79], v4, s[40:43], s39 offen sc1
    v_xor_b32 v5, 224, v65
    ds_read_b64_tr_b16 v[100:101], v5
    ds_read_b64_tr_b16 v[102:103], v5 offset:4096
    s_add_u32 s60, s60, 1
    s_cmp_eq_u32 s60, s8
    s_cselect_b32 s61, s59, 1024
    s_cselect_b32 s60, 0, s60
    s_add_u32 s39, s39, s61
    s_waitcnt lgkmcnt(10)
    buffer_store_dwordx4 v[80:83], v4, s[40:43], s39 offen sc1
    s_add_u32 s60, s60, 1
    s_cmp_eq_u32 s60, s8
    s_cselect_b32 s61, s59, 1024
    s_cselect_b32 s60, 0, s60
    s_add_u32 s39, s39, s61
    s_waitcnt lgkmcnt(8)
    buffer_store_dwordx4 v[84:87], v4, s[40:43], s39 offen sc1
    s_add_u32 s60, s60, 1
    s_cmp_eq_u32 s60, s8
    s_cselect_b32 s61, s59, 1024
    s_cselect_b32 s60, 0, s60
    s_add_u32 s39, s39, s61
    s_waitcnt lgkmcnt(6)
    buffer_store_dwordx4 v[88:91], v4, s[40:43], s39 offen sc1
    s_add_u32 s60, s60, 1
    s_cmp_eq_u32 s60, s8
    s_cselect_b32 s61, s59, 1024
    s_cselect_b32 s60, 0, s60
    s_add_u32 s39, s39, s61
    s_waitcnt lgkmcnt(4)
    buffer_store_dwordx4 v[92:95], v4, s[40:43], s39 offen sc1
    s_add_u32 s60, s60, 1
    s_cmp_eq_u32 s60, s8
    s_cselect_b32 s61, s59, 1024
    s_cselect_b32 s60, 0, s60
    s_add_u32 s39, s39, s61
    s_waitcnt lgkmcnt(2)
    buffer_store_dwordx4 v[96:99], v4, s[40:43], s39 offen sc1
    s_add_u32 s60, s60, 1
    s_cmp_eq_u32 s60, s8
    s_cselect_b32 s61, s59, 1024
    s_cselect_b32 s60, 0, s60
    s_add_u32 s39, s39, s61
    s_waitcnt lgkmcnt(0)
    buffer_store_dwordx4 v[100:103], v4, s[40:43], s39 offen sc1
L_SJEm:
    s_add_u32 s4, s4, 1
    s_add_u32 s26, s26, 8192
    s_cmp_lt_u32 s26, 16384
    s_cbranch_scc1 L_M2L
    s_branch L_S1F
L_M3:
    s_lshl_b32 s60, s55, 2
    s_add_u32 s60, s60, 0
    s_mov_b32 m0, 147200
    s_nop 0
    buffer_load_dword v24, s[40:43], s60 offen sc1 lds
    s_lshl_b32 s60, s55, 4
    s_add_u32 s60, s60, 3670016
    s_mov_b32 s61, 147456
L_XN:
    s_mov_b32 m0, s61
    s_add_u32 s61, s61, 4096
    buffer_load_dwordx4 v23, s[40:43], s60 offen offset:0 sc1 lds
    s_add_u32 s60, s60, 162816
    buffer_load_dwordx4 v23, s[40:43], s60 offen offset:1024 sc1 lds
    s_add_u32 s60, s60, 162816
    buffer_load_dwordx4 v23, s[40:43], s60 offen offset:2048 sc1 lds
    s_add_u32 s60, s60, 162816
    buffer_load_dwordx4 v23, s[40:43], s60 offen offset:3072 sc1 lds
    s_add_u32 s60, s60, 166912
    s_cmp_lt_u32 s61, 163840
    s_cbranch_scc1 L_XN
    s_and_b32 s39, s2, 7
    s_lshl_b32 s39, s39, 13
    s_add_u32 s39, s39, 14745600
    v_lshlrev_b32 v21, 7, v1
    buffer_load_dwordx4 v[56:59], v21, s[40:43], s39 offen sc1
    s_cmp_eq_u32 s58, 0
    s_cbranch_scc1 L_M3H
    s_waitcnt vmcnt(22)
    v_lshlrev_b32 v72, 16, v192
    v_and_b32 v73, 0xffff0000, v192
    v_lshlrev_b32 v74, 16, v193
    v_and_b32 v75, 0xffff0000, v193
    v_mul_f32 v76, 0xbfb8aa3b, v72
    v_mul_f32 v77, 0xbfb8aa3b, v73
    v_mul_f32 v78, 0xbfb8aa3b, v74
    v_mul_f32 v79, 0xbfb8aa3b, v75
    v_exp_f32 v76, v76
    v_exp_f32 v77, v77
    v_exp_f32 v78, v78
    v_exp_f32 v79, v79
    v_add_f32 v76, 1.0, v76
    v_add_f32 v77, 1.0, v77
    v_add_f32 v78, 1.0, v78
    v_add_f32 v79, 1.0, v79
    v_rcp_f32 v76, v76
    v_rcp_f32 v77, v77
    v_rcp_f32 v78, v78
    v_rcp_f32 v79, v79
    v_mul_f32 v76, v72, v76
    v_mul_f32 v77, v73, v77
    v_mul_f32 v78, v74, v78
    v_mul_f32 v79, v75, v79
    v_cvt_pk_bf16_f32 v72, v76, v77
    v_cvt_pk_bf16_f32 v73, v78, v79
    v_lshlrev_b32 v6, 3, v1
    v_add_u32 v6, 146688, v6
    ds_write_b64 v6, v[72:73]
    ds_read_b64 v[92:93], v69 offset:0
    ds_read_b64 v[94:95], v69 offset:32
    ds_read_b64 v[96:97], v69 offset:64
    ds_read_b64 v[98:99], v69 offset:96
    ds_read_b64 v[100:101], v69 offset:128
    ds_read_b64 v[102:103], v69 offset:160
    ds_read_b64 v[104:105], v69 offset:192
    ds_read_b64 v[106:107], v69 offset:224
    ds_read_b64 v[108:109], v69 offset:256
    ds_read_b64 v[110:111], v69 offset:288
    s_and_b32 s39, s13, 3
    s_mul_i32 s39, s39, 15360
    s_lshr_b32 s59, s13, 2
    s_lshl_b32 s59, s59, 8
    s_add_u32 s39, s39, s59
    s_add_u32 s39, s39, 0
    s_cmp_lt_u32 s13, 240
    s_cselect_b32 s39, s39, 0x40000000
    v_lshlrev_b32 v7, 6, v2
    v_lshl_add_u32 v7, v3, 4, v7
    v_add_u32 v7, s39, v7
    s_waitcnt lgkmcnt(4)
    v_xor_b32 v5, 0, v68
    ds_read_b64_tr_b16 v[72:73], v5 offset:0
    ds_read_b64_tr_b16 v[74:75], v5 offset:2048
    ds_read_b64_tr_b16 v[76:77], v5 offset:4096
    ds_read_b64_tr_b16 v[78:79], v5 offset:6144
    ds_read_b64_tr_b16 v[80:81], v5 offset:8192
    ds_read_b64_tr_b16 v[82:83], v5 offset:10240
    ds_read_b64_tr_b16 v[84:85], v5 offset:12288
    ds_read_b64_tr_b16 v[86:87], v5 offset:14336
    ds_read_b64_tr_b16 v[88:89], v5 offset:16384
    ds_read_b64_tr_b16 v[90:91], v5 offset:18432
    s_waitcnt lgkmcnt(0)
    v_xor_b32 v5, 32, v68
    ds_read_b64_tr_b16 v[160:161], v5 offset:0
    ds_read_b64_tr_b16 v[162:163], v5 offset:2048
    ds_read_b64_tr_b16 v[164:165], v5 offset:4096
    ds_read_b64_tr_b16 v[166:167], v5 offset:6144
    ds_read_b64_tr_b16 v[168:169], v5 offset:8192
    ds_read_b64_tr_b16 v[170:171], v5 offset:10240
    ds_read_b64_tr_b16 v[172:173], v5 offset:12288
    ds_read_b64_tr_b16 v[174:175], v5 offset:14336
    ds_read_b64_tr_b16 v[176:177], v5 offset:16384
    ds_read_b64_tr_b16 v[178:179], v5 offset:18432
    v_mfma_f32_16x16x32_bf16 v[196:199], v[72:75], v[92:95], 0
    v_mfma_f32_16x16x32_bf16 v[196:199], v[76:79], v[96:99], v[196:199]
    v_mfma_f32_16x16x32_bf16 v[196:199], v[80:83], v[100:103], v[196:199]
    v_mfma_f32_16x16x32_bf16 v[196:199], v[84:87], v[104:107], v[196:199]
    v_mfma_f32_16x16x32_bf16 v[196:199], v[88:91], v[108:111], v[196:199]
    s_waitcnt lgkmcnt(0)
    v_xor_b32 v5, 64, v68
    ds_read_b64_tr_b16 v[72:73], v5 offset:0
    ds_read_b64_tr_b16 v[74:75], v5 offset:2048
    ds_read_b64_tr_b16 v[76:77], v5 offset:4096
    ds_read_b64_tr_b16 v[78:79], v5 offset:6144
    ds_read_b64_tr_b16 v[80:81], v5 offset:8192
    ds_read_b64_tr_b16 v[82:83], v5 offset:10240
    ds_read_b64_tr_b16 v[84:85], v5 offset:12288
    ds_read_b64_tr_b16 v[86:87], v5 offset:14336
    ds_read_b64_tr_b16 v[88:89], v5 offset:16384
    ds_read_b64_tr_b16 v[90:91], v5 offset:18432
    v_mfma_f32_16x16x32_bf16 v[200:203], v[160:163], v[92:95], 0
    v_mfma_f32_16x16x32_bf16 v[200:203], v[164:167], v[96:99], v[200:203]
    v_mfma_f32_16x16x32_bf16 v[200:203], v[168:171], v[100:103], v[200:203]
    v_mfma_f32_16x16x32_bf16 v[200:203], v[172:175], v[104:107], v[200:203]
    v_mfma_f32_16x16x32_bf16 v[200:203], v[176:179], v[108:111], v[200:203]
    s_waitcnt lgkmcnt(0)
    v_xor_b32 v5, 96, v68
    ds_read_b64_tr_b16 v[160:161], v5 offset:0
    ds_read_b64_tr_b16 v[162:163], v5 offset:2048
    ds_read_b64_tr_b16 v[164:165], v5 offset:4096
    ds_read_b64_tr_b16 v[166:167], v5 offset:6144
    ds_read_b64_tr_b16 v[168:169], v5 offset:8192
    ds_read_b64_tr_b16 v[170:171], v5 offset:10240
    ds_read_b64_tr_b16 v[172:173], v5 offset:12288
    ds_read_b64_tr_b16 v[174:175], v5 offset:14336
    ds_read_b64_tr_b16 v[176:177], v5 offset:16384
    ds_read_b64_tr_b16 v[178:179], v5 offset:18432
    v_mfma_f32_16x16x32_bf16 v[204:207], v[72:75], v[92:95], 0
    v_mfma_f32_16x16x32_bf16 v[204:207], v[76:79], v[96:99], v[204:207]
    v_mfma_f32_16x16x32_bf16 v[204:207], v[80:83], v[100:103], v[204:207]
    v_mfma_f32_16x16x32_bf16 v[204:207], v[84:87], v[104:107], v[204:207]
    v_mfma_f32_16x16x32_bf16 v[204:207], v[88:91], v[108:111], v[204:207]
    s_waitcnt lgkmcnt(0)
    v_mfma_f32_16x16x32_bf16 v[208:211], v[160:163], v[92:95], 0
    v_mfma_f32_16x16x32_bf16 v[208:211], v[164:167], v[96:99], v[208:211]
    v_mfma_f32_16x16x32_bf16 v[208:211], v[168:171], v[100:103], v[208:211]
    v_mfma_f32_16x16x32_bf16 v[208:211], v[172:175], v[104:107], v[208:211]
    v_mfma_f32_16x16x32_bf16 v[208:211], v[176:179], v[108:111], v[208:211]
    v_cmp_eq_u32 vcc, 1, v2
    s_nop 1
    v_cndmask_b32 v196, v196, v200, vcc
    v_cndmask_b32 v197, v197, v201, vcc
    v_cndmask_b32 v198, v198, v202, vcc
    v_cndmask_b32 v199, v199, v203, vcc
    v_cmp_eq_u32 vcc, 2, v2
    s_nop 1
    v_cndmask_b32 v196, v196, v204, vcc
    v_cndmask_b32 v197, v197, v205, vcc
    v_cndmask_b32 v198, v198, v206, vcc
    v_cndmask_b32 v199, v199, v207, vcc
    v_cmp_eq_u32 vcc, 3, v2
    s_nop 1
    v_cndmask_b32 v196, v196, v208, vcc
    v_cndmask_b32 v197, v197, v209, vcc
    v_cndmask_b32 v198, v198, v210, vcc
    v_cndmask_b32 v199, v199, v211, vcc
    s_mov_b32 exec_lo, 0xf000f
    s_mov_b32 exec_hi, 0xf000f
    buffer_store_dwordx4 v[196:199], v7, s[40:43], 0 offen sc1
    s_mov_b64 exec, -1
    s_waitcnt vmcnt(1)
    s_branch L_M3C
L_M3H:
    s_waitcnt vmcnt(0)
L_M3C:
    v_subrev_u32 v56, s38, v56
    v_subrev_u32 v57, s38, v57
    v_subrev_u32 v58, s38, v58
    v_subrev_u32 v59, s38, v59
    v_or3_b32 v56, v56, v57, v58
    v_or_b32 v56, v56, v59
    v_cmp_lt_u32 vcc, 7, v56
    s_mov_b32 s60, 0xff00ff
    s_mov_b32 s61, 0xff00ff
    s_and_b64 vcc, vcc, s[60:61]
    s_cbranch_vccz L_PDA1h
    s_mov_b32 s59, 0
L_PLA1h:
    s_and_b32 s39, s2, 7
    s_lshl_b32 s39, s39, 13
    s_add_u32 s39, s39, 14745600
    v_lshlrev_b32 v21, 7, v1
    buffer_load_dwordx4 v[56:59], v21, s[40:43], s39 offen sc1
    s_add_u32 s59, s59, 1
    s_cmp_gt_u32 s59, 0x100000
    s_waitcnt vmcnt(0)
    s_cbranch_scc1 L_PDA1h
    v_subrev_u32 v56, s38, v56
    v_subrev_u32 v57, s38, v57
    v_subrev_u32 v58, s38, v58
    v_subrev_u32 v59, s38, v59
    v_or3_b32 v56, v56, v57, v58
    v_or_b32 v56, v56, v59
    v_cmp_lt_u32 vcc, 7, v56
    s_mov_b32 s60, 0xff00ff
    s_mov_b32 s61, 0xff00ff
    s_and_b64 vcc, vcc, s[60:61]
    s_cbranch_vccnz L_PLA1h
L_PDA1h:
    s_lshl_b32 s39, s53, 5
    s_lshl_b32 s59, s54, 2
    s_add_u32 s39, s39, s59
    s_add_u32 s39, s39, s52
    s_lshl_b32 s39, s39, 7
    v_min_u32 v5, 4, v1
    v_lshlrev_b32 v5, 17, v5
    v_add_u32 v5, 14811136, v5
    v_lshlrev_b32 v6, 17, v1
    v_add_u32 v6, -524288, v6
    v_cmp_lt_u32 vcc, 7, v1
    s_nop 1
    v_cndmask_b32 v5, v5, v6, vcc
    v_mov_b32 v6, 131072
    v_cmp_lt_u32 vcc, 11, v1
    s_nop 1
    v_cndmask_b32 v5, v5, v6, vcc
    buffer_load_dword v254, v5, s[40:43], s39 offen
    s_branch L_S1F
L_MF:
    v_mul_u32_u24 v5, 800, v2
    v_lshl_add_u32 v5, v3, 4, v5
    v_add_u32 v5, s22, v5
    ds_read_b128 v[48:51], v5 offset:0
    ds_read_b128 v[52:55], v5 offset:12800
    ds_read_b128 v[56:59], v5 offset:25600
    ds_read_b128 v[60:63], v5 offset:38400
    ds_read_b128 v[64:67], v5 offset:64
    ds_read_b128 v[68:71], v5 offset:12864
    ds_read_b128 v[72:75], v5 offset:25664
    ds_read_b128 v[76:79], v5 offset:38464
    ds_read_b128 v[80:83], v5 offset:128
    ds_read_b128 v[84:87], v5 offset:12928
    ds_read_b128 v[88:91], v5 offset:25728
    ds_read_b128 v[92:95], v5 offset:38528
    s_mul_i32 s39, s52, 1568
    s_add_u32 s39, s39, 137488
    v_lshlrev_b32 v112, 5, v2
    v_lshl_add_u32 v112, v3, 3, v112
    v_add_u32 v112, s39, v112
    v_lshlrev_b32 v113, 4, v2
    v_lshl_add_u32 v113, v3, 3, v113
    v_lshlrev_b32 v114, 3, v2
    v_lshl_add_u32 v114, v3, 7, v114
    v_cmp_lt_u32 vcc, 1, v3
    s_nop 1
    v_cndmask_b32 v113, v113, v114, vcc
    v_add_u32 v113, s39, v113
    v_lshlrev_b32 v114, 2, v2
    v_lshl_add_u32 v114, v3, 7, v114
    v_add_u32 v114, s39, v114
    v_readlane_b32 s59, v33, s52
    v_mov_b32 v115, 0
    s_nop 2
    v_writelane_b32 v115, s59, 0
    s_waitcnt lgkmcnt(8)
    ds_read_b128 v[96:99], v5 offset:192
    ds_read_b128 v[100:103], v5 offset:12992
    ds_read_b128 v[104:107], v5 offset:25792
    ds_read_b128 v[108:111], v5 offset:38592
    v_mfma_f32_16x16x32_bf16 v[36:39], v[52:55], v[48:51], 0
    v_mfma_f32_16x16x32_bf16 v[40:43], v[56:59], v[48:51], 0
    v_mfma_f32_16x16x32_bf16 v[44:47], v[60:63], v[48:51], 0
    s_waitcnt lgkmcnt(8)
    ds_read_b128 v[48:51], v5 offset:256
    ds_read_b128 v[52:55], v5 offset:13056
    ds_read_b128 v[56:59], v5 offset:25856
    ds_read_b128 v[60:63], v5 offset:38656
    v_mfma_f32_16x16x32_bf16 v[36:39], v[68:71], v[64:67], v[36:39]
    v_mfma_f32_16x16x32_bf16 v[40:43], v[72:75], v[64:67], v[40:43]
    v_mfma_f32_16x16x32_bf16 v[44:47], v[76:79], v[64:67], v[44:47]
    s_waitcnt lgkmcnt(8)
    ds_read_b128 v[64:67], v5 offset:320
    ds_read_b128 v[68:71], v5 offset:13120
    ds_read_b128 v[72:75], v5 offset:25920
    ds_read_b128 v[76:79], v5 offset:38720
    v_mfma_f32_16x16x32_bf16 v[36:39], v[84:87], v[80:83], v[36:39]
    v_mfma_f32_16x16x32_bf16 v[40:43], v[88:91], v[80:83], v[40:43]
    v_mfma_f32_16x16x32_bf16 v[44:47], v[92:95], v[80:83], v[44:47]
    s_waitcnt lgkmcnt(8)
    ds_read_b128 v[80:83], v5 offset:384
    ds_read_b128 v[84:87], v5 offset:13184
    ds_read_b128 v[88:91], v5 offset:25984
    ds_read_b128 v[92:95], v5 offset:38784
    v_mfma_f32_16x16x32_bf16 v[36:39], v[100:103], v[96:99], v[36:39]
    v_mfma_f32_16x16x32_bf16 v[40:43], v[104:107], v[96:99], v[40:43]
    v_mfma_f32_16x16x32_bf16 v[44:47], v[108:111], v[96:99], v[44:47]
    s_waitcnt lgkmcnt(8)
    ds_read_b128 v[96:99], v5 offset:448
    ds_read_b128 v[100:103], v5 offset:13248
    ds_read_b128 v[104:107], v5 offset:26048
    ds_read_b128 v[108:111], v5 offset:38848
    v_mfma_f32_16x16x32_bf16 v[36:39], v[52:55], v[48:51], v[36:39]
    v_mfma_f32_16x16x32_bf16 v[40:43], v[56:59], v[48:51], v[40:43]
    v_mfma_f32_16x16x32_bf16 v[44:47], v[60:63], v[48:51], v[44:47]
    s_waitcnt lgkmcnt(8)
    ds_read_b128 v[48:51], v5 offset:512
    ds_read_b128 v[52:55], v5 offset:13312
    ds_read_b128 v[56:59], v5 offset:26112
    ds_read_b128 v[60:63], v5 offset:38912
    v_mfma_f32_16x16x32_bf16 v[36:39], v[68:71], v[64:67], v[36:39]
    v_mfma_f32_16x16x32_bf16 v[40:43], v[72:75], v[64:67], v[40:43]
    v_mfma_f32_16x16x32_bf16 v[44:47], v[76:79], v[64:67], v[44:47]
    s_waitcnt lgkmcnt(8)
    ds_read_b128 v[64:67], v5 offset:576
    ds_read_b128 v[68:71], v5 offset:13376
    ds_read_b128 v[72:75], v5 offset:26176
    ds_read_b128 v[76:79], v5 offset:38976
    v_mfma_f32_16x16x32_bf16 v[36:39], v[84:87], v[80:83], v[36:39]
    v_mfma_f32_16x16x32_bf16 v[40:43], v[88:91], v[80:83], v[40:43]
    v_mfma_f32_16x16x32_bf16 v[44:47], v[92:95], v[80:83], v[44:47]
    s_waitcnt lgkmcnt(8)
    ds_read_b128 v[80:83], v5 offset:640
    ds_read_b128 v[84:87], v5 offset:13440
    ds_read_b128 v[88:91], v5 offset:26240
    ds_read_b128 v[92:95], v5 offset:39040
    v_mfma_f32_16x16x32_bf16 v[36:39], v[100:103], v[96:99], v[36:39]
    v_mfma_f32_16x16x32_bf16 v[40:43], v[104:107], v[96:99], v[40:43]
    v_mfma_f32_16x16x32_bf16 v[44:47], v[108:111], v[96:99], v[44:47]
    s_waitcnt lgkmcnt(8)
    ds_read_b128 v[96:99], v5 offset:704
    ds_read_b128 v[100:103], v5 offset:13504
    ds_read_b128 v[104:107], v5 offset:26304
    ds_read_b128 v[108:111], v5 offset:39104
    v_mfma_f32_16x16x32_bf16 v[36:39], v[52:55], v[48:51], v[36:39]
    v_mfma_f32_16x16x32_bf16 v[40:43], v[56:59], v[48:51], v[40:43]
    v_mfma_f32_16x16x32_bf16 v[44:47], v[60:63], v[48:51], v[44:47]
    s_waitcnt lgkmcnt(8)
    v_mfma_f32_16x16x32_bf16 v[36:39], v[68:71], v[64:67], v[36:39]
    v_mfma_f32_16x16x32_bf16 v[40:43], v[72:75], v[64:67], v[40:43]
    v_mfma_f32_16x16x32_bf16 v[44:47], v[76:79], v[64:67], v[44:47]
    s_waitcnt lgkmcnt(4)
    v_mfma_f32_16x16x32_bf16 v[36:39], v[84:87], v[80:83], v[36:39]
    v_mfma_f32_16x16x32_bf16 v[40:43], v[88:91], v[80:83], v[40:43]
    v_mfma_f32_16x16x32_bf16 v[44:47], v[92:95], v[80:83], v[44:47]
    s_waitcnt lgkmcnt(0)
    v_mfma_f32_16x16x32_bf16 v[36:39], v[100:103], v[96:99], v[36:39]
    v_mfma_f32_16x16x32_bf16 v[40:43], v[104:107], v[96:99], v[40:43]
    v_mfma_f32_16x16x32_bf16 v[44:47], v[108:111], v[96:99], v[44:47]
    s_nop 5
    v_add_f32 v36, v36, v115
    v_cvt_pk_bf16_f32 v120, v36, v37
    v_cvt_pk_bf16_f32 v121, v38, v39
    v_cvt_pk_bf16_f32 v122, v40, v41
    v_cvt_pk_bf16_f32 v123, v42, v43
    v_cvt_pk_bf16_f32 v124, v44, v45
    v_cvt_pk_bf16_f32 v125, v46, v47
    v_mov_b32 v5, s39
    v_subrev_u32 v5, 16, v5
    ds_write_b128 v5, v[116:119]
    ds_write_b64 v112, v[120:121]
    ds_write_b64 v113, v[122:123] offset:512
    ds_write_b32 v114, v124 offset:1024
    ds_write_b32 v114, v125 offset:1088
    s_waitcnt lgkmcnt(0)
L_S1F:
    s_barrier
    s_mov_b32 s44, s32
    s_mov_b32 s45, s33
    s_mov_b32 s46, 2621440
    s_mov_b32 s47, 0x20000
    s_lshl_b32 s13, s55, 2
    s_add_u32 s13, s13, 0
    v_lshlrev_b32 v6, 2, v1
    v_add_u32 v35, 147200, v6
    ds_read_b32 v30, v35
    ds_read_u16 v64, v8 offset:0
    ds_read_u16 v65, v9 offset:0
    ds_read_u16 v66, v10 offset:0
    ds_read_u16 v67, v11 offset:0
    ds_read_u16 v68, v12 offset:0
    ds_read_u16 v69, v13 offset:0
    ds_read_u16 v70, v14 offset:0
    ds_read_u16 v71, v15 offset:0
    ds_read_u16 v72, v16 offset:0
    ds_read_u16 v73, v17 offset:0
    ds_read_u16 v74, v18 offset:0
    v_lshlrev_b32 v5, 6, v0
    v_add_u32 v5, 147456, v5
    ds_read_b128 v[176:179], v5 offset:0
    ds_read_b128 v[180:183], v5 offset:16
    ds_read_b128 v[184:187], v5 offset:32
    s_lshl_b32 s21, s54, 2
    s_add_u32 s21, s21, s52
    s_mul_i32 s16, s21, 25600
    s_add_u32 s16, s16, 6291456
    s_mul_i32 s17, s21, 25600
    s_add_u32 s17, s17, 7110656
    s_mul_i32 s18, s21, 61440
    s_add_u32 s18, s18, 7929856
    s_mul_i32 s19, s21, 61440
    s_add_u32 s19, s19, 9895936
    s_mov_b32 exec_hi, 63
    s_waitcnt lgkmcnt(14)
    ds_write_b128 v26, v[116:119]
    s_mov_b32 exec_hi, -1
    s_cmp_eq_u32 s52, 3
    s_cbranch_scc1 L_RW
    s_cmp_eq_u32 s52, s56
    s_cbranch_scc1 L_RW2
    s_waitcnt vmcnt(0)
L_RW2:
    s_waitcnt vmcnt(16)
    s_cmp_lt_u32 s4, 681
    s_cbranch_scc1 L_RW
    s_waitcnt vmcnt(0)
L_RW:
    buffer_load_dwordx4 a[0:3], v4, s[40:43], s16 offen offset:0 sc1
    buffer_load_dwordx4 a[4:7], v4, s[40:43], s16 offen offset:1024 sc1
    v_mov_b32 v34, v30
    s_nop 1
    v_permlane16_swap_b32 v30, v34
    v_add_f32 v30, v30, v34
    v_mov_b32 v34, v30
    s_nop 1
    v_permlane32_swap_b32 v30, v34
    v_add_f32 v30, v30, v34
    v_cvt_pk_bf16_f32 v30, v30, v30
    v_and_b32 v30, 0xffff0000, v30
    v_add_f32 v34, 1.0, v30
    v_cvt_pk_bf16_f32 v34, v34, v34
    v_and_b32 v34, 0xffff0000, v34
    s_nop 0
    v_readlane_b32 s28, v34, 4
    v_readlane_b32 s29, v30, 0
    v_readlane_b32 s30, v34, 5
    v_readlane_b32 s31, v30, 1
    v_readlane_b32 s32, v34, 6
    v_readlane_b32 s33, v30, 2
    s_waitcnt lgkmcnt(13)
    v_lshl_or_b32 v76, v65, 16, v64
    s_waitcnt lgkmcnt(11)
    v_lshl_or_b32 v77, v67, 16, v66
    s_waitcnt lgkmcnt(9)
    v_lshl_or_b32 v78, v69, 16, v68
    s_waitcnt lgkmcnt(7)
    v_lshl_or_b32 v79, v71, 16, v70
    ds_read_u16 v96, v8 offset:1568
    ds_read_u16 v97, v9 offset:1568
    ds_read_u16 v98, v10 offset:1568
    ds_read_u16 v99, v11 offset:1568
    ds_read_u16 v100, v12 offset:1568
    ds_read_u16 v101, v13 offset:1568
    ds_read_u16 v102, v14 offset:1568
    buffer_load_dwordx4 a[8:11], v4, s[40:43], s16 offen offset:2048 sc1
    ds_read_u16 v103, v15 offset:1568
    s_waitcnt lgkmcnt(14)
    ds_read_u16 v104, v16 offset:1568
    s_waitcnt lgkmcnt(14)
    ds_read_u16 v105, v17 offset:1568
    s_waitcnt lgkmcnt(14)
    ds_read_u16 v106, v18 offset:1568
    s_waitcnt lgkmcnt(14)
    ds_write_b128 v27, v[76:79] offset:4608
    v_lshlrev_b32 v160, 16, v176
    v_and_b32 v161, 0xffff0000, v176
    v_pk_fma_f32 v[160:161], v[160:161], v[228:229], v[236:237]
    v_pk_fma_f32 v[160:161], v[160:161], s[28:29], s[28:29] op_sel:[0,0,1] op_sel_hi:[1,0,1]
    v_cvt_pk_bf16_f32 v176, v160, v161
    v_lshl_or_b32 v80, v66, 16, v65
    buffer_load_dwordx4 a[12:15], v4, s[40:43], s16 offen offset:3072 sc1
    v_lshl_or_b32 v81, v68, 16, v67
    v_lshl_or_b32 v82, v70, 16, v69
    v_lshl_or_b32 v83, v72, 16, v71
    s_waitcnt lgkmcnt(14)
    ds_write_b128 v27, v[80:83] offset:8768
    v_lshlrev_b32 v162, 16, v177
    v_and_b32 v163, 0xffff0000, v177
    v_pk_fma_f32 v[162:163], v[162:163], v[230:231], v[238:239]
    v_pk_fma_f32 v[162:163], v[162:163], s[28:29], s[28:29] op_sel:[0,0,1] op_sel_hi:[1,0,1]
    v_cvt_pk_bf16_f32 v177, v162, v163
    v_lshl_or_b32 v84, v67, 16, v66
    v_lshl_or_b32 v85, v69, 16, v68
    s_add_u32 s3, s16, 4096
    buffer_load_dwordx4 a[16:19], v4, s[40:43], s3 offen offset:0 sc1
    v_lshl_or_b32 v86, v71, 16, v70
    v_lshl_or_b32 v87, v73, 16, v72
    s_waitcnt lgkmcnt(14)
    ds_write_b128 v27, v[84:87] offset:12928
    v_lshlrev_b32 v164, 16, v178
    v_and_b32 v165, 0xffff0000, v178
    v_pk_fma_f32 v[164:165], v[164:165], v[232:233], v[240:241]
    v_pk_fma_f32 v[164:165], v[164:165], s[28:29], s[28:29] op_sel:[0,0,1] op_sel_hi:[1,0,1]
    v_cvt_pk_bf16_f32 v178, v164, v165
    v_lshl_or_b32 v88, v68, 16, v67
    v_lshl_or_b32 v89, v70, 16, v69
    v_lshl_or_b32 v90, v72, 16, v71
    buffer_load_dwordx4 a[20:23], v4, s[40:43], s3 offen offset:1024 sc1
    v_lshl_or_b32 v91, v74, 16, v73
    s_waitcnt lgkmcnt(14)
    ds_write_b128 v27, v[88:91] offset:17088
    v_lshlrev_b32 v166, 16, v179
    v_and_b32 v167, 0xffff0000, v179
    v_pk_fma_f32 v[166:167], v[166:167], v[234:235], v[242:243]
    v_pk_fma_f32 v[166:167], v[166:167], s[28:29], s[28:29] op_sel:[0,0,1] op_sel_hi:[1,0,1]
    v_cvt_pk_bf16_f32 v179, v166, v167
    s_waitcnt lgkmcnt(14)
    ds_write_b128 v27, v[176:179] offset:480
    s_add_u32 s39, s52, s58
    s_cmp_lg_u32 s39, 4
    s_cbranch_scc1 L_NA1L
    s_waitcnt vmcnt(7)
    s_and_b32 s39, s2, 63
    s_lshl_b32 s39, s39, 7
    s_lshr_b32 s59, s2, 6
    s_lshl_b32 s59, s59, 2
    s_add_u32 s39, s39, s59
    s_add_u32 s39, s39, 14745600
    v_lshlrev_b32 v21, 13, v1
    s_getreg_b32 s59, hwreg(HW_REG_XCC_ID, 0, 3)
    s_add_u32 s59, s59, s38
    v_mov_b32 v22, s59
    s_mov_b64 exec, 0xff
    buffer_store_dword v22, v21, s[40:43], s39 offen sc1
    s_mov_b64 exec, -1
L_NA1L:
    v_add_u32 v27, 45824, v27
    s_waitcnt lgkmcnt(14)
    v_lshl_or_b32 v108, v97, 16, v96
    s_waitcnt lgkmcnt(12)
    v_lshl_or_b32 v109, v99, 16, v98
    buffer_load_dwordx4 a[24:27], v4, s[40:43], s3 offen offset:2048 sc1
    s_waitcnt lgkmcnt(10)
    v_lshl_or_b32 v110, v101, 16, v100
    s_waitcnt lgkmcnt(8)
    v_lshl_or_b32 v111, v103, 16, v102
    ds_read_u16 v128, v8 offset:3136
    ds_read_u16 v129, v9 offset:3136
    ds_read_u16 v130, v10 offset:3136
    ds_read_u16 v131, v11 offset:3136
    ds_read_u16 v132, v12 offset:3136
    ds_read_u16 v133, v13 offset:3136
    ds_read_u16 v134, v14 offset:3136
    s_waitcnt lgkmcnt(14)
    ds_read_u16 v135, v15 offset:3136
    s_waitcnt lgkmcnt(14)
    ds_read_u16 v136, v16 offset:3136
    buffer_load_dwordx4 a[28:31], v4, s[40:43], s3 offen offset:3072 sc1
    s_waitcnt lgkmcnt(14)
    ds_read_u16 v137, v17 offset:3136
    s_waitcnt lgkmcnt(14)
    ds_read_u16 v138, v18 offset:3136
    s_waitcnt lgkmcnt(14)
    ds_write_b128 v27, v[108:111] offset:4608
    v_lshlrev_b32 v160, 16, v180
    v_and_b32 v161, 0xffff0000, v180
    v_pk_fma_f32 v[160:161], v[160:161], v[228:229], v[236:237]
    v_pk_fma_f32 v[160:161], v[160:161], s[30:31], s[30:31] op_sel:[0,0,1] op_sel_hi:[1,0,1]
    v_cvt_pk_bf16_f32 v180, v160, v161
    v_lshl_or_b32 v112, v98, 16, v97
    v_lshl_or_b32 v113, v100, 16, v99
    v_lshl_or_b32 v114, v102, 16, v101
    s_add_u32 s3, s16, 8192
    buffer_load_dwordx4 a[32:35], v4, s[40:43], s3 offen offset:0 sc1
    v_lshl_or_b32 v115, v104, 16, v103
    s_waitcnt lgkmcnt(14)
    ds_write_b128 v27, v[112:115] offset:8768
    v_lshlrev_b32 v162, 16, v181
    v_and_b32 v163, 0xffff0000, v181
    v_pk_fma_f32 v[162:163], v[162:163], v[230:231], v[238:239]
    v_pk_fma_f32 v[162:163], v[162:163], s[30:31], s[30:31] op_sel:[0,0,1] op_sel_hi:[1,0,1]
    v_cvt_pk_bf16_f32 v181, v162, v163
    v_lshl_or_b32 v116, v99, 16, v98
    v_lshl_or_b32 v117, v101, 16, v100
    v_lshl_or_b32 v118, v103, 16, v102
    v_lshl_or_b32 v119, v105, 16, v104
    buffer_load_dwordx4 a[36:39], v4, s[40:43], s3 offen offset:1024 sc1
    s_waitcnt lgkmcnt(14)
    ds_write_b128 v27, v[116:119] offset:12928
    v_lshlrev_b32 v164, 16, v182
    v_and_b32 v165, 0xffff0000, v182
    v_pk_fma_f32 v[164:165], v[164:165], v[232:233], v[240:241]
    v_pk_fma_f32 v[164:165], v[164:165], s[30:31], s[30:31] op_sel:[0,0,1] op_sel_hi:[1,0,1]
    v_cvt_pk_bf16_f32 v182, v164, v165
    v_lshl_or_b32 v120, v100, 16, v99
    v_lshl_or_b32 v121, v102, 16, v101
    v_lshl_or_b32 v122, v104, 16, v103
    v_lshl_or_b32 v123, v106, 16, v105
    s_waitcnt lgkmcnt(14)
    ds_write_b128 v27, v[120:123] offset:17088
    buffer_load_dwordx4 a[40:43], v4, s[40:43], s3 offen offset:2048 sc1
    v_lshlrev_b32 v166, 16, v183
    v_and_b32 v167, 0xffff0000, v183
    v_pk_fma_f32 v[166:167], v[166:167], v[234:235], v[242:243]
    v_pk_fma_f32 v[166:167], v[166:167], s[30:31], s[30:31] op_sel:[0,0,1] op_sel_hi:[1,0,1]
    v_cvt_pk_bf16_f32 v183, v166, v167
    s_waitcnt lgkmcnt(14)
    ds_write_b128 v27, v[180:183] offset:480
    s_waitcnt lgkmcnt(0)
    s_cmp_eq_u32 s58, 1
    s_cbranch_scc1 L_NX2
    v_add_u32 v27, 45824, v27
    v_lshl_or_b32 v140, v129, 16, v128
    v_lshl_or_b32 v141, v131, 16, v130
    v_lshl_or_b32 v142, v133, 16, v132
    v_lshl_or_b32 v143, v135, 16, v134
    ds_write_b128 v27, v[140:143] offset:4608
    v_lshlrev_b32 v160, 16, v184
    v_and_b32 v161, 0xffff0000, v184
    v_pk_fma_f32 v[160:161], v[160:161], v[228:229], v[236:237]
    v_pk_fma_f32 v[160:161], v[160:161], s[32:33], s[32:33] op_sel:[0,0,1] op_sel_hi:[1,0,1]
    v_cvt_pk_bf16_f32 v184, v160, v161
    v_lshl_or_b32 v144, v130, 16, v129
    v_lshl_or_b32 v145, v132, 16, v131
    v_lshl_or_b32 v146, v134, 16, v133
    v_lshl_or_b32 v147, v136, 16, v135
    ds_write_b128 v27, v[144:147] offset:8768
    v_lshlrev_b32 v162, 16, v185
    v_and_b32 v163, 0xffff0000, v185
    v_pk_fma_f32 v[162:163], v[162:163], v[230:231], v[238:239]
    v_pk_fma_f32 v[162:163], v[162:163], s[32:33], s[32:33] op_sel:[0,0,1] op_sel_hi:[1,0,1]
    v_cvt_pk_bf16_f32 v185, v162, v163
    v_lshl_or_b32 v148, v131, 16, v130
    v_lshl_or_b32 v149, v133, 16, v132
    v_lshl_or_b32 v150, v135, 16, v134
    v_lshl_or_b32 v151, v137, 16, v136
    ds_write_b128 v27, v[148:151] offset:12928
    v_lshlrev_b32 v164, 16, v186
    v_and_b32 v165, 0xffff0000, v186
    v_pk_fma_f32 v[164:165], v[164:165], v[232:233], v[240:241]
    v_pk_fma_f32 v[164:165], v[164:165], s[32:33], s[32:33] op_sel:[0,0,1] op_sel_hi:[1,0,1]
    v_cvt_pk_bf16_f32 v186, v164, v165
    v_lshl_or_b32 v152, v132, 16, v131
    v_lshl_or_b32 v153, v134, 16, v133
    v_lshl_or_b32 v154, v136, 16, v135
    v_lshl_or_b32 v155, v138, 16, v137
    ds_write_b128 v27, v[152:155] offset:17088
    v_lshlrev_b32 v166, 16, v187
    v_and_b32 v167, 0xffff0000, v187
    v_pk_fma_f32 v[166:167], v[166:167], v[234:235], v[242:243]
    v_pk_fma_f32 v[166:167], v[166:167], s[32:33], s[32:33] op_sel:[0,0,1] op_sel_hi:[1,0,1]
    v_cvt_pk_bf16_f32 v187, v166, v167
    ds_write_b128 v27, v[184:187] offset:480
L_NX2:
    v_lshlrev_b32 v8, 4, v0
    v_lshrrev_b32 v15, 1, v3
    v_lshlrev_b32 v15, 6, v15
    v_and_b32 v16, 1, v3
    v_lshl_add_u32 v15, v16, 3, v15
    buffer_load_dwordx4 a[44:47], v4, s[40:43], s3 offen offset:3072 sc1
    v_lshl_add_u32 v15, v2, 7, v15
    v_lshrrev_b32 v16, 2, v2
    v_mul_u32_u24 v16, 81920, v16
    v_and_b32 v17, 3, v2
    v_lshl_add_u32 v16, v17, 5, v16
    v_lshrrev_b32 v17, 1, v3
    v_lshl_add_u32 v16, v17, 4, v16
    v_and_b32 v17, 1, v3
    v_mul_u32_u24 v17, 327680, v17
    v_add_u32 v16, v16, v17
    s_cmp_eq_u32 s52, 3
    s_cselect_b32 s23, 0, s52
    s_cselect_b32 s60, 2, 0
    s_lshl_b32 s39, s23, 4
    s_lshl_b32 s59, s60, 11
    s_add_u32 s39, s39, s59
    s_add_u32 s39, s39, 147456
    v_add_u32 v9, s39, v15
    s_add_u32 s3, s16, 12288
    buffer_load_dwordx4 a[48:51], v4, s[40:43], s3 offen offset:0 sc1
    s_add_u32 s39, s23, s55
    s_lshl_b32 s39, s39, 7
    s_mul_i32 s59, s60, 327680
    s_add_u32 s39, s39, s59
    s_cmp_lt_u32 s23, s56
    s_cselect_b32 s39, s39, 0x40000000
    v_add_u32 v12, s39, v16
    s_cmp_eq_u32 s52, 3
    s_cselect_b32 s24, 1, s52
    s_cselect_b32 s60, 2, 4
    s_lshl_b32 s39, s24, 4
    s_lshl_b32 s59, s60, 11
    s_add_u32 s39, s39, s59
    s_add_u32 s39, s39, 147456
    v_add_u32 v10, s39, v15
    s_add_u32 s39, s24, s55
    s_lshl_b32 s39, s39, 7
    s_mul_i32 s59, s60, 327680
    s_add_u32 s39, s39, s59
    s_cmp_lt_u32 s24, s56
    s_cselect_b32 s39, s39, 0x40000000
    v_add_u32 v13, s39, v16
    s_cmp_eq_u32 s52, 3
    s_cselect_b32 s25, 2, s52
    s_cselect_b32 s60, 2, 6
    s_lshl_b32 s39, s25, 4
    s_lshl_b32 s59, s60, 11
    s_add_u32 s39, s39, s59
    s_add_u32 s39, s39, 147456
    v_add_u32 v11, s39, v15
    s_add_u32 s39, s25, s55
    s_lshl_b32 s39, s39, 7
    s_mul_i32 s59, s60, 327680
    s_add_u32 s39, s39, s59
    s_cmp_lt_u32 s25, s56
    s_cselect_b32 s39, s39, 0x40000000
    v_add_u32 v14, s39, v16
    s_waitcnt lgkmcnt(0)
    s_barrier
    s_cmp_eq_u32 s52, 3
    s_cbranch_scc1 L_C3
    s_cmp_ge_u32 s52, s56
    s_cbranch_scc1 L_C2
    v_add_u32 v19, s22, v19
    v_add_u32 v20, s22, v20
    ds_read_b64 v[44:45], v19 offset:3584
    ds_read_b64 v[46:47], v19 offset:3592
    ds_read_b128 v[48:51], v20 offset:0
    ds_read_b64 v[52:53], v19 offset:3072
    ds_read_b64 v[54:55], v19 offset:3080
    ds_read_b128 v[56:59], v20 offset:512
    ds_read_b64 v[60:61], v19 offset:2560
    ds_read_b64 v[62:63], v19 offset:2568
    ds_read_b128 v[64:67], v20 offset:1024
    ds_read_b64 v[68:69], v19 offset:2048
    ds_read_b64 v[70:71], v19 offset:2056
    ds_read_b128 v[72:75], v20 offset:1536
    ds_read_b64 v[76:77], v19 offset:1536
    ds_read_b64 v[78:79], v19 offset:1544
    ds_read_b128 v[80:83], v20 offset:2048
    s_waitcnt lgkmcnt(14)
    ds_read_b64 v[84:85], v19 offset:1024
    s_waitcnt lgkmcnt(14)
    ds_read_b64 v[86:87], v19 offset:1032
    s_waitcnt lgkmcnt(14)
    ds_read_b128 v[88:91], v20 offset:2560
    s_waitcnt lgkmcnt(14)
    ds_read_b64 v[92:93], v19 offset:512
    s_waitcnt lgkmcnt(14)
    ds_read_b64 v[94:95], v19 offset:520
    s_waitcnt lgkmcnt(14)
    ds_read_b128 v[96:99], v20 offset:3072
    s_waitcnt lgkmcnt(14)
    ds_read_b64 v[100:101], v19 offset:0
    s_waitcnt lgkmcnt(14)
    ds_read_b64 v[102:103], v19 offset:8
    s_waitcnt lgkmcnt(14)
    ds_read_b128 v[104:107], v20 offset:3584
    v_mfma_f32_16x16x32_bf16 v[172:175], v[44:47], v[48:51], 0
    s_waitcnt lgkmcnt(14)
    ds_read_b64 v[108:109], v19 offset:3648
    v_mfma_f32_16x16x32_bf16 v[176:179], v[44:47], v[56:59], 0
    s_waitcnt lgkmcnt(14)
    ds_read_b64 v[110:111], v19 offset:3656
    v_mfma_f32_16x16x32_bf16 v[176:179], v[52:55], v[48:51], v[176:179]
    s_waitcnt lgkmcnt(14)
    ds_read_b128 v[112:115], v20 offset:64
    v_mfma_f32_16x16x32_bf16 v[180:183], v[60:63], v[64:67], 0
    buffer_load_dwordx4 a[52:55], v4, s[40:43], s3 offen offset:1024 sc1
    v_mfma_f32_16x16x32_bf16 v[180:183], v[52:55], v[72:75], v[180:183]
    s_waitcnt lgkmcnt(14)
    ds_read_b64 v[116:117], v19 offset:3136
    v_mfma_f32_16x16x32_bf16 v[184:187], v[60:63], v[72:75], 0
    s_waitcnt lgkmcnt(14)
    ds_read_b64 v[118:119], v19 offset:3144
    s_waitcnt lgkmcnt(14)
    ds_read_b128 v[120:123], v20 offset:576
    v_mfma_f32_16x16x32_bf16 v[180:183], v[68:71], v[56:59], v[180:183]
    s_waitcnt lgkmcnt(14)
    ds_read_b64 v[124:125], v19 offset:2624
    v_mfma_f32_16x16x32_bf16 v[184:187], v[68:71], v[64:67], v[184:187]
    s_waitcnt lgkmcnt(14)
    ds_read_b64 v[126:127], v19 offset:2632
    v_mfma_f32_16x16x32_bf16 v[188:191], v[68:71], v[72:75], 0
    s_waitcnt lgkmcnt(14)
    ds_read_b128 v[128:131], v20 offset:1088
    v_mfma_f32_16x16x32_bf16 v[180:183], v[44:47], v[80:83], v[180:183]
    buffer_load_dwordx4 a[56:59], v4, s[40:43], s3 offen offset:2048 sc1
    v_mfma_f32_16x16x32_bf16 v[184:187], v[52:55], v[80:83], v[184:187]
    s_waitcnt lgkmcnt(14)
    ds_read_b64 v[132:133], v19 offset:2112
    v_mfma_f32_16x16x32_bf16 v[188:191], v[60:63], v[80:83], v[188:191]
    s_waitcnt lgkmcnt(14)
    ds_read_b64 v[134:135], v19 offset:2120
    s_waitcnt lgkmcnt(14)
    ds_read_b128 v[136:139], v20 offset:1600
    v_mfma_f32_16x16x32_bf16 v[192:195], v[68:71], v[80:83], 0
    s_waitcnt lgkmcnt(14)
    ds_read_b64 v[140:141], v19 offset:1600
    v_mfma_f32_16x16x32_bf16 v[180:183], v[76:79], v[48:51], v[180:183]
    s_waitcnt lgkmcnt(14)
    ds_read_b64 v[142:143], v19 offset:1608
    v_mfma_f32_16x16x32_bf16 v[184:187], v[76:79], v[56:59], v[184:187]
    s_waitcnt lgkmcnt(14)
    ds_read_b128 v[144:147], v20 offset:2112
    v_mfma_f32_16x16x32_bf16 v[188:191], v[76:79], v[64:67], v[188:191]
    buffer_load_dwordx4 a[60:63], v4, s[40:43], s3 offen offset:3072 sc1
    v_mfma_f32_16x16x32_bf16 v[192:195], v[76:79], v[72:75], v[192:195]
    s_waitcnt lgkmcnt(14)
    ds_read_b64 v[148:149], v19 offset:1088
    v_mfma_f32_16x16x32_bf16 v[184:187], v[44:47], v[88:91], v[184:187]
    s_waitcnt lgkmcnt(14)
    ds_read_b64 v[150:151], v19 offset:1096
    s_waitcnt lgkmcnt(14)
    ds_read_b128 v[152:155], v20 offset:2624
    v_mfma_f32_16x16x32_bf16 v[188:191], v[52:55], v[88:91], v[188:191]
    s_waitcnt lgkmcnt(14)
    ds_read_b64 v[156:157], v19 offset:576
    v_mfma_f32_16x16x32_bf16 v[192:195], v[60:63], v[88:91], v[192:195]
    s_waitcnt lgkmcnt(14)
    ds_read_b64 v[158:159], v19 offset:584
    v_mfma_f32_16x16x32_bf16 v[184:187], v[84:87], v[48:51], v[184:187]
    s_waitcnt lgkmcnt(14)
    ds_read_b128 v[160:163], v20 offset:3136
    v_mfma_f32_16x16x32_bf16 v[188:191], v[84:87], v[56:59], v[188:191]
    s_add_u32 s3, s16, 16384
    v_mfma_f32_16x16x32_bf16 v[192:195], v[84:87], v[64:67], v[192:195]
    s_waitcnt lgkmcnt(14)
    ds_read_b64 v[164:165], v19 offset:64
    v_mfma_f32_16x16x32_bf16 v[188:191], v[44:47], v[96:99], v[188:191]
    s_waitcnt lgkmcnt(14)
    ds_read_b64 v[166:167], v19 offset:72
    s_waitcnt lgkmcnt(14)
    ds_read_b128 v[168:171], v20 offset:3648
    v_mfma_f32_16x16x32_bf16 v[192:195], v[52:55], v[96:99], v[192:195]
    v_mfma_f32_16x16x32_bf16 v[188:191], v[92:95], v[48:51], v[188:191]
    v_mfma_f32_16x16x32_bf16 v[192:195], v[92:95], v[56:59], v[192:195]
    buffer_load_dwordx4 a[64:67], v4, s[40:43], s3 offen offset:0 sc1
    v_mfma_f32_16x16x32_bf16 v[192:195], v[44:47], v[104:107], v[192:195]
    v_mfma_f32_16x16x32_bf16 v[192:195], v[100:103], v[48:51], v[192:195]
    buffer_load_dwordx4 a[68:71], v4, s[40:43], s3 offen offset:1024 sc1
    s_waitcnt lgkmcnt(0)
    v_mfma_f32_16x16x32_bf16 v[172:175], v[108:111], v[112:115], v[172:175]
    ds_read_b64 v[44:45], v19 offset:3712
    v_mfma_f32_16x16x32_bf16 v[176:179], v[108:111], v[120:123], v[176:179]
    ds_read_b64 v[46:47], v19 offset:3720
    v_mfma_f32_16x16x32_bf16 v[176:179], v[116:119], v[112:115], v[176:179]
    ds_read_b128 v[48:51], v20 offset:128
    v_mfma_f32_16x16x32_bf16 v[180:183], v[124:127], v[128:131], v[180:183]
    buffer_load_dwordx4 a[72:75], v4, s[40:43], s3 offen offset:2048 sc1
    v_mfma_f32_16x16x32_bf16 v[180:183], v[116:119], v[136:139], v[180:183]
    ds_read_b64 v[52:53], v19 offset:3200
    v_mfma_f32_16x16x32_bf16 v[184:187], v[124:127], v[136:139], v[184:187]
    ds_read_b64 v[54:55], v19 offset:3208
    ds_read_b128 v[56:59], v20 offset:640
    v_mfma_f32_16x16x32_bf16 v[180:183], v[132:135], v[120:123], v[180:183]
    ds_read_b64 v[60:61], v19 offset:2688
    v_mfma_f32_16x16x32_bf16 v[184:187], v[132:135], v[128:131], v[184:187]
    ds_read_b64 v[62:63], v19 offset:2696
    v_mfma_f32_16x16x32_bf16 v[188:191], v[132:135], v[136:139], v[188:191]
    ds_read_b128 v[64:67], v20 offset:1152
    v_mfma_f32_16x16x32_bf16 v[180:183], v[108:111], v[144:147], v[180:183]
    buffer_load_dwordx4 a[76:79], v4, s[40:43], s3 offen offset:3072 sc1
    v_mfma_f32_16x16x32_bf16 v[184:187], v[116:119], v[144:147], v[184:187]
    ds_read_b64 v[68:69], v19 offset:2176
    v_mfma_f32_16x16x32_bf16 v[188:191], v[124:127], v[144:147], v[188:191]
    ds_read_b64 v[70:71], v19 offset:2184
    ds_read_b128 v[72:75], v20 offset:1664
    v_mfma_f32_16x16x32_bf16 v[192:195], v[132:135], v[144:147], v[192:195]
    ds_read_b64 v[76:77], v19 offset:1664
    v_mfma_f32_16x16x32_bf16 v[180:183], v[140:143], v[112:115], v[180:183]
    ds_read_b64 v[78:79], v19 offset:1672
    v_mfma_f32_16x16x32_bf16 v[184:187], v[140:143], v[120:123], v[184:187]
    ds_read_b128 v[80:83], v20 offset:2176
    v_mfma_f32_16x16x32_bf16 v[188:191], v[140:143], v[128:131], v[188:191]
    s_add_u32 s3, s16, 20480
    v_mfma_f32_16x16x32_bf16 v[192:195], v[140:143], v[136:139], v[192:195]
    ds_read_b64 v[84:85], v19 offset:1152
    v_mfma_f32_16x16x32_bf16 v[184:187], v[108:111], v[152:155], v[184:187]
    ds_read_b64 v[86:87], v19 offset:1160
    ds_read_b128 v[88:91], v20 offset:2688
    v_mfma_f32_16x16x32_bf16 v[188:191], v[116:119], v[152:155], v[188:191]
    ds_read_b64 v[92:93], v19 offset:640
    v_mfma_f32_16x16x32_bf16 v[192:195], v[124:127], v[152:155], v[192:195]
    ds_read_b64 v[94:95], v19 offset:648
    v_mfma_f32_16x16x32_bf16 v[184:187], v[148:151], v[112:115], v[184:187]
    ds_read_b128 v[96:99], v20 offset:3200
    v_mfma_f32_16x16x32_bf16 v[188:191], v[148:151], v[120:123], v[188:191]
    buffer_load_dwordx4 a[80:83], v4, s[40:43], s3 offen offset:0 sc1
    v_mfma_f32_16x16x32_bf16 v[192:195], v[148:151], v[128:131], v[192:195]
    ds_read_b64 v[100:101], v19 offset:128
    v_mfma_f32_16x16x32_bf16 v[188:191], v[108:111], v[160:163], v[188:191]
    ds_read_b64 v[102:103], v19 offset:136
    ds_read_b128 v[104:107], v20 offset:3712
    v_mfma_f32_16x16x32_bf16 v[192:195], v[116:119], v[160:163], v[192:195]
    v_mfma_f32_16x16x32_bf16 v[188:191], v[156:159], v[112:115], v[188:191]
    v_mfma_f32_16x16x32_bf16 v[192:195], v[156:159], v[120:123], v[192:195]
    buffer_load_dwordx4 a[84:87], v4, s[40:43], s3 offen offset:1024 sc1
    v_mfma_f32_16x16x32_bf16 v[192:195], v[108:111], v[168:171], v[192:195]
    v_mfma_f32_16x16x32_bf16 v[192:195], v[164:167], v[112:115], v[192:195]
    buffer_load_dwordx4 a[88:91], v4, s[40:43], s3 offen offset:2048 sc1
    s_waitcnt lgkmcnt(0)
    v_mfma_f32_16x16x32_bf16 v[172:175], v[44:47], v[48:51], v[172:175]
    ds_read_b64 v[108:109], v19 offset:3776
    v_mfma_f32_16x16x32_bf16 v[176:179], v[44:47], v[56:59], v[176:179]
    ds_read_b64 v[110:111], v19 offset:3784
    v_mfma_f32_16x16x32_bf16 v[176:179], v[52:55], v[48:51], v[176:179]
    ds_read_b128 v[112:115], v20 offset:192
    v_mfma_f32_16x16x32_bf16 v[180:183], v[60:63], v[64:67], v[180:183]
    buffer_load_dwordx4 a[92:95], v4, s[40:43], s3 offen offset:3072 sc1
    v_mfma_f32_16x16x32_bf16 v[180:183], v[52:55], v[72:75], v[180:183]
    ds_read_b64 v[116:117], v19 offset:3264
    v_mfma_f32_16x16x32_bf16 v[184:187], v[60:63], v[72:75], v[184:187]
    ds_read_b64 v[118:119], v19 offset:3272
    ds_read_b128 v[120:123], v20 offset:704
    v_mfma_f32_16x16x32_bf16 v[180:183], v[68:71], v[56:59], v[180:183]
    ds_read_b64 v[124:125], v19 offset:2752
    v_mfma_f32_16x16x32_bf16 v[184:187], v[68:71], v[64:67], v[184:187]
    ds_read_b64 v[126:127], v19 offset:2760
    v_mfma_f32_16x16x32_bf16 v[188:191], v[68:71], v[72:75], v[188:191]
    ds_read_b128 v[128:131], v20 offset:1216
    v_mfma_f32_16x16x32_bf16 v[180:183], v[44:47], v[80:83], v[180:183]
    s_add_u32 s3, s16, 24576
    v_mfma_f32_16x16x32_bf16 v[184:187], v[52:55], v[80:83], v[184:187]
    ds_read_b64 v[132:133], v19 offset:2240
    v_mfma_f32_16x16x32_bf16 v[188:191], v[60:63], v[80:83], v[188:191]
    ds_read_b64 v[134:135], v19 offset:2248
    ds_read_b128 v[136:139], v20 offset:1728
    v_mfma_f32_16x16x32_bf16 v[192:195], v[68:71], v[80:83], v[192:195]
    ds_read_b64 v[140:141], v19 offset:1728
    v_mfma_f32_16x16x32_bf16 v[180:183], v[76:79], v[48:51], v[180:183]
    ds_read_b64 v[142:143], v19 offset:1736
    v_mfma_f32_16x16x32_bf16 v[184:187], v[76:79], v[56:59], v[184:187]
    ds_read_b128 v[144:147], v20 offset:2240
    v_mfma_f32_16x16x32_bf16 v[188:191], v[76:79], v[64:67], v[188:191]
    buffer_load_dwordx4 a[96:99], v4, s[40:43], s3 offen offset:0 sc1
    v_mfma_f32_16x16x32_bf16 v[192:195], v[76:79], v[72:75], v[192:195]
    ds_read_b64 v[148:149], v19 offset:1216
    v_mfma_f32_16x16x32_bf16 v[184:187], v[44:47], v[88:91], v[184:187]
    ds_read_b64 v[150:151], v19 offset:1224
    ds_read_b128 v[152:155], v20 offset:2752
    v_mfma_f32_16x16x32_bf16 v[188:191], v[52:55], v[88:91], v[188:191]
    ds_read_b64 v[156:157], v19 offset:704
    v_mfma_f32_16x16x32_bf16 v[192:195], v[60:63], v[88:91], v[192:195]
    ds_read_b64 v[158:159], v19 offset:712
    v_mfma_f32_16x16x32_bf16 v[184:187], v[84:87], v[48:51], v[184:187]
    ds_read_b128 v[160:163], v20 offset:3264
    v_mfma_f32_16x16x32_bf16 v[188:191], v[84:87], v[56:59], v[188:191]
    buffer_load_dwordx4 a[100:103], v4, s[40:43], s17 offen offset:0 sc1
    v_mfma_f32_16x16x32_bf16 v[192:195], v[84:87], v[64:67], v[192:195]
    ds_read_b64 v[164:165], v19 offset:192
    v_mfma_f32_16x16x32_bf16 v[188:191], v[44:47], v[96:99], v[188:191]
    ds_read_b64 v[166:167], v19 offset:200
    ds_read_b128 v[168:171], v20 offset:3776
    v_mfma_f32_16x16x32_bf16 v[192:195], v[52:55], v[96:99], v[192:195]
    v_mfma_f32_16x16x32_bf16 v[188:191], v[92:95], v[48:51], v[188:191]
    v_mfma_f32_16x16x32_bf16 v[192:195], v[92:95], v[56:59], v[192:195]
    buffer_load_dwordx4 a[104:107], v4, s[40:43], s17 offen offset:1024 sc1
    v_mfma_f32_16x16x32_bf16 v[192:195], v[44:47], v[104:107], v[192:195]
    v_mfma_f32_16x16x32_bf16 v[192:195], v[100:103], v[48:51], v[192:195]
    buffer_load_dwordx4 a[108:111], v4, s[40:43], s17 offen offset:2048 sc1
    s_waitcnt lgkmcnt(0)
    v_mfma_f32_16x16x32_bf16 v[172:175], v[108:111], v[112:115], v[172:175]
    ds_read_b64 v[44:45], v19 offset:3840
    v_mfma_f32_16x16x32_bf16 v[176:179], v[108:111], v[120:123], v[176:179]
    ds_read_b64 v[46:47], v19 offset:3848
    v_mfma_f32_16x16x32_bf16 v[176:179], v[116:119], v[112:115], v[176:179]
    ds_read_b128 v[48:51], v20 offset:256
    v_mfma_f32_16x16x32_bf16 v[180:183], v[124:127], v[128:131], v[180:183]
    buffer_load_dwordx4 a[112:115], v4, s[40:43], s17 offen offset:3072 sc1
    v_mfma_f32_16x16x32_bf16 v[180:183], v[116:119], v[136:139], v[180:183]
    ds_read_b64 v[52:53], v19 offset:3328
    v_mfma_f32_16x16x32_bf16 v[184:187], v[124:127], v[136:139], v[184:187]
    ds_read_b64 v[54:55], v19 offset:3336
    ds_read_b128 v[56:59], v20 offset:768
    v_mfma_f32_16x16x32_bf16 v[180:183], v[132:135], v[120:123], v[180:183]
    ds_read_b64 v[60:61], v19 offset:2816
    v_mfma_f32_16x16x32_bf16 v[184:187], v[132:135], v[128:131], v[184:187]
    ds_read_b64 v[62:63], v19 offset:2824
    v_mfma_f32_16x16x32_bf16 v[188:191], v[132:135], v[136:139], v[188:191]
    ds_read_b128 v[64:67], v20 offset:1280
    v_mfma_f32_16x16x32_bf16 v[180:183], v[108:111], v[144:147], v[180:183]
    s_add_u32 s3, s17, 4096
    v_mfma_f32_16x16x32_bf16 v[184:187], v[116:119], v[144:147], v[184:187]
    ds_read_b64 v[68:69], v19 offset:2304
    v_mfma_f32_16x16x32_bf16 v[188:191], v[124:127], v[144:147], v[188:191]
    ds_read_b64 v[70:71], v19 offset:2312
    ds_read_b128 v[72:75], v20 offset:1792
    v_mfma_f32_16x16x32_bf16 v[192:195], v[132:135], v[144:147], v[192:195]
    ds_read_b64 v[76:77], v19 offset:1792
    v_mfma_f32_16x16x32_bf16 v[180:183], v[140:143], v[112:115], v[180:183]
    ds_read_b64 v[78:79], v19 offset:1800
    v_mfma_f32_16x16x32_bf16 v[184:187], v[140:143], v[120:123], v[184:187]
    ds_read_b128 v[80:83], v20 offset:2304
    v_mfma_f32_16x16x32_bf16 v[188:191], v[140:143], v[128:131], v[188:191]
    buffer_load_dwordx4 a[116:119], v4, s[40:43], s3 offen offset:0 sc1
    v_mfma_f32_16x16x32_bf16 v[192:195], v[140:143], v[136:139], v[192:195]
    ds_read_b64 v[84:85], v19 offset:1280
    v_mfma_f32_16x16x32_bf16 v[184:187], v[108:111], v[152:155], v[184:187]
    ds_read_b64 v[86:87], v19 offset:1288
    ds_read_b128 v[88:91], v20 offset:2816
    v_mfma_f32_16x16x32_bf16 v[188:191], v[116:119], v[152:155], v[188:191]
    ds_read_b64 v[92:93], v19 offset:768
    v_mfma_f32_16x16x32_bf16 v[192:195], v[124:127], v[152:155], v[192:195]
    ds_read_b64 v[94:95], v19 offset:776
    v_mfma_f32_16x16x32_bf16 v[184:187], v[148:151], v[112:115], v[184:187]
    ds_read_b128 v[96:99], v20 offset:3328
    v_mfma_f32_16x16x32_bf16 v[188:191], v[148:151], v[120:123], v[188:191]
    buffer_load_dwordx4 a[120:123], v4, s[40:43], s3 offen offset:1024 sc1
    v_mfma_f32_16x16x32_bf16 v[192:195], v[148:151], v[128:131], v[192:195]
    ds_read_b64 v[100:101], v19 offset:256
    v_mfma_f32_16x16x32_bf16 v[188:191], v[108:111], v[160:163], v[188:191]
    ds_read_b64 v[102:103], v19 offset:264
    ds_read_b128 v[104:107], v20 offset:3840
    v_mfma_f32_16x16x32_bf16 v[192:195], v[116:119], v[160:163], v[192:195]
    v_mfma_f32_16x16x32_bf16 v[188:191], v[156:159], v[112:115], v[188:191]
    v_mfma_f32_16x16x32_bf16 v[192:195], v[156:159], v[120:123], v[192:195]
    buffer_load_dwordx4 a[124:127], v4, s[40:43], s3 offen offset:2048 sc1
    v_mfma_f32_16x16x32_bf16 v[192:195], v[108:111], v[168:171], v[192:195]
    v_mfma_f32_16x16x32_bf16 v[192:195], v[164:167], v[112:115], v[192:195]
    buffer_load_dwordx4 a[128:131], v4, s[40:43], s3 offen offset:3072 sc1
    s_waitcnt lgkmcnt(0)
    v_mfma_f32_16x16x32_bf16 v[172:175], v[44:47], v[48:51], v[172:175]
    ds_read_b64 v[108:109], v19 offset:3904
    v_mfma_f32_16x16x32_bf16 v[176:179], v[44:47], v[56:59], v[176:179]
    ds_read_b64 v[110:111], v19 offset:3912
    v_mfma_f32_16x16x32_bf16 v[176:179], v[52:55], v[48:51], v[176:179]
    s_add_u32 s3, s17, 8192
    v_mfma_f32_16x16x32_bf16 v[180:183], v[60:63], v[64:67], v[180:183]
    ds_read_b128 v[112:115], v20 offset:320
    v_mfma_f32_16x16x32_bf16 v[180:183], v[52:55], v[72:75], v[180:183]
    ds_read_b64 v[116:117], v19 offset:3392
    ds_read_b64 v[118:119], v19 offset:3400
    v_mfma_f32_16x16x32_bf16 v[184:187], v[60:63], v[72:75], v[184:187]
    ds_read_b128 v[120:123], v20 offset:832
    v_mfma_f32_16x16x32_bf16 v[180:183], v[68:71], v[56:59], v[180:183]
    ds_read_b64 v[124:125], v19 offset:2880
    v_mfma_f32_16x16x32_bf16 v[184:187], v[68:71], v[64:67], v[184:187]
    buffer_load_dwordx4 a[132:135], v4, s[40:43], s3 offen offset:0 sc1
    v_mfma_f32_16x16x32_bf16 v[188:191], v[68:71], v[72:75], v[188:191]
    ds_read_b64 v[126:127], v19 offset:2888
    v_mfma_f32_16x16x32_bf16 v[180:183], v[44:47], v[80:83], v[180:183]
    ds_read_b128 v[128:131], v20 offset:1344
    ds_read_b64 v[132:133], v19 offset:2368
    v_mfma_f32_16x16x32_bf16 v[184:187], v[52:55], v[80:83], v[184:187]
    ds_read_b64 v[134:135], v19 offset:2376
    v_mfma_f32_16x16x32_bf16 v[188:191], v[60:63], v[80:83], v[188:191]
    ds_read_b128 v[136:139], v20 offset:1856
    v_mfma_f32_16x16x32_bf16 v[192:195], v[68:71], v[80:83], v[192:195]
    buffer_load_dwordx4 a[136:139], v4, s[40:43], s3 offen offset:1024 sc1
    v_mfma_f32_16x16x32_bf16 v[180:183], v[76:79], v[48:51], v[180:183]
    ds_read_b64 v[140:141], v19 offset:1856
    v_mfma_f32_16x16x32_bf16 v[184:187], v[76:79], v[56:59], v[184:187]
    ds_read_b64 v[142:143], v19 offset:1864
    ds_read_b128 v[144:147], v20 offset:2368
    v_mfma_f32_16x16x32_bf16 v[188:191], v[76:79], v[64:67], v[188:191]
    ds_read_b64 v[148:149], v19 offset:1344
    v_mfma_f32_16x16x32_bf16 v[192:195], v[76:79], v[72:75], v[192:195]
    ds_read_b64 v[150:151], v19 offset:1352
    v_mfma_f32_16x16x32_bf16 v[184:187], v[44:47], v[88:91], v[184:187]
    buffer_load_dwordx4 a[140:143], v4, s[40:43], s3 offen offset:2048 sc1
    v_mfma_f32_16x16x32_bf16 v[188:191], v[52:55], v[88:91], v[188:191]
    ds_read_b128 v[152:155], v20 offset:2880
    v_mfma_f32_16x16x32_bf16 v[192:195], v[60:63], v[88:91], v[192:195]
    ds_read_b64 v[156:157], v19 offset:832
    ds_read_b64 v[158:159], v19 offset:840
    v_mfma_f32_16x16x32_bf16 v[184:187], v[84:87], v[48:51], v[184:187]
    ds_read_b128 v[160:163], v20 offset:3392
    v_mfma_f32_16x16x32_bf16 v[188:191], v[84:87], v[56:59], v[188:191]
    ds_read_b64 v[164:165], v19 offset:320
    v_mfma_f32_16x16x32_bf16 v[192:195], v[84:87], v[64:67], v[192:195]
    buffer_load_dwordx4 a[144:147], v4, s[40:43], s3 offen offset:3072 sc1
    v_mfma_f32_16x16x32_bf16 v[188:191], v[44:47], v[96:99], v[188:191]
    ds_read_b64 v[166:167], v19 offset:328
    ds_read_b128 v[168:171], v20 offset:3904
    v_mfma_f32_16x16x32_bf16 v[192:195], v[52:55], v[96:99], v[192:195]
    v_mfma_f32_16x16x32_bf16 v[188:191], v[92:95], v[48:51], v[188:191]
    v_mfma_f32_16x16x32_bf16 v[192:195], v[92:95], v[56:59], v[192:195]
    s_add_u32 s3, s17, 12288
    v_mfma_f32_16x16x32_bf16 v[192:195], v[44:47], v[104:107], v[192:195]
    v_mfma_f32_16x16x32_bf16 v[192:195], v[100:103], v[48:51], v[192:195]
    buffer_load_dwordx4 a[148:151], v4, s[40:43], s3 offen offset:0 sc1
    s_waitcnt lgkmcnt(0)
    v_mfma_f32_16x16x32_bf16 v[172:175], v[108:111], v[112:115], v[172:175]
    ds_read_b64 v[44:45], v19 offset:3968
    v_mfma_f32_16x16x32_bf16 v[176:179], v[108:111], v[120:123], v[176:179]
    ds_read_b64 v[46:47], v19 offset:3976
    v_mfma_f32_16x16x32_bf16 v[176:179], v[116:119], v[112:115], v[176:179]
    ds_read_b128 v[48:51], v20 offset:384
    v_mfma_f32_16x16x32_bf16 v[180:183], v[124:127], v[128:131], v[180:183]
    buffer_load_dwordx4 a[152:155], v4, s[40:43], s3 offen offset:1024 sc1
    v_mfma_f32_16x16x32_bf16 v[180:183], v[116:119], v[136:139], v[180:183]
    ds_read_b64 v[52:53], v19 offset:3456
    v_mfma_f32_16x16x32_bf16 v[184:187], v[124:127], v[136:139], v[184:187]
    ds_read_b64 v[54:55], v19 offset:3464
    ds_read_b128 v[56:59], v20 offset:896
    v_mfma_f32_16x16x32_bf16 v[180:183], v[132:135], v[120:123], v[180:183]
    ds_read_b64 v[60:61], v19 offset:2944
    v_mfma_f32_16x16x32_bf16 v[184:187], v[132:135], v[128:131], v[184:187]
    ds_read_b64 v[62:63], v19 offset:2952
    v_mfma_f32_16x16x32_bf16 v[188:191], v[132:135], v[136:139], v[188:191]
    ds_read_b128 v[64:67], v20 offset:1408
    v_mfma_f32_16x16x32_bf16 v[180:183], v[108:111], v[144:147], v[180:183]
    buffer_load_dwordx4 a[156:159], v4, s[40:43], s3 offen offset:2048 sc1
    v_mfma_f32_16x16x32_bf16 v[184:187], v[116:119], v[144:147], v[184:187]
    ds_read_b64 v[68:69], v19 offset:2432
    v_mfma_f32_16x16x32_bf16 v[188:191], v[124:127], v[144:147], v[188:191]
    ds_read_b64 v[70:71], v19 offset:2440
    ds_read_b128 v[72:75], v20 offset:1920
    v_mfma_f32_16x16x32_bf16 v[192:195], v[132:135], v[144:147], v[192:195]
    ds_read_b64 v[76:77], v19 offset:1920
    v_mfma_f32_16x16x32_bf16 v[180:183], v[140:143], v[112:115], v[180:183]
    ds_read_b64 v[78:79], v19 offset:1928
    v_mfma_f32_16x16x32_bf16 v[184:187], v[140:143], v[120:123], v[184:187]
    ds_read_b128 v[80:83], v20 offset:2432
    v_mfma_f32_16x16x32_bf16 v[188:191], v[140:143], v[128:131], v[188:191]
    buffer_load_dwordx4 a[160:163], v4, s[40:43], s3 offen offset:3072 sc1
    v_mfma_f32_16x16x32_bf16 v[192:195], v[140:143], v[136:139], v[192:195]
    ds_read_b64 v[84:85], v19 offset:1408
    v_mfma_f32_16x16x32_bf16 v[184:187], v[108:111], v[152:155], v[184:187]
    ds_read_b64 v[86:87], v19 offset:1416
    ds_read_b128 v[88:91], v20 offset:2944
    v_mfma_f32_16x16x32_bf16 v[188:191], v[116:119], v[152:155], v[188:191]
    ds_read_b64 v[92:93], v19 offset:896
    v_mfma_f32_16x16x32_bf16 v[192:195], v[124:127], v[152:155], v[192:195]
    ds_read_b64 v[94:95], v19 offset:904
    v_mfma_f32_16x16x32_bf16 v[184:187], v[148:151], v[112:115], v[184:187]
    ds_read_b128 v[96:99], v20 offset:3456
    v_mfma_f32_16x16x32_bf16 v[188:191], v[148:151], v[120:123], v[188:191]
    s_add_u32 s3, s17, 16384
    v_mfma_f32_16x16x32_bf16 v[192:195], v[148:151], v[128:131], v[192:195]
    ds_read_b64 v[100:101], v19 offset:384
    v_mfma_f32_16x16x32_bf16 v[188:191], v[108:111], v[160:163], v[188:191]
    ds_read_b64 v[102:103], v19 offset:392
    ds_read_b128 v[104:107], v20 offset:3968
    v_mfma_f32_16x16x32_bf16 v[192:195], v[116:119], v[160:163], v[192:195]
    v_mfma_f32_16x16x32_bf16 v[188:191], v[156:159], v[112:115], v[188:191]
    v_mfma_f32_16x16x32_bf16 v[192:195], v[156:159], v[120:123], v[192:195]
    buffer_load_dwordx4 a[164:167], v4, s[40:43], s3 offen offset:0 sc1
    v_mfma_f32_16x16x32_bf16 v[192:195], v[108:111], v[168:171], v[192:195]
    v_mfma_f32_16x16x32_bf16 v[192:195], v[164:167], v[112:115], v[192:195]
    buffer_load_dwordx4 a[168:171], v4, s[40:43], s3 offen offset:1024 sc1
    s_waitcnt lgkmcnt(0)
    v_mfma_f32_16x16x32_bf16 v[172:175], v[44:47], v[48:51], v[172:175]
    ds_read_b64 v[108:109], v19 offset:4032
    v_mfma_f32_16x16x32_bf16 v[176:179], v[44:47], v[56:59], v[176:179]
    ds_read_b64 v[110:111], v19 offset:4040
    v_mfma_f32_16x16x32_bf16 v[176:179], v[52:55], v[48:51], v[176:179]
    ds_read_b128 v[112:115], v20 offset:448
    v_mfma_f32_16x16x32_bf16 v[180:183], v[60:63], v[64:67], v[180:183]
    buffer_load_dwordx4 a[172:175], v4, s[40:43], s3 offen offset:2048 sc1
    v_mfma_f32_16x16x32_bf16 v[180:183], v[52:55], v[72:75], v[180:183]
    ds_read_b64 v[116:117], v19 offset:3520
    v_mfma_f32_16x16x32_bf16 v[184:187], v[60:63], v[72:75], v[184:187]
    ds_read_b64 v[118:119], v19 offset:3528
    ds_read_b128 v[120:123], v20 offset:960
    v_mfma_f32_16x16x32_bf16 v[180:183], v[68:71], v[56:59], v[180:183]
    ds_read_b64 v[124:125], v19 offset:3008
    v_mfma_f32_16x16x32_bf16 v[184:187], v[68:71], v[64:67], v[184:187]
    ds_read_b64 v[126:127], v19 offset:3016
    v_mfma_f32_16x16x32_bf16 v[188:191], v[68:71], v[72:75], v[188:191]
    ds_read_b128 v[128:131], v20 offset:1472
    v_mfma_f32_16x16x32_bf16 v[180:183], v[44:47], v[80:83], v[180:183]
    buffer_load_dwordx4 a[176:179], v4, s[40:43], s3 offen offset:3072 sc1
    v_mfma_f32_16x16x32_bf16 v[184:187], v[52:55], v[80:83], v[184:187]
    ds_read_b64 v[132:133], v19 offset:2496
    v_mfma_f32_16x16x32_bf16 v[188:191], v[60:63], v[80:83], v[188:191]
    ds_read_b64 v[134:135], v19 offset:2504
    ds_read_b128 v[136:139], v20 offset:1984
    v_mfma_f32_16x16x32_bf16 v[192:195], v[68:71], v[80:83], v[192:195]
    ds_read_b64 v[140:141], v19 offset:1984
    v_mfma_f32_16x16x32_bf16 v[180:183], v[76:79], v[48:51], v[180:183]
    ds_read_b64 v[142:143], v19 offset:1992
    v_mfma_f32_16x16x32_bf16 v[184:187], v[76:79], v[56:59], v[184:187]
    ds_read_b128 v[144:147], v20 offset:2496
    v_mfma_f32_16x16x32_bf16 v[188:191], v[76:79], v[64:67], v[188:191]
    s_add_u32 s3, s17, 20480
    v_mfma_f32_16x16x32_bf16 v[192:195], v[76:79], v[72:75], v[192:195]
    ds_read_b64 v[148:149], v19 offset:1472
    v_mfma_f32_16x16x32_bf16 v[184:187], v[44:47], v[88:91], v[184:187]
    ds_read_b64 v[150:151], v19 offset:1480
    ds_read_b128 v[152:155], v20 offset:3008
    v_mfma_f32_16x16x32_bf16 v[188:191], v[52:55], v[88:91], v[188:191]
    ds_read_b64 v[156:157], v19 offset:960
    v_mfma_f32_16x16x32_bf16 v[192:195], v[60:63], v[88:91], v[192:195]
    ds_read_b64 v[158:159], v19 offset:968
    v_mfma_f32_16x16x32_bf16 v[184:187], v[84:87], v[48:51], v[184:187]
    ds_read_b128 v[160:163], v20 offset:3520
    v_mfma_f32_16x16x32_bf16 v[188:191], v[84:87], v[56:59], v[188:191]
    buffer_load_dwordx4 a[180:183], v4, s[40:43], s3 offen offset:0 sc1
    v_mfma_f32_16x16x32_bf16 v[192:195], v[84:87], v[64:67], v[192:195]
    ds_read_b64 v[164:165], v19 offset:448
    v_mfma_f32_16x16x32_bf16 v[188:191], v[44:47], v[96:99], v[188:191]
    ds_read_b64 v[166:167], v19 offset:456
    ds_read_b128 v[168:171], v20 offset:4032
    v_mfma_f32_16x16x32_bf16 v[192:195], v[52:55], v[96:99], v[192:195]
    v_mfma_f32_16x16x32_bf16 v[188:191], v[92:95], v[48:51], v[188:191]
    v_mfma_f32_16x16x32_bf16 v[192:195], v[92:95], v[56:59], v[192:195]
    buffer_load_dwordx4 a[184:187], v4, s[40:43], s3 offen offset:1024 sc1
    v_mfma_f32_16x16x32_bf16 v[192:195], v[44:47], v[104:107], v[192:195]
    v_mfma_f32_16x16x32_bf16 v[192:195], v[100:103], v[48:51], v[192:195]
    buffer_load_dwordx4 a[188:191], v4, s[40:43], s3 offen offset:2048 sc1
    s_waitcnt lgkmcnt(0)
    v_mfma_f32_16x16x32_bf16 v[172:175], v[108:111], v[112:115], v[172:175]
    v_mfma_f32_16x16x32_bf16 v[176:179], v[108:111], v[120:123], v[176:179]
    v_mfma_f32_16x16x32_bf16 v[176:179], v[116:119], v[112:115], v[176:179]
    v_mfma_f32_16x16x32_bf16 v[180:183], v[124:127], v[128:131], v[180:183]
    v_mfma_f32_16x16x32_bf16 v[180:183], v[116:119], v[136:139], v[180:183]
    v_mfma_f32_16x16x32_bf16 v[184:187], v[124:127], v[136:139], v[184:187]
    buffer_load_dwordx4 a[192:195], v4, s[40:43], s3 offen offset:3072 sc1
    v_mfma_f32_16x16x32_bf16 v[180:183], v[132:135], v[120:123], v[180:183]
    v_mfma_f32_16x16x32_bf16 v[184:187], v[132:135], v[128:131], v[184:187]
    v_mfma_f32_16x16x32_bf16 v[188:191], v[132:135], v[136:139], v[188:191]
    v_mfma_f32_16x16x32_bf16 v[180:183], v[108:111], v[144:147], v[180:183]
    v_mfma_f32_16x16x32_bf16 v[184:187], v[116:119], v[144:147], v[184:187]
    v_mfma_f32_16x16x32_bf16 v[188:191], v[124:127], v[144:147], v[188:191]
    s_add_u32 s3, s17, 24576
    v_mfma_f32_16x16x32_bf16 v[192:195], v[132:135], v[144:147], v[192:195]
    v_mfma_f32_16x16x32_bf16 v[180:183], v[140:143], v[112:115], v[180:183]
    v_mfma_f32_16x16x32_bf16 v[184:187], v[140:143], v[120:123], v[184:187]
    v_mfma_f32_16x16x32_bf16 v[188:191], v[140:143], v[128:131], v[188:191]
    v_mfma_f32_16x16x32_bf16 v[192:195], v[140:143], v[136:139], v[192:195]
    v_mfma_f32_16x16x32_bf16 v[184:187], v[108:111], v[152:155], v[184:187]
    buffer_load_dwordx4 a[196:199], v4, s[40:43], s3 offen offset:0 sc1
    v_mfma_f32_16x16x32_bf16 v[188:191], v[116:119], v[152:155], v[188:191]
    v_mfma_f32_16x16x32_bf16 v[192:195], v[124:127], v[152:155], v[192:195]
    v_mfma_f32_16x16x32_bf16 v[184:187], v[148:151], v[112:115], v[184:187]
    v_mfma_f32_16x16x32_bf16 v[188:191], v[148:151], v[120:123], v[188:191]
    v_mfma_f32_16x16x32_bf16 v[192:195], v[148:151], v[128:131], v[192:195]
    v_mfma_f32_16x16x32_bf16 v[188:191], v[108:111], v[160:163], v[188:191]
    buffer_load_dwordx4 a[200:203], v4, s[40:43], s18 offen offset:0 sc1
    v_mfma_f32_16x16x32_bf16 v[192:195], v[116:119], v[160:163], v[192:195]
    v_mfma_f32_16x16x32_bf16 v[188:191], v[156:159], v[112:115], v[188:191]
    v_mfma_f32_16x16x32_bf16 v[192:195], v[156:159], v[120:123], v[192:195]
    buffer_load_dwordx4 a[204:207], v4, s[40:43], s18 offen offset:1024 sc1
    v_mfma_f32_16x16x32_bf16 v[192:195], v[108:111], v[168:171], v[192:195]
    v_mfma_f32_16x16x32_bf16 v[192:195], v[164:167], v[112:115], v[192:195]
    buffer_load_dwordx4 a[208:211], v4, s[40:43], s18 offen offset:2048 sc1
    s_branch L_CD
L_C2:
    s_cmp_ge_u32 s26, 24576
    s_cbranch_scc1 L_C2E
L_C2L:
    s_cmp_ge_u32 s4, 680
    s_cbranch_scc1 L_SJEc
    s_cmp_ge_u32 s4, 100
    s_cbranch_scc1 L_Pjc1
    s_sub_u32 s6, s4, 0
    s_mul_i32 s5, s6, 13108
    s_lshr_b32 s5, s5, 16
    s_mul_i32 s39, s5, 5
    s_sub_u32 s6, s6, s39
    s_mov_b32 s8, 5
    s_mov_b32 s9, 100
    s_mov_b32 s10, 6291456
    s_mov_b32 s11, 13108
    s_branch L_PCjc
L_Pjc1:
    s_cmp_ge_u32 s4, 200
    s_cbranch_scc1 L_Pjc2
    s_sub_u32 s6, s4, 100
    s_mul_i32 s5, s6, 13108
    s_lshr_b32 s5, s5, 16
    s_mul_i32 s39, s5, 5
    s_sub_u32 s6, s6, s39
    s_mov_b32 s8, 5
    s_mov_b32 s9, 100
    s_mov_b32 s10, 7110656
    s_mov_b32 s11, 13108
    s_branch L_PCjc
L_Pjc2:
    s_cmp_ge_u32 s4, 440
    s_cbranch_scc1 L_Pjc3
    s_sub_u32 s6, s4, 200
    s_mul_i32 s5, s6, 5462
    s_lshr_b32 s5, s5, 16
    s_mul_i32 s39, s5, 12
    s_sub_u32 s6, s6, s39
    s_mov_b32 s8, 3
    s_mov_b32 s9, 60
    s_mov_b32 s10, 7929856
    s_mov_b32 s11, 21846
    s_branch L_PCjc
L_Pjc3:
    s_sub_u32 s6, s4, 440
    s_mul_i32 s5, s6, 13108
    s_lshr_b32 s5, s5, 16
    s_mul_i32 s39, s5, 5
    s_sub_u32 s6, s6, s39
    s_mov_b32 s8, 5
    s_mov_b32 s9, 240
    s_mov_b32 s10, 9895936
    s_mov_b32 s11, 13108
L_PCjc:
    s_mul_i32 s5, s5, s8
    s_lshl_b32 s6, s6, 3
    s_add_u32 s39, s26, 112896
    v_add_u32 v65, s39, v28
    s_mul_i32 s59, s6, s11
    s_lshr_b32 s59, s59, 16
    s_mul_i32 s60, s59, s8
    s_sub_u32 s60, s6, s60
    s_mul_i32 s59, s59, s9
    s_add_u32 s39, s60, s59
    s_add_u32 s39, s39, s5
    s_lshl_b32 s39, s39, 10
    s_add_u32 s39, s39, s10
    s_sub_u32 s59, s9, s8
    s_add_u32 s59, s59, 1
    s_lshl_b32 s59, s59, 10
    v_xor_b32 v5, 0, v65
    ds_read_b64_tr_b16 v[72:73], v5
    ds_read_b64_tr_b16 v[74:75], v5 offset:4096
    v_xor_b32 v5, 32, v65
    ds_read_b64_tr_b16 v[76:77], v5
    ds_read_b64_tr_b16 v[78:79], v5 offset:4096
    v_xor_b32 v5, 64, v65
    ds_read_b64_tr_b16 v[80:81], v5
    ds_read_b64_tr_b16 v[82:83], v5 offset:4096
    v_xor_b32 v5, 96, v65
    ds_read_b64_tr_b16 v[84:85], v5
    ds_read_b64_tr_b16 v[86:87], v5 offset:4096
    v_xor_b32 v5, 128, v65
    ds_read_b64_tr_b16 v[88:89], v5
    ds_read_b64_tr_b16 v[90:91], v5 offset:4096
    v_xor_b32 v5, 160, v65
    ds_read_b64_tr_b16 v[92:93], v5
    ds_read_b64_tr_b16 v[94:95], v5 offset:4096
    s_waitcnt lgkmcnt(10)
    buffer_store_dwordx4 v[72:75], v4, s[40:43], s39 offen sc1
    v_xor_b32 v5, 192, v65
    ds_read_b64_tr_b16 v[96:97], v5
    ds_read_b64_tr_b16 v[98:99], v5 offset:4096
    s_add_u32 s60, s60, 1
    s_cmp_eq_u32 s60, s8
    s_cselect_b32 s61, s59, 1024
    s_cselect_b32 s60, 0, s60
    s_add_u32 s39, s39, s61
    s_waitcnt lgkmcnt(10)
    buffer_store_dwordx4 v[76:79], v4, s[40:43], s39 offen sc1
    v_xor_b32 v5, 224, v65
    ds_read_b64_tr_b16 v[100:101], v5
    ds_read_b64_tr_b16 v[102:103], v5 offset:4096
    s_add_u32 s60, s60, 1
    s_cmp_eq_u32 s60, s8
    s_cselect_b32 s61, s59, 1024
    s_cselect_b32 s60, 0, s60
    s_add_u32 s39, s39, s61
    s_waitcnt lgkmcnt(10)
    buffer_store_dwordx4 v[80:83], v4, s[40:43], s39 offen sc1
    s_add_u32 s60, s60, 1
    s_cmp_eq_u32 s60, s8
    s_cselect_b32 s61, s59, 1024
    s_cselect_b32 s60, 0, s60
    s_add_u32 s39, s39, s61
    s_waitcnt lgkmcnt(8)
    buffer_store_dwordx4 v[84:87], v4, s[40:43], s39 offen sc1
    s_add_u32 s60, s60, 1
    s_cmp_eq_u32 s60, s8
    s_cselect_b32 s61, s59, 1024
    s_cselect_b32 s60, 0, s60
    s_add_u32 s39, s39, s61
    s_waitcnt lgkmcnt(6)
    buffer_store_dwordx4 v[88:91], v4, s[40:43], s39 offen sc1
    s_add_u32 s60, s60, 1
    s_cmp_eq_u32 s60, s8
    s_cselect_b32 s61, s59, 1024
    s_cselect_b32 s60, 0, s60
    s_add_u32 s39, s39, s61
    s_waitcnt lgkmcnt(4)
    buffer_store_dwordx4 v[92:95], v4, s[40:43], s39 offen sc1
    s_add_u32 s60, s60, 1
    s_cmp_eq_u32 s60, s8
    s_cselect_b32 s61, s59, 1024
    s_cselect_b32 s60, 0, s60
    s_add_u32 s39, s39, s61
    s_waitcnt lgkmcnt(2)
    buffer_store_dwordx4 v[96:99], v4, s[40:43], s39 offen sc1
    s_add_u32 s60, s60, 1
    s_cmp_eq_u32 s60, s8
    s_cselect_b32 s61, s59, 1024
    s_cselect_b32 s60, 0, s60
    s_add_u32 s39, s39, s61
    s_waitcnt lgkmcnt(0)
    buffer_store_dwordx4 v[100:103], v4, s[40:43], s39 offen sc1
L_SJEc:
    s_add_u32 s4, s4, 1
    s_add_u32 s26, s26, 8192
    s_cmp_lt_u32 s26, 24576
    s_cbranch_scc1 L_C2L
L_C2E:
    s_add_u32 s3, s16, 12288
    buffer_load_dwordx4 a[52:55], v4, s[40:43], s3 offen offset:1024 sc1
    buffer_load_dwordx4 a[56:59], v4, s[40:43], s3 offen offset:2048 sc1
    buffer_load_dwordx4 a[60:63], v4, s[40:43], s3 offen offset:3072 sc1
    s_add_u32 s3, s16, 16384
    buffer_load_dwordx4 a[64:67], v4, s[40:43], s3 offen offset:0 sc1
    buffer_load_dwordx4 a[68:71], v4, s[40:43], s3 offen offset:1024 sc1
    buffer_load_dwordx4 a[72:75], v4, s[40:43], s3 offen offset:2048 sc1
    buffer_load_dwordx4 a[76:79], v4, s[40:43], s3 offen offset:3072 sc1
    s_add_u32 s3, s16, 20480
    buffer_load_dwordx4 a[80:83], v4, s[40:43], s3 offen offset:0 sc1
    buffer_load_dwordx4 a[84:87], v4, s[40:43], s3 offen offset:1024 sc1
    buffer_load_dwordx4 a[88:91], v4, s[40:43], s3 offen offset:2048 sc1
    buffer_load_dwordx4 a[92:95], v4, s[40:43], s3 offen offset:3072 sc1
    s_add_u32 s3, s16, 24576
    buffer_load_dwordx4 a[96:99], v4, s[40:43], s3 offen offset:0 sc1
    buffer_load_dwordx4 a[100:103], v4, s[40:43], s17 offen offset:0 sc1
    buffer_load_dwordx4 a[104:107], v4, s[40:43], s17 offen offset:1024 sc1
    buffer_load_dwordx4 a[108:111], v4, s[40:43], s17 offen offset:2048 sc1
    buffer_load_dwordx4 a[112:115], v4, s[40:43], s17 offen offset:3072 sc1
    s_add_u32 s3, s17, 4096
    buffer_load_dwordx4 a[116:119], v4, s[40:43], s3 offen offset:0 sc1
    buffer_load_dwordx4 a[120:123], v4, s[40:43], s3 offen offset:1024 sc1
    buffer_load_dwordx4 a[124:127], v4, s[40:43], s3 offen offset:2048 sc1
    buffer_load_dwordx4 a[128:131], v4, s[40:43], s3 offen offset:3072 sc1
    s_add_u32 s3, s17, 8192
    buffer_load_dwordx4 a[132:135], v4, s[40:43], s3 offen offset:0 sc1
    buffer_load_dwordx4 a[136:139], v4, s[40:43], s3 offen offset:1024 sc1
    buffer_load_dwordx4 a[140:143], v4, s[40:43], s3 offen offset:2048 sc1
    buffer_load_dwordx4 a[144:147], v4, s[40:43], s3 offen offset:3072 sc1
    s_add_u32 s3, s17, 12288
    buffer_load_dwordx4 a[148:151], v4, s[40:43], s3 offen offset:0 sc1
    buffer_load_dwordx4 a[152:155], v4, s[40:43], s3 offen offset:1024 sc1
    buffer_load_dwordx4 a[156:159], v4, s[40:43], s3 offen offset:2048 sc1
    buffer_load_dwordx4 a[160:163], v4, s[40:43], s3 offen offset:3072 sc1
    s_add_u32 s3, s17, 16384
    buffer_load_dwordx4 a[164:167], v4, s[40:43], s3 offen offset:0 sc1
    buffer_load_dwordx4 a[168:171], v4, s[40:43], s3 offen offset:1024 sc1
    buffer_load_dwordx4 a[172:175], v4, s[40:43], s3 offen offset:2048 sc1
    buffer_load_dwordx4 a[176:179], v4, s[40:43], s3 offen offset:3072 sc1
    s_add_u32 s3, s17, 20480
    buffer_load_dwordx4 a[180:183], v4, s[40:43], s3 offen offset:0 sc1
    buffer_load_dwordx4 a[184:187], v4, s[40:43], s3 offen offset:1024 sc1
    buffer_load_dwordx4 a[188:191], v4, s[40:43], s3 offen offset:2048 sc1
    buffer_load_dwordx4 a[192:195], v4, s[40:43], s3 offen offset:3072 sc1
    s_add_u32 s3, s17, 24576
    buffer_load_dwordx4 a[196:199], v4, s[40:43], s3 offen offset:0 sc1
    buffer_load_dwordx4 a[200:203], v4, s[40:43], s18 offen offset:0 sc1
    buffer_load_dwordx4 a[204:207], v4, s[40:43], s18 offen offset:1024 sc1
    buffer_load_dwordx4 a[208:211], v4, s[40:43], s18 offen offset:2048 sc1
    s_branch L_CD
L_C3:
    ds_read_b64 v[44:45], v19 offset:3584
    ds_read_b64 v[46:47], v19 offset:3592
    ds_read_b128 v[48:51], v20 offset:0
    ds_read_b64 v[52:53], v19 offset:3072
    ds_read_b64 v[54:55], v19 offset:3080
    ds_read_b128 v[56:59], v20 offset:512
    ds_read_b64 v[60:61], v19 offset:2560
    ds_read_b64 v[62:63], v19 offset:2568
    ds_read_b128 v[64:67], v20 offset:1024
    ds_read_b64 v[68:69], v19 offset:2048
    ds_read_b64 v[70:71], v19 offset:2056
    ds_read_b128 v[72:75], v20 offset:1536
    ds_read_b64 v[76:77], v19 offset:3648
    ds_read_b64 v[78:79], v19 offset:3656
    ds_read_b128 v[80:83], v20 offset:64
    s_waitcnt lgkmcnt(14)
    ds_read_b64 v[84:85], v19 offset:3136
    s_waitcnt lgkmcnt(14)
    ds_read_b64 v[86:87], v19 offset:3144
    s_waitcnt lgkmcnt(14)
    ds_read_b128 v[88:91], v20 offset:576
    s_waitcnt lgkmcnt(14)
    ds_read_b64 v[92:93], v19 offset:2624
    s_waitcnt lgkmcnt(14)
    ds_read_b64 v[94:95], v19 offset:2632
    s_waitcnt lgkmcnt(14)
    ds_read_b128 v[96:99], v20 offset:1088
    s_waitcnt lgkmcnt(14)
    ds_read_b64 v[100:101], v19 offset:2112
    s_waitcnt lgkmcnt(14)
    ds_read_b64 v[102:103], v19 offset:2120
    s_waitcnt lgkmcnt(14)
    ds_read_b128 v[104:107], v20 offset:1600
    v_mfma_f32_16x16x32_bf16 v[172:175], v[52:55], v[56:59], 0
    s_waitcnt lgkmcnt(14)
    ds_read_b64 v[108:109], v19 offset:3712
    s_waitcnt lgkmcnt(14)
    ds_read_b64 v[110:111], v19 offset:3720
    v_mfma_f32_16x16x32_bf16 v[172:175], v[44:47], v[64:67], v[172:175]
    s_add_u32 s3, s16, 12288
    s_waitcnt lgkmcnt(14)
    ds_read_b128 v[112:115], v20 offset:128
    v_mfma_f32_16x16x32_bf16 v[176:179], v[52:55], v[64:67], 0
    s_waitcnt lgkmcnt(14)
    ds_read_b64 v[116:117], v19 offset:3200
    s_waitcnt lgkmcnt(14)
    ds_read_b64 v[118:119], v19 offset:3208
    v_mfma_f32_16x16x32_bf16 v[172:175], v[60:63], v[48:51], v[172:175]
    s_waitcnt lgkmcnt(14)
    ds_read_b128 v[120:123], v20 offset:640
    buffer_load_dwordx4 a[52:55], v4, s[40:43], s3 offen offset:1024 sc1
    v_mfma_f32_16x16x32_bf16 v[176:179], v[60:63], v[56:59], v[176:179]
    s_waitcnt lgkmcnt(14)
    ds_read_b64 v[124:125], v19 offset:2688
    s_waitcnt lgkmcnt(14)
    ds_read_b64 v[126:127], v19 offset:2696
    v_mfma_f32_16x16x32_bf16 v[176:179], v[44:47], v[72:75], v[176:179]
    s_waitcnt lgkmcnt(14)
    ds_read_b128 v[128:131], v20 offset:1152
    s_waitcnt lgkmcnt(14)
    ds_read_b64 v[132:133], v19 offset:2176
    v_mfma_f32_16x16x32_bf16 v[176:179], v[68:71], v[48:51], v[176:179]
    buffer_load_dwordx4 a[56:59], v4, s[40:43], s3 offen offset:2048 sc1
    s_waitcnt lgkmcnt(14)
    ds_read_b64 v[134:135], v19 offset:2184
    s_waitcnt lgkmcnt(14)
    ds_read_b128 v[136:139], v20 offset:1664
    v_mfma_f32_16x16x32_bf16 v[172:175], v[84:87], v[88:91], v[172:175]
    s_waitcnt lgkmcnt(14)
    ds_read_b64 v[140:141], v19 offset:3776
    s_waitcnt lgkmcnt(14)
    ds_read_b64 v[142:143], v19 offset:3784
    v_mfma_f32_16x16x32_bf16 v[172:175], v[76:79], v[96:99], v[172:175]
    buffer_load_dwordx4 a[60:63], v4, s[40:43], s3 offen offset:3072 sc1
    s_waitcnt lgkmcnt(14)
    ds_read_b128 v[144:147], v20 offset:192
    v_mfma_f32_16x16x32_bf16 v[176:179], v[84:87], v[96:99], v[176:179]
    s_waitcnt lgkmcnt(14)
    ds_read_b64 v[148:149], v19 offset:3264
    s_waitcnt lgkmcnt(14)
    ds_read_b64 v[150:151], v19 offset:3272
    v_mfma_f32_16x16x32_bf16 v[172:175], v[92:95], v[80:83], v[172:175]
    s_waitcnt lgkmcnt(14)
    ds_read_b128 v[152:155], v20 offset:704
    s_add_u32 s3, s16, 16384
    v_mfma_f32_16x16x32_bf16 v[176:179], v[92:95], v[88:91], v[176:179]
    s_waitcnt lgkmcnt(14)
    ds_read_b64 v[156:157], v19 offset:2752
    s_waitcnt lgkmcnt(14)
    ds_read_b64 v[158:159], v19 offset:2760
    v_mfma_f32_16x16x32_bf16 v[176:179], v[76:79], v[104:107], v[176:179]
    s_waitcnt lgkmcnt(14)
    ds_read_b128 v[160:163], v20 offset:1216
    s_waitcnt lgkmcnt(14)
    ds_read_b64 v[164:165], v19 offset:2240
    v_mfma_f32_16x16x32_bf16 v[176:179], v[100:103], v[80:83], v[176:179]
    buffer_load_dwordx4 a[64:67], v4, s[40:43], s3 offen offset:0 sc1
    s_waitcnt lgkmcnt(14)
    ds_read_b64 v[166:167], v19 offset:2248
    s_waitcnt lgkmcnt(14)
    ds_read_b128 v[168:171], v20 offset:1728
    s_waitcnt lgkmcnt(6)
    v_mfma_f32_16x16x32_bf16 v[172:175], v[116:119], v[120:123], v[172:175]
    ds_read_b64 v[44:45], v19 offset:3840
    ds_read_b64 v[46:47], v19 offset:3848
    v_mfma_f32_16x16x32_bf16 v[172:175], v[108:111], v[128:131], v[172:175]
    buffer_load_dwordx4 a[68:71], v4, s[40:43], s3 offen offset:1024 sc1
    ds_read_b128 v[48:51], v20 offset:256
    v_mfma_f32_16x16x32_bf16 v[176:179], v[116:119], v[128:131], v[176:179]
    ds_read_b64 v[52:53], v19 offset:3328
    ds_read_b64 v[54:55], v19 offset:3336
    v_mfma_f32_16x16x32_bf16 v[172:175], v[124:127], v[112:115], v[172:175]
    ds_read_b128 v[56:59], v20 offset:768
    ds_read_b64 v[60:61], v19 offset:2816
    v_mfma_f32_16x16x32_bf16 v[176:179], v[124:127], v[120:123], v[176:179]
    buffer_load_dwordx4 a[72:75], v4, s[40:43], s3 offen offset:2048 sc1
    ds_read_b64 v[62:63], v19 offset:2824
    v_mfma_f32_16x16x32_bf16 v[176:179], v[108:111], v[136:139], v[176:179]
    ds_read_b128 v[64:67], v20 offset:1280
    ds_read_b64 v[68:69], v19 offset:2304
    v_mfma_f32_16x16x32_bf16 v[176:179], v[132:135], v[112:115], v[176:179]
    ds_read_b64 v[70:71], v19 offset:2312
    ds_read_b128 v[72:75], v20 offset:1792
    v_mfma_f32_16x16x32_bf16 v[172:175], v[148:151], v[152:155], v[172:175]
    buffer_load_dwordx4 a[76:79], v4, s[40:43], s3 offen offset:3072 sc1
    ds_read_b64 v[76:77], v19 offset:3904
    s_waitcnt lgkmcnt(15)
    v_mfma_f32_16x16x32_bf16 v[172:175], v[140:143], v[160:163], v[172:175]
    ds_read_b64 v[78:79], v19 offset:3912
    ds_read_b128 v[80:83], v20 offset:320
    v_mfma_f32_16x16x32_bf16 v[176:179], v[148:151], v[160:163], v[176:179]
    ds_read_b64 v[84:85], v19 offset:3392
    ds_read_b64 v[86:87], v19 offset:3400
    v_mfma_f32_16x16x32_bf16 v[172:175], v[156:159], v[144:147], v[172:175]
    s_add_u32 s3, s16, 20480
    ds_read_b128 v[88:91], v20 offset:832
    v_mfma_f32_16x16x32_bf16 v[176:179], v[156:159], v[152:155], v[176:179]
    ds_read_b64 v[92:93], v19 offset:2880
    ds_read_b64 v[94:95], v19 offset:2888
    s_waitcnt lgkmcnt(15)
    v_mfma_f32_16x16x32_bf16 v[176:179], v[140:143], v[168:171], v[176:179]
    ds_read_b128 v[96:99], v20 offset:1344
    ds_read_b64 v[100:101], v19 offset:2368
    v_mfma_f32_16x16x32_bf16 v[176:179], v[164:167], v[144:147], v[176:179]
    buffer_load_dwordx4 a[80:83], v4, s[40:43], s3 offen offset:0 sc1
    ds_read_b64 v[102:103], v19 offset:2376
    ds_read_b128 v[104:107], v20 offset:1856
    s_waitcnt lgkmcnt(6)
    v_mfma_f32_16x16x32_bf16 v[172:175], v[52:55], v[56:59], v[172:175]
    ds_read_b64 v[108:109], v19 offset:3968
    ds_read_b64 v[110:111], v19 offset:3976
    v_mfma_f32_16x16x32_bf16 v[172:175], v[44:47], v[64:67], v[172:175]
    buffer_load_dwordx4 a[84:87], v4, s[40:43], s3 offen offset:1024 sc1
    ds_read_b128 v[112:115], v20 offset:384
    v_mfma_f32_16x16x32_bf16 v[176:179], v[52:55], v[64:67], v[176:179]
    ds_read_b64 v[116:117], v19 offset:3456
    ds_read_b64 v[118:119], v19 offset:3464
    v_mfma_f32_16x16x32_bf16 v[172:175], v[60:63], v[48:51], v[172:175]
    ds_read_b128 v[120:123], v20 offset:896
    ds_read_b64 v[124:125], v19 offset:2944
    v_mfma_f32_16x16x32_bf16 v[176:179], v[60:63], v[56:59], v[176:179]
    buffer_load_dwordx4 a[88:91], v4, s[40:43], s3 offen offset:2048 sc1
    ds_read_b64 v[126:127], v19 offset:2952
    v_mfma_f32_16x16x32_bf16 v[176:179], v[44:47], v[72:75], v[176:179]
    ds_read_b128 v[128:131], v20 offset:1408
    ds_read_b64 v[132:133], v19 offset:2432
    v_mfma_f32_16x16x32_bf16 v[176:179], v[68:71], v[48:51], v[176:179]
    ds_read_b64 v[134:135], v19 offset:2440
    ds_read_b128 v[136:139], v20 offset:1920
    v_mfma_f32_16x16x32_bf16 v[172:175], v[84:87], v[88:91], v[172:175]
    buffer_load_dwordx4 a[92:95], v4, s[40:43], s3 offen offset:3072 sc1
    ds_read_b64 v[140:141], v19 offset:4032
    s_waitcnt lgkmcnt(15)
    v_mfma_f32_16x16x32_bf16 v[172:175], v[76:79], v[96:99], v[172:175]
    ds_read_b64 v[142:143], v19 offset:4040
    ds_read_b128 v[144:147], v20 offset:448
    v_mfma_f32_16x16x32_bf16 v[176:179], v[84:87], v[96:99], v[176:179]
    ds_read_b64 v[148:149], v19 offset:3520
    ds_read_b64 v[150:151], v19 offset:3528
    v_mfma_f32_16x16x32_bf16 v[172:175], v[92:95], v[80:83], v[172:175]
    s_add_u32 s3, s16, 24576
    ds_read_b128 v[152:155], v20 offset:960
    v_mfma_f32_16x16x32_bf16 v[176:179], v[92:95], v[88:91], v[176:179]
    ds_read_b64 v[156:157], v19 offset:3008
    ds_read_b64 v[158:159], v19 offset:3016
    s_waitcnt lgkmcnt(15)
    v_mfma_f32_16x16x32_bf16 v[176:179], v[76:79], v[104:107], v[176:179]
    ds_read_b128 v[160:163], v20 offset:1472
    ds_read_b64 v[164:165], v19 offset:2496
    v_mfma_f32_16x16x32_bf16 v[176:179], v[100:103], v[80:83], v[176:179]
    buffer_load_dwordx4 a[96:99], v4, s[40:43], s3 offen offset:0 sc1
    ds_read_b64 v[166:167], v19 offset:2504
    ds_read_b128 v[168:171], v20 offset:1984
    s_waitcnt lgkmcnt(6)
    v_mfma_f32_16x16x32_bf16 v[172:175], v[116:119], v[120:123], v[172:175]
    v_add_u32 v19, 45824, v19
    v_add_u32 v20, 45824, v20
    v_mfma_f32_16x16x32_bf16 v[172:175], v[108:111], v[128:131], v[172:175]
    ds_read_b64 v[44:45], v19 offset:3584
    buffer_load_dwordx4 a[100:103], v4, s[40:43], s17 offen offset:0 sc1
    v_mfma_f32_16x16x32_bf16 v[176:179], v[116:119], v[128:131], v[176:179]
    ds_read_b64 v[46:47], v19 offset:3592
    ds_read_b128 v[48:51], v20 offset:0
    v_mfma_f32_16x16x32_bf16 v[172:175], v[124:127], v[112:115], v[172:175]
    ds_read_b64 v[52:53], v19 offset:3072
    ds_read_b64 v[54:55], v19 offset:3080
    v_mfma_f32_16x16x32_bf16 v[176:179], v[124:127], v[120:123], v[176:179]
    ds_read_b128 v[56:59], v20 offset:512
    ds_read_b64 v[60:61], v19 offset:2560
    v_mfma_f32_16x16x32_bf16 v[176:179], v[108:111], v[136:139], v[176:179]
    ds_read_b64 v[62:63], v19 offset:2568
    buffer_load_dwordx4 a[104:107], v4, s[40:43], s17 offen offset:1024 sc1
    v_mfma_f32_16x16x32_bf16 v[176:179], v[132:135], v[112:115], v[176:179]
    ds_read_b128 v[64:67], v20 offset:1024
    ds_read_b64 v[68:69], v19 offset:2048
    ds_read_b64 v[70:71], v19 offset:2056
    v_mfma_f32_16x16x32_bf16 v[172:175], v[148:151], v[152:155], v[172:175]
    ds_read_b128 v[72:75], v20 offset:1536
    ds_read_b64 v[76:77], v19 offset:3648
    s_waitcnt lgkmcnt(15)
    v_mfma_f32_16x16x32_bf16 v[172:175], v[140:143], v[160:163], v[172:175]
    ds_read_b64 v[78:79], v19 offset:3656
    buffer_load_dwordx4 a[108:111], v4, s[40:43], s17 offen offset:2048 sc1
    v_mfma_f32_16x16x32_bf16 v[176:179], v[148:151], v[160:163], v[176:179]
    ds_read_b128 v[80:83], v20 offset:64
    ds_read_b64 v[84:85], v19 offset:3136
    v_mfma_f32_16x16x32_bf16 v[172:175], v[156:159], v[144:147], v[172:175]
    ds_read_b64 v[86:87], v19 offset:3144
    ds_read_b128 v[88:91], v20 offset:576
    v_mfma_f32_16x16x32_bf16 v[176:179], v[156:159], v[152:155], v[176:179]
    ds_read_b64 v[92:93], v19 offset:2624
    ds_read_b64 v[94:95], v19 offset:2632
    s_waitcnt lgkmcnt(15)
    v_mfma_f32_16x16x32_bf16 v[176:179], v[140:143], v[168:171], v[176:179]
    ds_read_b128 v[96:99], v20 offset:1088
    buffer_load_dwordx4 a[112:115], v4, s[40:43], s17 offen offset:3072 sc1
    v_mfma_f32_16x16x32_bf16 v[176:179], v[164:167], v[144:147], v[176:179]
    ds_read_b64 v[100:101], v19 offset:2112
    ds_read_b64 v[102:103], v19 offset:2120
    ds_read_b128 v[104:107], v20 offset:1600
    s_and_b32 s39, s2, 7
    s_lshl_b32 s39, s39, 13
    s_add_u32 s39, s39, 14745600
    v_lshlrev_b32 v21, 7, v1
    buffer_load_dwordx4 v[40:43], v21, s[40:43], s39 offen sc1
    s_waitcnt lgkmcnt(6)
    v_mfma_f32_16x16x32_bf16 v[180:183], v[52:55], v[56:59], 0
    ds_read_b64 v[108:109], v19 offset:3712
    ds_read_b64 v[110:111], v19 offset:3720
    v_mfma_f32_16x16x32_bf16 v[180:183], v[44:47], v[64:67], v[180:183]
    s_add_u32 s3, s17, 4096
    ds_read_b128 v[112:115], v20 offset:128
    v_mfma_f32_16x16x32_bf16 v[184:187], v[52:55], v[64:67], 0
    ds_read_b64 v[116:117], v19 offset:3200
    ds_read_b64 v[118:119], v19 offset:3208
    v_mfma_f32_16x16x32_bf16 v[180:183], v[60:63], v[48:51], v[180:183]
    ds_read_b128 v[120:123], v20 offset:640
    ds_read_b64 v[124:125], v19 offset:2688
    v_mfma_f32_16x16x32_bf16 v[184:187], v[60:63], v[56:59], v[184:187]
    buffer_load_dwordx4 a[116:119], v4, s[40:43], s3 offen offset:0 sc1
    ds_read_b64 v[126:127], v19 offset:2696
    v_mfma_f32_16x16x32_bf16 v[184:187], v[44:47], v[72:75], v[184:187]
    ds_read_b128 v[128:131], v20 offset:1152
    ds_read_b64 v[132:133], v19 offset:2176
    v_mfma_f32_16x16x32_bf16 v[184:187], v[68:71], v[48:51], v[184:187]
    ds_read_b64 v[134:135], v19 offset:2184
    ds_read_b128 v[136:139], v20 offset:1664
    v_mfma_f32_16x16x32_bf16 v[180:183], v[84:87], v[88:91], v[180:183]
    buffer_load_dwordx4 a[120:123], v4, s[40:43], s3 offen offset:1024 sc1
    ds_read_b64 v[140:141], v19 offset:3776
    s_waitcnt lgkmcnt(15)
    v_mfma_f32_16x16x32_bf16 v[180:183], v[76:79], v[96:99], v[180:183]
    ds_read_b64 v[142:143], v19 offset:3784
    ds_read_b128 v[144:147], v20 offset:192
    v_mfma_f32_16x16x32_bf16 v[184:187], v[84:87], v[96:99], v[184:187]
    ds_read_b64 v[148:149], v19 offset:3264
    ds_read_b64 v[150:151], v19 offset:3272
    v_mfma_f32_16x16x32_bf16 v[180:183], v[92:95], v[80:83], v[180:183]
    buffer_load_dwordx4 a[124:127], v4, s[40:43], s3 offen offset:2048 sc1
    ds_read_b128 v[152:155], v20 offset:704
    v_mfma_f32_16x16x32_bf16 v[184:187], v[92:95], v[88:91], v[184:187]
    ds_read_b64 v[156:157], v19 offset:2752
    ds_read_b64 v[158:159], v19 offset:2760
    s_waitcnt lgkmcnt(15)
    v_mfma_f32_16x16x32_bf16 v[184:187], v[76:79], v[104:107], v[184:187]
    ds_read_b128 v[160:163], v20 offset:1216
    ds_read_b64 v[164:165], v19 offset:2240
    v_mfma_f32_16x16x32_bf16 v[184:187], v[100:103], v[80:83], v[184:187]
    buffer_load_dwordx4 a[128:131], v4, s[40:43], s3 offen offset:3072 sc1
    ds_read_b64 v[166:167], v19 offset:2248
    ds_read_b128 v[168:171], v20 offset:1728
    s_waitcnt lgkmcnt(6)
    v_mfma_f32_16x16x32_bf16 v[180:183], v[116:119], v[120:123], v[180:183]
    ds_read_b64 v[44:45], v19 offset:3840
    ds_read_b64 v[46:47], v19 offset:3848
    v_mfma_f32_16x16x32_bf16 v[180:183], v[108:111], v[128:131], v[180:183]
    s_add_u32 s3, s17, 8192
    ds_read_b128 v[48:51], v20 offset:256
    v_mfma_f32_16x16x32_bf16 v[184:187], v[116:119], v[128:131], v[184:187]
    ds_read_b64 v[52:53], v19 offset:3328
    ds_read_b64 v[54:55], v19 offset:3336
    v_mfma_f32_16x16x32_bf16 v[180:183], v[124:127], v[112:115], v[180:183]
    ds_read_b128 v[56:59], v20 offset:768
    ds_read_b64 v[60:61], v19 offset:2816
    v_mfma_f32_16x16x32_bf16 v[184:187], v[124:127], v[120:123], v[184:187]
    buffer_load_dwordx4 a[132:135], v4, s[40:43], s3 offen offset:0 sc1
    ds_read_b64 v[62:63], v19 offset:2824
    v_mfma_f32_16x16x32_bf16 v[184:187], v[108:111], v[136:139], v[184:187]
    ds_read_b128 v[64:67], v20 offset:1280
    ds_read_b64 v[68:69], v19 offset:2304
    v_mfma_f32_16x16x32_bf16 v[184:187], v[132:135], v[112:115], v[184:187]
    ds_read_b64 v[70:71], v19 offset:2312
    ds_read_b128 v[72:75], v20 offset:1792
    v_mfma_f32_16x16x32_bf16 v[180:183], v[148:151], v[152:155], v[180:183]
    buffer_load_dwordx4 a[136:139], v4, s[40:43], s3 offen offset:1024 sc1
    ds_read_b64 v[76:77], v19 offset:3904
    s_waitcnt lgkmcnt(15)
    v_mfma_f32_16x16x32_bf16 v[180:183], v[140:143], v[160:163], v[180:183]
    ds_read_b64 v[78:79], v19 offset:3912
    ds_read_b128 v[80:83], v20 offset:320
    v_mfma_f32_16x16x32_bf16 v[184:187], v[148:151], v[160:163], v[184:187]
    ds_read_b64 v[84:85], v19 offset:3392
    ds_read_b64 v[86:87], v19 offset:3400
    v_mfma_f32_16x16x32_bf16 v[180:183], v[156:159], v[144:147], v[180:183]
    buffer_load_dwordx4 a[140:143], v4, s[40:43], s3 offen offset:2048 sc1
    ds_read_b128 v[88:91], v20 offset:832
    v_mfma_f32_16x16x32_bf16 v[184:187], v[156:159], v[152:155], v[184:187]
    ds_read_b64 v[92:93], v19 offset:2880
    ds_read_b64 v[94:95], v19 offset:2888
    s_waitcnt lgkmcnt(15)
    v_mfma_f32_16x16x32_bf16 v[184:187], v[140:143], v[168:171], v[184:187]
    ds_read_b128 v[96:99], v20 offset:1344
    ds_read_b64 v[100:101], v19 offset:2368
    v_mfma_f32_16x16x32_bf16 v[184:187], v[164:167], v[144:147], v[184:187]
    buffer_load_dwordx4 a[144:147], v4, s[40:43], s3 offen offset:3072 sc1
    ds_read_b64 v[102:103], v19 offset:2376
    ds_read_b128 v[104:107], v20 offset:1856
    s_waitcnt vmcnt(8)
    v_subrev_u32 v40, s38, v40
    v_subrev_u32 v41, s38, v41
    v_subrev_u32 v42, s38, v42
    v_subrev_u32 v43, s38, v43
    v_or3_b32 v40, v40, v41, v42
    v_or_b32 v40, v40, v43
    v_cmp_lt_u32 vcc, 7, v40
    s_mov_b32 s60, 0xff00ff00
    s_mov_b32 s61, 0xff00ff00
    s_and_b64 vcc, vcc, s[60:61]
    s_cbranch_vccz L_PDA1l
    s_mov_b32 s59, 0
L_PLA1l:
    s_and_b32 s39, s2, 7
    s_lshl_b32 s39, s39, 13
    s_add_u32 s39, s39, 14745600
    v_lshlrev_b32 v21, 7, v1
    buffer_load_dwordx4 v[40:43], v21, s[40:43], s39 offen sc1
    s_add_u32 s59, s59, 1
    s_cmp_gt_u32 s59, 0x100000
    s_waitcnt vmcnt(0)
    s_cbranch_scc1 L_PDA1l
    v_subrev_u32 v40, s38, v40
    v_subrev_u32 v41, s38, v41
    v_subrev_u32 v42, s38, v42
    v_subrev_u32 v43, s38, v43
    v_or3_b32 v40, v40, v41, v42
    v_or_b32 v40, v40, v43
    v_cmp_lt_u32 vcc, 7, v40
    s_mov_b32 s60, 0xff00ff00
    s_mov_b32 s61, 0xff00ff00
    s_and_b64 vcc, vcc, s[60:61]
    s_cbranch_vccnz L_PLA1l
L_PDA1l:
    s_waitcnt lgkmcnt(6)
    v_mfma_f32_16x16x32_bf16 v[180:183], v[52:55], v[56:59], v[180:183]
    ds_read_b64 v[108:109], v19 offset:3968
    ds_read_b64 v[110:111], v19 offset:3976
    v_mfma_f32_16x16x32_bf16 v[180:183], v[44:47], v[64:67], v[180:183]
    s_mov_b32 m0, 147200
    ds_read_b128 v[112:115], v20 offset:384
    v_mfma_f32_16x16x32_bf16 v[184:187], v[52:55], v[64:67], v[184:187]
    ds_read_b64 v[116:117], v19 offset:3456
    ds_read_b64 v[118:119], v19 offset:3464
    v_mfma_f32_16x16x32_bf16 v[180:183], v[60:63], v[48:51], v[180:183]
    s_nop 0
    ds_read_b128 v[120:123], v20 offset:896
    ds_read_b64 v[124:125], v19 offset:2944
    v_mfma_f32_16x16x32_bf16 v[184:187], v[60:63], v[56:59], v[184:187]
    ds_read_b64 v[126:127], v19 offset:2952
    buffer_load_dword v24, s[40:43], s13 offen sc1 lds
    v_mfma_f32_16x16x32_bf16 v[184:187], v[44:47], v[72:75], v[184:187]
    ds_read_b128 v[128:131], v20 offset:1408
    ds_read_b64 v[132:133], v19 offset:2432
    v_mfma_f32_16x16x32_bf16 v[184:187], v[68:71], v[48:51], v[184:187]
    ds_read_b64 v[134:135], v19 offset:2440
    s_add_u32 s3, s17, 12288
    ds_read_b128 v[136:139], v20 offset:1920
    v_mfma_f32_16x16x32_bf16 v[180:183], v[84:87], v[88:91], v[180:183]
    ds_read_b64 v[140:141], v19 offset:4032
    ds_read_b64 v[142:143], v19 offset:4040
    s_waitcnt lgkmcnt(15)
    v_mfma_f32_16x16x32_bf16 v[180:183], v[76:79], v[96:99], v[180:183]
    buffer_load_dwordx4 a[148:151], v4, s[40:43], s3 offen offset:0 sc1
    ds_read_b128 v[144:147], v20 offset:448
    v_mfma_f32_16x16x32_bf16 v[184:187], v[84:87], v[96:99], v[184:187]
    ds_read_b64 v[148:149], v19 offset:3520
    ds_read_b64 v[150:151], v19 offset:3528
    v_mfma_f32_16x16x32_bf16 v[180:183], v[92:95], v[80:83], v[180:183]
    buffer_load_dwordx4 a[152:155], v4, s[40:43], s3 offen offset:1024 sc1
    ds_read_b128 v[152:155], v20 offset:960
    ds_read_b64 v[156:157], v19 offset:3008
    v_mfma_f32_16x16x32_bf16 v[184:187], v[92:95], v[88:91], v[184:187]
    ds_read_b64 v[158:159], v19 offset:3016
    buffer_load_dwordx4 a[156:159], v4, s[40:43], s3 offen offset:2048 sc1
    s_waitcnt lgkmcnt(15)
    v_mfma_f32_16x16x32_bf16 v[184:187], v[76:79], v[104:107], v[184:187]
    ds_read_b128 v[160:163], v20 offset:1472
    ds_read_b64 v[164:165], v19 offset:2496
    v_mfma_f32_16x16x32_bf16 v[184:187], v[100:103], v[80:83], v[184:187]
    ds_read_b64 v[166:167], v19 offset:2504
    buffer_load_dwordx4 a[160:163], v4, s[40:43], s3 offen offset:3072 sc1
    ds_read_b128 v[168:171], v20 offset:1984
    s_waitcnt lgkmcnt(6)
    v_mfma_f32_16x16x32_bf16 v[180:183], v[116:119], v[120:123], v[180:183]
    v_add_u32 v19, 45824, v19
    v_add_u32 v20, 45824, v20
    v_mfma_f32_16x16x32_bf16 v[180:183], v[108:111], v[128:131], v[180:183]
    ds_read_b64 v[44:45], v19 offset:3584
    s_add_u32 s3, s17, 16384
    v_mfma_f32_16x16x32_bf16 v[184:187], v[116:119], v[128:131], v[184:187]
    ds_read_b64 v[46:47], v19 offset:3592
    ds_read_b128 v[48:51], v20 offset:0
    v_mfma_f32_16x16x32_bf16 v[180:183], v[124:127], v[112:115], v[180:183]
    ds_read_b64 v[52:53], v19 offset:3072
    ds_read_b64 v[54:55], v19 offset:3080
    v_mfma_f32_16x16x32_bf16 v[184:187], v[124:127], v[120:123], v[184:187]
    ds_read_b128 v[56:59], v20 offset:512
    buffer_load_dwordx4 a[164:167], v4, s[40:43], s3 offen offset:0 sc1
    ds_read_b64 v[60:61], v19 offset:2560
    v_mfma_f32_16x16x32_bf16 v[184:187], v[108:111], v[136:139], v[184:187]
    ds_read_b64 v[62:63], v19 offset:2568
    ds_read_b128 v[64:67], v20 offset:1024
    v_mfma_f32_16x16x32_bf16 v[184:187], v[132:135], v[112:115], v[184:187]
    ds_read_b64 v[68:69], v19 offset:2048
    ds_read_b64 v[70:71], v19 offset:2056
    v_mfma_f32_16x16x32_bf16 v[180:183], v[148:151], v[152:155], v[180:183]
    buffer_load_dwordx4 a[168:171], v4, s[40:43], s3 offen offset:1024 sc1
    ds_read_b128 v[72:75], v20 offset:1536
    s_waitcnt lgkmcnt(15)
    v_mfma_f32_16x16x32_bf16 v[180:183], v[140:143], v[160:163], v[180:183]
    ds_read_b64 v[76:77], v19 offset:3648
    ds_read_b64 v[78:79], v19 offset:3656
    v_mfma_f32_16x16x32_bf16 v[184:187], v[148:151], v[160:163], v[184:187]
    ds_read_b128 v[80:83], v20 offset:64
    ds_read_b64 v[84:85], v19 offset:3136
    buffer_load_dwordx4 a[172:175], v4, s[40:43], s3 offen offset:2048 sc1
    v_mfma_f32_16x16x32_bf16 v[180:183], v[156:159], v[144:147], v[180:183]
    ds_read_b64 v[86:87], v19 offset:3144
    ds_read_b128 v[88:91], v20 offset:576
    v_mfma_f32_16x16x32_bf16 v[184:187], v[156:159], v[152:155], v[184:187]
    ds_read_b64 v[92:93], v19 offset:2624
    ds_read_b64 v[94:95], v19 offset:2632
    s_waitcnt lgkmcnt(15)
    v_mfma_f32_16x16x32_bf16 v[184:187], v[140:143], v[168:171], v[184:187]
    ds_read_b128 v[96:99], v20 offset:1088
    buffer_load_dwordx4 a[176:179], v4, s[40:43], s3 offen offset:3072 sc1
    v_mfma_f32_16x16x32_bf16 v[184:187], v[164:167], v[144:147], v[184:187]
    ds_read_b64 v[100:101], v19 offset:2112
    ds_read_b64 v[102:103], v19 offset:2120
    ds_read_b128 v[104:107], v20 offset:1600
    s_cmp_eq_u32 s58, 1
    s_cbranch_scc1 L_C3L
    s_waitcnt lgkmcnt(6)
    v_mfma_f32_16x16x32_bf16 v[188:191], v[52:55], v[56:59], 0
    ds_read_b64 v[108:109], v19 offset:3712
    ds_read_b64 v[110:111], v19 offset:3720
    v_mfma_f32_16x16x32_bf16 v[188:191], v[44:47], v[64:67], v[188:191]
    s_add_u32 s3, s17, 20480
    ds_read_b128 v[112:115], v20 offset:128
    v_mfma_f32_16x16x32_bf16 v[192:195], v[52:55], v[64:67], 0
    ds_read_b64 v[116:117], v19 offset:3200
    ds_read_b64 v[118:119], v19 offset:3208
    v_mfma_f32_16x16x32_bf16 v[188:191], v[60:63], v[48:51], v[188:191]
    ds_read_b128 v[120:123], v20 offset:640
    ds_read_b64 v[124:125], v19 offset:2688
    v_mfma_f32_16x16x32_bf16 v[192:195], v[60:63], v[56:59], v[192:195]
    buffer_load_dwordx4 a[180:183], v4, s[40:43], s3 offen offset:0 sc1
    ds_read_b64 v[126:127], v19 offset:2696
    v_mfma_f32_16x16x32_bf16 v[192:195], v[44:47], v[72:75], v[192:195]
    ds_read_b128 v[128:131], v20 offset:1152
    ds_read_b64 v[132:133], v19 offset:2176
    v_mfma_f32_16x16x32_bf16 v[192:195], v[68:71], v[48:51], v[192:195]
    ds_read_b64 v[134:135], v19 offset:2184
    ds_read_b128 v[136:139], v20 offset:1664
    v_mfma_f32_16x16x32_bf16 v[188:191], v[84:87], v[88:91], v[188:191]
    buffer_load_dwordx4 a[184:187], v4, s[40:43], s3 offen offset:1024 sc1
    ds_read_b64 v[140:141], v19 offset:3776
    s_waitcnt lgkmcnt(15)
    v_mfma_f32_16x16x32_bf16 v[188:191], v[76:79], v[96:99], v[188:191]
    ds_read_b64 v[142:143], v19 offset:3784
    ds_read_b128 v[144:147], v20 offset:192
    v_mfma_f32_16x16x32_bf16 v[192:195], v[84:87], v[96:99], v[192:195]
    ds_read_b64 v[148:149], v19 offset:3264
    ds_read_b64 v[150:151], v19 offset:3272
    v_mfma_f32_16x16x32_bf16 v[188:191], v[92:95], v[80:83], v[188:191]
    buffer_load_dwordx4 a[188:191], v4, s[40:43], s3 offen offset:2048 sc1
    ds_read_b128 v[152:155], v20 offset:704
    v_mfma_f32_16x16x32_bf16 v[192:195], v[92:95], v[88:91], v[192:195]
    ds_read_b64 v[156:157], v19 offset:2752
    ds_read_b64 v[158:159], v19 offset:2760
    s_waitcnt lgkmcnt(15)
    v_mfma_f32_16x16x32_bf16 v[192:195], v[76:79], v[104:107], v[192:195]
    ds_read_b128 v[160:163], v20 offset:1216
    ds_read_b64 v[164:165], v19 offset:2240
    v_mfma_f32_16x16x32_bf16 v[192:195], v[100:103], v[80:83], v[192:195]
    buffer_load_dwordx4 a[192:195], v4, s[40:43], s3 offen offset:3072 sc1
    ds_read_b64 v[166:167], v19 offset:2248
    ds_read_b128 v[168:171], v20 offset:1728
    s_waitcnt lgkmcnt(6)
    v_mfma_f32_16x16x32_bf16 v[188:191], v[116:119], v[120:123], v[188:191]
    ds_read_b64 v[44:45], v19 offset:3840
    ds_read_b64 v[46:47], v19 offset:3848
    v_mfma_f32_16x16x32_bf16 v[188:191], v[108:111], v[128:131], v[188:191]
    s_add_u32 s3, s17, 24576
    ds_read_b128 v[48:51], v20 offset:256
    v_mfma_f32_16x16x32_bf16 v[192:195], v[116:119], v[128:131], v[192:195]
    ds_read_b64 v[52:53], v19 offset:3328
    ds_read_b64 v[54:55], v19 offset:3336
    v_mfma_f32_16x16x32_bf16 v[188:191], v[124:127], v[112:115], v[188:191]
    ds_read_b128 v[56:59], v20 offset:768
    ds_read_b64 v[60:61], v19 offset:2816
    v_mfma_f32_16x16x32_bf16 v[192:195], v[124:127], v[120:123], v[192:195]
    buffer_load_dwordx4 a[196:199], v4, s[40:43], s3 offen offset:0 sc1
    ds_read_b64 v[62:63], v19 offset:2824
    v_mfma_f32_16x16x32_bf16 v[192:195], v[108:111], v[136:139], v[192:195]
    ds_read_b128 v[64:67], v20 offset:1280
    ds_read_b64 v[68:69], v19 offset:2304
    v_mfma_f32_16x16x32_bf16 v[192:195], v[132:135], v[112:115], v[192:195]
    ds_read_b64 v[70:71], v19 offset:2312
    ds_read_b128 v[72:75], v20 offset:1792
    v_mfma_f32_16x16x32_bf16 v[188:191], v[148:151], v[152:155], v[188:191]
    buffer_load_dwordx4 a[200:203], v4, s[40:43], s18 offen offset:0 sc1
    ds_read_b64 v[76:77], v19 offset:3904
    s_waitcnt lgkmcnt(15)
    v_mfma_f32_16x16x32_bf16 v[188:191], v[140:143], v[160:163], v[188:191]
    ds_read_b64 v[78:79], v19 offset:3912
    ds_read_b128 v[80:83], v20 offset:320
    v_mfma_f32_16x16x32_bf16 v[192:195], v[148:151], v[160:163], v[192:195]
    ds_read_b64 v[84:85], v19 offset:3392
    ds_read_b64 v[86:87], v19 offset:3400
    v_mfma_f32_16x16x32_bf16 v[188:191], v[156:159], v[144:147], v[188:191]
    buffer_load_dwordx4 a[204:207], v4, s[40:43], s18 offen offset:1024 sc1
    ds_read_b128 v[88:91], v20 offset:832
    v_mfma_f32_16x16x32_bf16 v[192:195], v[156:159], v[152:155], v[192:195]
    ds_read_b64 v[92:93], v19 offset:2880
    ds_read_b64 v[94:95], v19 offset:2888
    s_waitcnt lgkmcnt(15)
    v_mfma_f32_16x16x32_bf16 v[192:195], v[140:143], v[168:171], v[192:195]
    ds_read_b128 v[96:99], v20 offset:1344
    ds_read_b64 v[100:101], v19 offset:2368
    v_mfma_f32_16x16x32_bf16 v[192:195], v[164:167], v[144:147], v[192:195]
    buffer_load_dwordx4 a[208:211], v4, s[40:43], s18 offen offset:2048 sc1
    ds_read_b64 v[102:103], v19 offset:2376
    ds_read_b128 v[104:107], v20 offset:1856
    s_waitcnt lgkmcnt(6)
    v_mfma_f32_16x16x32_bf16 v[188:191], v[52:55], v[56:59], v[188:191]
    ds_read_b64 v[108:109], v19 offset:3968
    v_mfma_f32_16x16x32_bf16 v[188:191], v[44:47], v[64:67], v[188:191]
    ds_read_b64 v[110:111], v19 offset:3976
    ds_read_b128 v[112:115], v20 offset:384
    v_mfma_f32_16x16x32_bf16 v[192:195], v[52:55], v[64:67], v[192:195]
    ds_read_b64 v[116:117], v19 offset:3456
    ds_read_b64 v[118:119], v19 offset:3464
    v_mfma_f32_16x16x32_bf16 v[188:191], v[60:63], v[48:51], v[188:191]
    ds_read_b128 v[120:123], v20 offset:896
    v_mfma_f32_16x16x32_bf16 v[192:195], v[60:63], v[56:59], v[192:195]
    ds_read_b64 v[124:125], v19 offset:2944
    ds_read_b64 v[126:127], v19 offset:2952
    v_mfma_f32_16x16x32_bf16 v[192:195], v[44:47], v[72:75], v[192:195]
    ds_read_b128 v[128:131], v20 offset:1408
    ds_read_b64 v[132:133], v19 offset:2432
    v_mfma_f32_16x16x32_bf16 v[192:195], v[68:71], v[48:51], v[192:195]
    ds_read_b64 v[134:135], v19 offset:2440
    ds_read_b128 v[136:139], v20 offset:1920
    v_mfma_f32_16x16x32_bf16 v[188:191], v[84:87], v[88:91], v[188:191]
    ds_read_b64 v[140:141], v19 offset:4032
    s_waitcnt lgkmcnt(15)
    v_mfma_f32_16x16x32_bf16 v[188:191], v[76:79], v[96:99], v[188:191]
    ds_read_b64 v[142:143], v19 offset:4040
    ds_read_b128 v[144:147], v20 offset:448
    v_mfma_f32_16x16x32_bf16 v[192:195], v[84:87], v[96:99], v[192:195]
    ds_read_b64 v[148:149], v19 offset:3520
    ds_read_b64 v[150:151], v19 offset:3528
    v_mfma_f32_16x16x32_bf16 v[188:191], v[92:95], v[80:83], v[188:191]
    ds_read_b128 v[152:155], v20 offset:960
    v_mfma_f32_16x16x32_bf16 v[192:195], v[92:95], v[88:91], v[192:195]
    ds_read_b64 v[156:157], v19 offset:3008
    ds_read_b64 v[158:159], v19 offset:3016
    s_waitcnt lgkmcnt(15)
    v_mfma_f32_16x16x32_bf16 v[192:195], v[76:79], v[104:107], v[192:195]
    ds_read_b128 v[160:163], v20 offset:1472
    ds_read_b64 v[164:165], v19 offset:2496
    v_mfma_f32_16x16x32_bf16 v[192:195], v[100:103], v[80:83], v[192:195]
    ds_read_b64 v[166:167], v19 offset:2504
    ds_read_b128 v[168:171], v20 offset:1984
    s_waitcnt lgkmcnt(6)
    v_mfma_f32_16x16x32_bf16 v[188:191], v[116:119], v[120:123], v[188:191]
    v_mfma_f32_16x16x32_bf16 v[188:191], v[108:111], v[128:131], v[188:191]
    v_mfma_f32_16x16x32_bf16 v[192:195], v[116:119], v[128:131], v[192:195]
    v_mfma_f32_16x16x32_bf16 v[188:191], v[124:127], v[112:115], v[188:191]
    v_mfma_f32_16x16x32_bf16 v[192:195], v[124:127], v[120:123], v[192:195]
    v_mfma_f32_16x16x32_bf16 v[192:195], v[108:111], v[136:139], v[192:195]
    v_mfma_f32_16x16x32_bf16 v[192:195], v[132:135], v[112:115], v[192:195]
    v_mfma_f32_16x16x32_bf16 v[188:191], v[148:151], v[152:155], v[188:191]
    s_waitcnt lgkmcnt(3)
    v_mfma_f32_16x16x32_bf16 v[188:191], v[140:143], v[160:163], v[188:191]
    v_mfma_f32_16x16x32_bf16 v[192:195], v[148:151], v[160:163], v[192:195]
    v_mfma_f32_16x16x32_bf16 v[188:191], v[156:159], v[144:147], v[188:191]
    v_mfma_f32_16x16x32_bf16 v[192:195], v[156:159], v[152:155], v[192:195]
    s_waitcnt lgkmcnt(0)
    v_mfma_f32_16x16x32_bf16 v[192:195], v[140:143], v[168:171], v[192:195]
    v_mfma_f32_16x16x32_bf16 v[192:195], v[164:167], v[144:147], v[192:195]
    s_branch L_C3E
L_C3L:
    s_add_u32 s3, s17, 20480
    buffer_load_dwordx4 a[180:183], v4, s[40:43], s3 offen offset:0 sc1
    buffer_load_dwordx4 a[184:187], v4, s[40:43], s3 offen offset:1024 sc1
    buffer_load_dwordx4 a[188:191], v4, s[40:43], s3 offen offset:2048 sc1
    buffer_load_dwordx4 a[192:195], v4, s[40:43], s3 offen offset:3072 sc1
    s_add_u32 s3, s17, 24576
    buffer_load_dwordx4 a[196:199], v4, s[40:43], s3 offen offset:0 sc1
    buffer_load_dwordx4 a[200:203], v4, s[40:43], s18 offen offset:0 sc1
    buffer_load_dwordx4 a[204:207], v4, s[40:43], s18 offen offset:1024 sc1
    buffer_load_dwordx4 a[208:211], v4, s[40:43], s18 offen offset:2048 sc1
L_C3E:
    s_waitcnt vmcnt(8)
L_CD:
    s_waitcnt lgkmcnt(0)
    s_mov_b32 s60, 1048576
    s_add_u32 s39, s23, 8
    v_readlane_b32 s4, v30, s39
    s_add_u32 s39, s24, 8
    v_readlane_b32 s6, v30, s39
    s_add_u32 s39, s25, 8
    v_readlane_b32 s8, v30, s39
    s_barrier
    ds_read_b32 v30, v35
    ds_read_b64 v[44:45], v9 offset:0
    ds_read_b64 v[46:47], v9 offset:2048
    ds_read_b64 v[48:49], v10 offset:0
    ds_read_b64 v[50:51], v10 offset:2048
    ds_read_b64 v[52:53], v11 offset:0
    ds_read_b64 v[54:55], v11 offset:2048
    s_mov_b32 s34, 7680
    buffer_load_dwordx4 v[224:227], v8, s[40:43], s34 offen sc1
    s_mov_b32 s34, 23040
    buffer_load_dwordx4 v[228:231], v8, s[40:43], s34 offen sc1
    s_mov_b32 s34, 38400
    buffer_load_dwordx4 v[232:235], v8, s[40:43], s34 offen sc1
    s_mov_b32 s34, 53760
    buffer_load_dwordx4 v[236:239], v8, s[40:43], s34 offen sc1
    s_mov_b32 s34, 11776
    buffer_load_dwordx4 v[240:243], v8, s[40:43], s34 offen sc1
    s_mov_b32 s34, 27136
    buffer_load_dwordx4 v[244:247], v8, s[40:43], s34 offen sc1
    s_mov_b32 s34, 42496
    buffer_load_dwordx4 v[248:251], v8, s[40:43], s34 offen sc1
    s_mov_b32 s34, 57856
    buffer_load_dwordx4 v[252:255], v8, s[40:43], s34 offen sc1
    s_waitcnt lgkmcnt(6)
    v_mov_b32 v34, v30
    s_nop 1
    v_permlane16_swap_b32 v30, v34
    v_add_f32 v30, v30, v34
    v_mov_b32 v34, v30
    s_nop 1
    v_permlane32_swap_b32 v30, v34
    v_add_f32 v30, v30, v34
    v_cvt_pk_bf16_f32 v30, v30, v30
    v_and_b32 v30, 0xffff0000, v30
    v_add_f32 v30, 1.0, v30
    v_cvt_pk_bf16_f32 v30, v30, v30
    v_and_b32 v30, 0xffff0000, v30
    s_add_u32 s39, s23, 12
    v_readlane_b32 s5, v30, s39
    s_add_u32 s39, s24, 12
    v_readlane_b32 s7, v30, s39
    s_add_u32 s39, s25, 12
    v_readlane_b32 s9, v30, s39
    s_waitcnt lgkmcnt(5)
    v_lshlrev_b32 v72, 16, v44
    v_and_b32 v73, 0xffff0000, v44
    v_lshlrev_b32 v74, 16, v45
    v_and_b32 v75, 0xffff0000, v45
    s_waitcnt lgkmcnt(4)
    v_lshlrev_b32 v76, 16, v46
    v_and_b32 v77, 0xffff0000, v46
    v_lshlrev_b32 v78, 16, v47
    v_and_b32 v79, 0xffff0000, v47
    v_pk_fma_f32 v[172:173], v[172:173], s[4:5], v[72:73] op_sel_hi:[1,0,1]
    v_pk_fma_f32 v[174:175], v[174:175], s[4:5], v[74:75] op_sel_hi:[1,0,1]
    v_pk_fma_f32 v[176:177], v[176:177], s[4:5], v[76:77] op_sel_hi:[1,0,1]
    v_pk_fma_f32 v[178:179], v[178:179], s[4:5], v[78:79] op_sel_hi:[1,0,1]
    v_pk_mul_f32 v[72:73], v[172:173], s[4:5] op_sel:[0,1] op_sel_hi:[1,1]
    v_pk_mul_f32 v[74:75], v[174:175], s[4:5] op_sel:[0,1] op_sel_hi:[1,1]
    v_pk_mul_f32 v[76:77], v[176:177], s[4:5] op_sel:[0,1] op_sel_hi:[1,1]
    v_pk_mul_f32 v[78:79], v[178:179], s[4:5] op_sel:[0,1] op_sel_hi:[1,1]
    v_cvt_pk_bf16_f32 v100, v72, v73
    v_cvt_pk_bf16_f32 v101, v74, v75
    v_cvt_pk_bf16_f32 v102, v76, v77
    v_cvt_pk_bf16_f32 v103, v78, v79
    v_cvt_pk_bf16_f32 v96, v172, v173
    v_cvt_pk_bf16_f32 v97, v174, v175
    v_cvt_pk_bf16_f32 v98, v176, v177
    v_cvt_pk_bf16_f32 v99, v178, v179
    v_permlane16_swap_b32 v100, v102
    v_permlane16_swap_b32 v101, v103
    buffer_store_dwordx4 v[100:103], v12, s[40:43], s60 offen sc1
    v_permlane16_swap_b32 v96, v98
    v_permlane16_swap_b32 v97, v99
    s_waitcnt vmcnt(61)
    buffer_store_dwordx4 v[96:99], v12, s[44:47], 0 offen sc1
    s_waitcnt lgkmcnt(3)
    v_lshlrev_b32 v80, 16, v48
    v_and_b32 v81, 0xffff0000, v48
    v_lshlrev_b32 v82, 16, v49
    v_and_b32 v83, 0xffff0000, v49
    s_waitcnt lgkmcnt(2)
    v_lshlrev_b32 v84, 16, v50
    v_and_b32 v85, 0xffff0000, v50
    v_lshlrev_b32 v86, 16, v51
    v_and_b32 v87, 0xffff0000, v51
    v_pk_fma_f32 v[180:181], v[180:181], s[6:7], v[80:81] op_sel_hi:[1,0,1]
    v_pk_fma_f32 v[182:183], v[182:183], s[6:7], v[82:83] op_sel_hi:[1,0,1]
    v_pk_fma_f32 v[184:185], v[184:185], s[6:7], v[84:85] op_sel_hi:[1,0,1]
    v_pk_fma_f32 v[186:187], v[186:187], s[6:7], v[86:87] op_sel_hi:[1,0,1]
    v_pk_mul_f32 v[80:81], v[180:181], s[6:7] op_sel:[0,1] op_sel_hi:[1,1]
    v_pk_mul_f32 v[82:83], v[182:183], s[6:7] op_sel:[0,1] op_sel_hi:[1,1]
    v_pk_mul_f32 v[84:85], v[184:185], s[6:7] op_sel:[0,1] op_sel_hi:[1,1]
    v_pk_mul_f32 v[86:87], v[186:187], s[6:7] op_sel:[0,1] op_sel_hi:[1,1]
    v_cvt_pk_bf16_f32 v108, v80, v81
    v_cvt_pk_bf16_f32 v109, v82, v83
    v_cvt_pk_bf16_f32 v110, v84, v85
    v_cvt_pk_bf16_f32 v111, v86, v87
    v_cvt_pk_bf16_f32 v104, v180, v181
    v_cvt_pk_bf16_f32 v105, v182, v183
    v_cvt_pk_bf16_f32 v106, v184, v185
    v_cvt_pk_bf16_f32 v107, v186, v187
    v_permlane16_swap_b32 v108, v110
    v_permlane16_swap_b32 v109, v111
    s_waitcnt vmcnt(61)
    buffer_store_dwordx4 v[108:111], v13, s[40:43], s60 offen sc1
    v_permlane16_swap_b32 v104, v106
    v_permlane16_swap_b32 v105, v107
    s_waitcnt vmcnt(61)
    buffer_store_dwordx4 v[104:107], v13, s[44:47], 0 offen sc1
    s_waitcnt lgkmcnt(1)
    v_lshlrev_b32 v88, 16, v52
    v_and_b32 v89, 0xffff0000, v52
    v_lshlrev_b32 v90, 16, v53
    v_and_b32 v91, 0xffff0000, v53
    s_waitcnt lgkmcnt(0)
    v_lshlrev_b32 v92, 16, v54
    v_and_b32 v93, 0xffff0000, v54
    v_lshlrev_b32 v94, 16, v55
    v_and_b32 v95, 0xffff0000, v55
    v_pk_fma_f32 v[188:189], v[188:189], s[8:9], v[88:89] op_sel_hi:[1,0,1]
    v_pk_fma_f32 v[190:191], v[190:191], s[8:9], v[90:91] op_sel_hi:[1,0,1]
    v_pk_fma_f32 v[192:193], v[192:193], s[8:9], v[92:93] op_sel_hi:[1,0,1]
    v_pk_fma_f32 v[194:195], v[194:195], s[8:9], v[94:95] op_sel_hi:[1,0,1]
    v_pk_mul_f32 v[88:89], v[188:189], s[8:9] op_sel:[0,1] op_sel_hi:[1,1]
    v_pk_mul_f32 v[90:91], v[190:191], s[8:9] op_sel:[0,1] op_sel_hi:[1,1]
    v_pk_mul_f32 v[92:93], v[192:193], s[8:9] op_sel:[0,1] op_sel_hi:[1,1]
    v_pk_mul_f32 v[94:95], v[194:195], s[8:9] op_sel:[0,1] op_sel_hi:[1,1]
    v_cvt_pk_bf16_f32 v116, v88, v89
    v_cvt_pk_bf16_f32 v117, v90, v91
    v_cvt_pk_bf16_f32 v118, v92, v93
    v_cvt_pk_bf16_f32 v119, v94, v95
    v_cvt_pk_bf16_f32 v112, v188, v189
    v_cvt_pk_bf16_f32 v113, v190, v191
    v_cvt_pk_bf16_f32 v114, v192, v193
    v_cvt_pk_bf16_f32 v115, v194, v195
    v_permlane16_swap_b32 v116, v118
    v_permlane16_swap_b32 v117, v119
    s_waitcnt vmcnt(61)
    buffer_store_dwordx4 v[116:119], v14, s[40:43], s60 offen sc1
    v_permlane16_swap_b32 v112, v114
    v_permlane16_swap_b32 v113, v115
    s_waitcnt vmcnt(61)
    buffer_store_dwordx4 v[112:115], v14, s[44:47], 0 offen sc1
    v_lshlrev_b32 v5, 4, v3
    v_lshlrev_b32 v6, 1, v3
    v_and_b32 v7, 7, v1
    v_xor_b32 v6, v6, v7
    v_lshrrev_b32 v7, 3, v1
    v_lshlrev_b32 v7, 7, v7
    v_lshl_add_u32 v6, v6, 4, v7
    v_lshrrev_b32 v7, 2, v1
    v_lshlrev_b32 v12, 7, v7
    v_and_b32 v13, 3, v1
    v_lshl_add_u32 v12, v13, 3, v12
    v_bfe_u32 v7, v1, 3, 2
    s_mul_i32 s22, s52, 20480
    s_add_u32 s22, s22, 81920
    s_sub_u32 s20, s22, 4096
    s_xor_b32 s39, s52, 3
    v_xor_b32 v13, s39, v7
    v_lshl_add_u32 v8, v13, 5, v12
    v_add_u32 v8, s22, v8
    s_mov_b32 s30, s39
    s_xor_b32 s39, s52, 2
    v_xor_b32 v13, s39, v7
    v_lshl_add_u32 v9, v13, 5, v12
    v_add_u32 v9, s22, v9
    s_mov_b32 s31, s39
    s_xor_b32 s39, s52, 1
    v_xor_b32 v13, s39, v7
    v_lshl_add_u32 v10, v13, 5, v12
    v_add_u32 v10, s22, v10
    s_mov_b32 s32, s39
    s_xor_b32 s39, s52, 0
    v_xor_b32 v13, s39, v7
    v_lshl_add_u32 v11, v13, 5, v12
    v_add_u32 v17, 61440, v11
    v_add_u32 v11, s22, v11
    s_mov_b32 s33, s39
    s_xor_b32 s39, s52, 3
    s_mul_i32 s39, s39, 15360
    s_add_u32 s39, s39, 0
    v_add_u32 v13, s39, v4
    s_xor_b32 s39, s52, 2
    s_mul_i32 s39, s39, 15360
    s_add_u32 s39, s39, 5120
    v_add_u32 v14, s39, v4
    s_xor_b32 s39, s52, 1
    s_mul_i32 s39, s39, 15360
    s_add_u32 s39, s39, 10240
    v_add_u32 v15, s39, v4
    s_mul_i32 s39, s52, 15360
    v_add_u32 v16, s39, v4
    v_min_u32 v12, 2, v2
    v_mul_u32_u24 v12, 1280, v12
    v_lshl_add_u32 v12, v3, 3, v12
    s_mul_i32 s39, s52, 320
    s_add_u32 s39, s39, 29696
    v_add_u32 v12, s39, v12
    v_cmp_gt_u32 s[24:25], 3, v2
    s_lshl_b32 s39, s53, 6
    s_lshl_b32 s59, s52, 4
    s_add_u32 s39, s39, s59
    v_add_u32 v20, s39, v2
    s_mul_i32 s26, s54, 320
    s_add_u32 s26, s26, 21504
    v_mov_b32 v74, 0xc0135761
    v_mov_b32 v75, 0xbdd2d3e8
    v_add_u32 v18, s26, v5
    s_mul_i32 s23, s53, 81920
    s_lshl_b32 s27, s53, 12
    s_lshl_b32 s39, s21, 7
    s_add_u32 s27, s27, s39
    s_add_u32 s27, s27, 14942208
    v_lshlrev_b32 v21, 4, v0
    v_add_u32 v21, 21504, v21
    v_lshlrev_b32 v22, 3, v0
    v_add_u32 v22, 29696, v22
    s_waitcnt vmcnt(12)
    v_pk_add_f32 v[224:225], v[224:225], v[228:229]
    s_waitcnt vmcnt(10)
    v_pk_add_f32 v[232:233], v[232:233], v[236:237]
    v_pk_add_f32 v[226:227], v[226:227], v[230:231]
    v_pk_add_f32 v[234:235], v[234:235], v[238:239]
    v_pk_add_f32 v[224:225], v[224:225], v[232:233]
    v_pk_add_f32 v[226:227], v[226:227], v[234:235]
    v_cvt_pk_bf16_f32 v228, v224, v225
    v_cvt_pk_bf16_f32 v229, v226, v227
    v_lshlrev_b32 v224, 16, v228
    v_and_b32 v225, 0xffff0000, v228
    v_lshlrev_b32 v226, 16, v229
    v_and_b32 v227, 0xffff0000, v229
    v_cmp_lt_u32 vcc, 159, v0
    s_nop 1
    v_cndmask_b32 v232, 0, 1.0, vcc
    v_pk_add_f32 v[224:225], v[224:225], v[232:233] op_sel_hi:[1,0]
    v_pk_add_f32 v[226:227], v[226:227], v[232:233] op_sel_hi:[1,0]
    v_cvt_pk_bf16_f32 v228, v224, v225
    v_cvt_pk_bf16_f32 v229, v226, v227
    v_lshlrev_b32 v224, 16, v228
    v_and_b32 v225, 0xffff0000, v228
    v_lshlrev_b32 v226, 16, v229
    v_and_b32 v227, 0xffff0000, v229
    ds_write_b128 v21, v[224:227] offset:0
    ds_write_b64 v22, v[228:229] offset:0
    s_waitcnt vmcnt(8)
    v_pk_add_f32 v[240:241], v[240:241], v[244:245]
    s_waitcnt vmcnt(6)
    v_pk_add_f32 v[248:249], v[248:249], v[252:253]
    v_pk_add_f32 v[242:243], v[242:243], v[246:247]
    v_pk_add_f32 v[250:251], v[250:251], v[254:255]
    v_pk_add_f32 v[240:241], v[240:241], v[248:249]
    v_pk_add_f32 v[242:243], v[242:243], v[250:251]
    v_cvt_pk_bf16_f32 v244, v240, v241
    v_cvt_pk_bf16_f32 v245, v242, v243
    v_lshlrev_b32 v240, 16, v244
    v_and_b32 v241, 0xffff0000, v244
    v_lshlrev_b32 v242, 16, v245
    v_and_b32 v243, 0xffff0000, v245
    v_cmp_gt_u32 vcc, 64, v0
    s_nop 1
    v_cndmask_b32 v248, 0, 1.0, vcc
    v_pk_add_f32 v[240:241], v[240:241], v[248:249] op_sel_hi:[1,0]
    v_pk_add_f32 v[242:243], v[242:243], v[248:249] op_sel_hi:[1,0]
    v_cvt_pk_bf16_f32 v244, v240, v241
    v_cvt_pk_bf16_f32 v245, v242, v243
    v_lshlrev_b32 v240, 16, v244
    v_and_b32 v241, 0xffff0000, v244
    v_lshlrev_b32 v242, 16, v245
    v_and_b32 v243, 0xffff0000, v245
    ds_write_b128 v21, v[240:243] offset:4096
    v_mov_b32 v249, 0x3f803f80
    v_cndmask_b32 v244, v249, v244, vcc
    v_cndmask_b32 v245, v249, v245, vcc
    ds_write_b64 v22, v[244:245] offset:2048
    s_bitcmp1_b32 s54, 1
    s_cselect_b32 s39, -1, 1
    s_add_u32 s39, s39, s53
    s_and_b32 s39, s39, 31
    v_mov_b32 v21, s53
    v_mov_b32 v22, s39
    v_cmp_lt_u32 vcc, 7, v1
    s_nop 1
    v_cndmask_b32 v21, v21, v22, vcc
    v_lshrrev_b32 v22, 2, v21
    v_and_b32 v21, 3, v21
    v_lshl_add_u32 v21, v21, 6, v22
    v_and_b32 v22, 7, v1
    v_lshl_add_u32 v21, v22, 3, v21
    v_lshrrev_b32 v22, 6, v21
    v_and_b32 v21, 63, v21
    v_lshlrev_b32 v21, 7, v21
    v_lshl_add_u32 v21, v22, 2, v21
    s_and_b32 s39, s2, 7
    s_lshl_b32 s39, s39, 13
    s_add_u32 s39, s39, 14745600
    buffer_load_dword v44, v21, s[40:43], s39 offen sc1
    s_waitcnt vmcnt(1)
    s_waitcnt lgkmcnt(0)
    s_barrier
    s_cmp_lg_u32 s52, 0
    s_cbranch_scc1 L_SGA
    s_and_b32 s39, s2, 31
    s_lshl_b32 s39, s39, 7
    s_lshr_b32 s59, s2, 5
    s_lshl_b32 s59, s59, 2
    s_add_u32 s39, s39, s59
    s_add_u32 s39, s39, 14811136
    v_lshlrev_b32 v21, 13, v1
    v_mov_b32 v22, s38
    s_mov_b64 exec, 0xff
    buffer_store_dword v22, v21, s[40:43], s39 offen sc1
    s_mov_b64 exec, -1
L_SGA:
    ds_read_b64 v[164:165], v12 offset:0
    ds_read_b64 v[166:167], v12 offset:32
    ds_read_b64 v[168:169], v12 offset:64
    ds_read_b64 v[170:171], v12 offset:96
    ds_read_b64 v[172:173], v12 offset:160
    ds_read_b64 v[174:175], v12 offset:192
    ds_read_b64 v[176:177], v12 offset:224
    ds_read_b64 v[178:179], v12 offset:256
    ds_read_b64 v[180:181], v12 offset:128
    ds_read_b64 v[182:183], v12 offset:288
    s_waitcnt lgkmcnt(8)
    v_mfma_f32_16x16x32_bf16 v[76:79], a[0:3], v[164:167], 0
    v_mfma_f32_16x16x32_bf16 v[80:83], a[4:7], v[164:167], 0
    ds_read_b128 v[54:57], v18 offset:2560
    v_mfma_f32_16x16x32_bf16 v[84:87], a[8:11], v[164:167], 0
    buffer_load_dwordx4 a[212:215], v4, s[40:43], s18 offen offset:3072 sc1
    v_mfma_f32_16x16x32_bf16 v[88:91], a[12:15], v[164:167], 0
    ds_read_b128 v[58:61], v18 offset:2624
    v_mfma_f32_16x16x32_bf16 v[92:95], a[16:19], v[164:167], 0
    ds_read_b128 v[62:65], v18 offset:2688
    v_mfma_f32_16x16x32_bf16 v[96:99], v[164:167], v[164:167], 0
    ds_read_b128 v[66:69], v18 offset:2752
    s_waitcnt lgkmcnt(10)
    v_mfma_f32_16x16x32_bf16 v[76:79], a[20:23], v[168:171], v[76:79]
    s_add_u32 s3, s18, 4096
    v_mfma_f32_16x16x32_bf16 v[80:83], a[24:27], v[168:171], v[80:83]
    ds_read_b128 v[70:73], v18 offset:2816
    v_mfma_f32_16x16x32_bf16 v[84:87], a[28:31], v[168:171], v[84:87]
    ds_read_b128 v[24:27], v18 offset:0
    v_mfma_f32_16x16x32_bf16 v[88:91], a[32:35], v[168:171], v[88:91]
    ds_read_b128 v[28:31], v18 offset:64
    v_mfma_f32_16x16x32_bf16 v[92:95], a[36:39], v[168:171], v[92:95]
    buffer_load_dwordx4 a[216:219], v4, s[40:43], s3 offen offset:0 sc1
    v_mfma_f32_16x16x32_bf16 v[96:99], v[168:171], v[168:171], v[96:99]
    ds_read_b128 v[32:35], v18 offset:128
    s_waitcnt lgkmcnt(12)
    v_mfma_f32_16x16x32_bf16 v[76:79], a[40:43], v[172:175], v[76:79]
    ds_read_b128 v[36:39], v18 offset:192
    v_mfma_f32_16x16x32_bf16 v[80:83], a[44:47], v[172:175], v[80:83]
    buffer_load_dwordx4 a[220:223], v4, s[40:43], s3 offen offset:1024 sc1
    v_mfma_f32_16x16x32_bf16 v[84:87], a[48:51], v[172:175], v[84:87]
    ds_read_b128 v[40:43], v18 offset:256
    v_mfma_f32_16x16x32_bf16 v[88:91], a[52:55], v[172:175], v[88:91]
    v_min_u32 v18, 19, v1
    v_mfma_f32_16x16x32_bf16 v[92:95], a[56:59], v[172:175], v[92:95]
    v_lshlrev_b32 v18, 4, v18
    v_mfma_f32_16x16x32_bf16 v[96:99], v[172:175], v[172:175], v[96:99]
    buffer_load_dwordx4 a[224:227], v4, s[40:43], s3 offen offset:2048 sc1
    s_waitcnt lgkmcnt(12)
    v_mfma_f32_16x16x32_bf16 v[76:79], a[60:63], v[176:179], v[76:79]
    v_add_u32 v19, s26, v18
    v_mfma_f32_16x16x32_bf16 v[80:83], a[64:67], v[176:179], v[80:83]
    ds_read_b128 v[116:119], v19 offset:5120
    v_mfma_f32_16x16x32_bf16 v[84:87], a[68:71], v[176:179], v[84:87]
    buffer_load_dwordx4 a[228:231], v4, s[40:43], s3 offen offset:3072 sc1
    v_mfma_f32_16x16x32_bf16 v[88:91], a[72:75], v[176:179], v[88:91]
    v_add_u32 v19, 81024, v18
    v_mfma_f32_16x16x32_bf16 v[92:95], a[76:79], v[176:179], v[92:95]
    v_mul_u32_u24 v18, 384, v2
    v_mfma_f32_16x16x32_bf16 v[96:99], v[176:179], v[176:179], v[96:99]
    v_add_u32 v18, v18, v5
    s_waitcnt lgkmcnt(11)
    v_mfma_f32_16x16x32_bf16 v[76:79], a[80:83], v[180:183], v[76:79]
    s_add_u32 s3, s18, 8192
    v_mfma_f32_16x16x32_bf16 v[80:83], a[84:87], v[180:183], v[80:83]
    s_mul_i32 s39, s52, 1152
    v_mfma_f32_16x16x32_bf16 v[84:87], a[88:91], v[180:183], v[84:87]
    s_add_u32 s39, s39, 73728
    v_mfma_f32_16x16x32_bf16 v[88:91], a[92:95], v[180:183], v[88:91]
    v_add_u32 v18, s39, v18
    v_mfma_f32_16x16x32_bf16 v[92:95], a[96:99], v[180:183], v[92:95]
    buffer_load_dwordx4 a[232:235], v4, s[40:43], s3 offen offset:0 sc1
    v_mfma_f32_16x16x32_bf16 v[96:99], v[180:183], v[180:183], v[96:99]
    s_waitcnt lgkmcnt(0)
    ds_write_b128 v19, v[116:119]
    s_mov_b64 exec, s[24:25]
    ds_write_b128 v18, v[76:79] offset:0
    ds_write_b128 v18, v[80:83] offset:64
    ds_write_b128 v18, v[84:87] offset:128
    ds_write_b128 v18, v[88:91] offset:192
    ds_write_b128 v18, v[92:95] offset:256
    ds_write_b128 v18, v[96:99] offset:320
    s_mov_b64 exec, -1
    v_lshlrev_b32 v18, 3, v0
    v_min_u32 v18, 1144, v18
    v_add_u32 v18, 73728, v18
    s_waitcnt lgkmcnt(0)
    s_barrier
    ds_read_b64 v[76:77], v18 offset:0
    ds_read_b64 v[78:79], v18 offset:1152
    ds_read_b64 v[80:81], v18 offset:2304
    ds_read_b64 v[82:83], v18 offset:3456
    s_getpc_b64 s[48:49]
L_CPF1:
    s_mov_b32 s50, CODE_END-L_CPF1
    s_mov_b32 s51, 0x20000
    s_lshr_b32 s39, s2, 3
    s_lshl_b32 s39, s39, 2
    s_add_u32 s39, s39, s52
    s_mul_i32 s39, s39, 256
    v_min_u32 v22, 1, v1
    v_lshlrev_b32 v22, 7, v22
    buffer_load_dword v23, v22, s[48:51], s39 offen
    s_waitcnt lgkmcnt(2)
    v_pk_add_f32 v[76:77], v[76:77], v[78:79]
    s_waitcnt lgkmcnt(0)
    v_pk_add_f32 v[80:81], v[80:81], v[82:83]
    v_pk_add_f32 v[76:77], v[76:77], v[80:81]
    ds_write_b64 v18, v[76:77] offset:6144
    s_mul_i32 s29, s54, 10240
    s_add_u32 s28, s29, s23
    s_add_u32 s39, s52, 0
    s_min_u32 s39, s39, 9
    s_lshl_b32 s4, s39, 10
    s_add_u32 s8, s4, s28
    s_add_u32 s39, s52, 4
    s_min_u32 s39, s39, 9
    s_lshl_b32 s5, s39, 10
    s_add_u32 s9, s5, s28
    s_add_u32 s39, s52, 8
    s_min_u32 s39, s39, 9
    s_lshl_b32 s6, s39, 10
    s_add_u32 s10, s6, s28
    s_mul_i32 s34, s52, 20480
    s_add_u32 s28, s34, s23
    s_add_u32 s28, s28, 1048576
    v_add_u32 v12, 79872, v5
    v_mov_b32 v19, 80192
    s_getreg_b32 s39, hwreg(HW_REG_XCC_ID, 0, 3)
    s_add_u32 s39, s39, s38
    s_waitcnt vmcnt(7)
    v_cmp_ne_u32 vcc, s39, v44
    s_nop 0
    s_and_b32 s39, vcc_lo, 0xff
    s_cselect_b32 s36, 0, 1
    s_and_b32 s39, vcc_lo, 0xff00
    s_cselect_b32 s39, 0, 2
    s_or_b32 s36, s36, s39
    s_cmp_lg_u32 s52, 0
    s_cbranch_scc1 L_NL2
    s_and_b32 s39, s2, 7
    s_lshl_b32 s39, s39, 13
    s_add_u32 s39, s39, 14811136
    v_lshrrev_b32 v21, 1, v1
    v_lshlrev_b32 v21, 7, v21
    v_and_b32 v22, 1, v1
    v_lshl_add_u32 v21, v22, 4, v21
    buffer_load_dwordx4 v[116:119], v21, s[40:43], s39 offen sc1
L_NL2:
    buffer_load_dwordx4 a[236:239], v4, s[40:43], s3 offen offset:1024 sc1
    buffer_load_dwordx4 a[240:243], v4, s[40:43], s3 offen offset:2048 sc1
    buffer_load_dwordx4 a[244:247], v4, s[40:43], s3 offen offset:3072 sc1
    s_add_u32 s3, s18, 12288
    buffer_load_dwordx4 a[248:251], v4, s[40:43], s3 offen offset:0 sc1
    buffer_load_dwordx4 a[252:255], v4, s[40:43], s3 offen offset:1024 sc1
    buffer_load_dwordx4 v[196:199], v4, s[40:43], s3 offen offset:2048 sc1
    buffer_load_dwordx4 v[200:203], v4, s[40:43], s3 offen offset:3072 sc1
    s_add_u32 s3, s18, 16384
    buffer_load_dwordx4 v[204:207], v4, s[40:43], s3 offen offset:0 sc1
    s_waitcnt lgkmcnt(0)
    s_cmp_lg_u32 s52, 0
    s_cbranch_scc1 L_PDA2
    s_waitcnt vmcnt(8)
    v_subrev_u32 v116, s38, v116
    v_subrev_u32 v117, s38, v117
    v_subrev_u32 v118, s38, v118
    v_subrev_u32 v119, s38, v119
    v_or3_b32 v116, v116, v117, v118
    v_or_b32 v116, v116, v119
    v_cmp_lt_u32 vcc, 0, v116
    s_cbranch_vccz L_PDA2
    s_mov_b32 s59, 0
L_PLA2:
    s_and_b32 s39, s2, 7
    s_lshl_b32 s39, s39, 13
    s_add_u32 s39, s39, 14811136
    v_lshrrev_b32 v21, 1, v1
    v_lshlrev_b32 v21, 7, v21
    v_and_b32 v22, 1, v1
    v_lshl_add_u32 v21, v22, 4, v21
    buffer_load_dwordx4 v[116:119], v21, s[40:43], s39 offen sc1
    s_add_u32 s59, s59, 1
    s_cmp_gt_u32 s59, 0x100000
    s_waitcnt vmcnt(0)
    s_cbranch_scc1 L_PDA2
    v_subrev_u32 v116, s38, v116
    v_subrev_u32 v117, s38, v117
    v_subrev_u32 v118, s38, v118
    v_subrev_u32 v119, s38, v119
    v_or3_b32 v116, v116, v117, v118
    v_or_b32 v116, v116, v119
    v_cmp_lt_u32 vcc, 0, v116
    s_cbranch_vccnz L_PLA2
L_PDA2:
    s_barrier
    s_add_u32 m0, s4, 61440
    s_nop 0
    buffer_load_dwordx4 v6, s[44:47], s8 offen sc1 lds
    s_add_u32 m0, s5, 61440
    s_nop 0
    buffer_load_dwordx4 v6, s[44:47], s9 offen sc1 lds
    s_add_u32 m0, s6, 61440
    s_nop 0
    buffer_load_dwordx4 v6, s[44:47], s10 offen sc1 lds
    s_add_u32 m0, s22, 0
    s_add_u32 s13, s28, 0
    buffer_load_dwordx4 v6, s[40:43], s13 offen offset:0 sc1 lds
    buffer_load_dwordx4 v6, s[40:43], s13 offen offset:1024 sc1 lds
    s_add_u32 m0, s22, 2048
    s_add_u32 s13, s28, 2048
    buffer_load_dwordx4 v6, s[40:43], s13 offen offset:0 sc1 lds
    buffer_load_dwordx4 v6, s[40:43], s13 offen offset:1024 sc1 lds
    s_add_u32 m0, s22, 4096
    s_add_u32 s13, s28, 4096
    buffer_load_dwordx4 v6, s[40:43], s13 offen offset:0 sc1 lds
    buffer_load_dwordx4 v6, s[40:43], s13 offen offset:1024 sc1 lds
    s_add_u32 m0, s22, 6144
    s_add_u32 s13, s28, 6144
    buffer_load_dwordx4 v6, s[40:43], s13 offen offset:0 sc1 lds
    buffer_load_dwordx4 v6, s[40:43], s13 offen offset:1024 sc1 lds
    s_add_u32 m0, s22, 8192
    s_add_u32 s13, s28, 10240
    buffer_load_dwordx4 v6, s[40:43], s13 offen offset:0 sc1 lds
    buffer_load_dwordx4 v6, s[40:43], s13 offen offset:1024 sc1 lds
    s_add_u32 m0, s22, 10240
    s_add_u32 s13, s28, 12288
    buffer_load_dwordx4 v6, s[40:43], s13 offen offset:0 sc1 lds
    buffer_load_dwordx4 v6, s[40:43], s13 offen offset:1024 sc1 lds
    ds_read_b128 v[188:191], v19
    ds_read_b128 v[192:195], v19 offset:384
    s_waitcnt vmcnt(12)
    s_barrier
    ds_read_b64_tr_b16 v[44:45], v17 offset:0
    ds_read_b64_tr_b16 v[46:47], v17 offset:2048
    ds_read_b64_tr_b16 v[48:49], v17 offset:4096
    ds_read_b64_tr_b16 v[50:51], v17 offset:6144
    ds_read_b64_tr_b16 v[52:53], v17 offset:8192
    s_waitcnt lgkmcnt(4)
    v_lshlrev_b32 v84, 16, v44
    v_and_b32 v85, 0xffff0000, v44
    v_lshlrev_b32 v86, 16, v45
    v_and_b32 v87, 0xffff0000, v45
    s_waitcnt lgkmcnt(3)
    v_lshlrev_b32 v88, 16, v46
    v_and_b32 v89, 0xffff0000, v46
    v_lshlrev_b32 v90, 16, v47
    v_and_b32 v91, 0xffff0000, v47
    s_waitcnt lgkmcnt(2)
    v_lshlrev_b32 v92, 16, v48
    v_and_b32 v93, 0xffff0000, v48
    v_lshlrev_b32 v94, 16, v49
    v_and_b32 v95, 0xffff0000, v49
    s_waitcnt lgkmcnt(1)
    v_lshlrev_b32 v96, 16, v50
    v_and_b32 v97, 0xffff0000, v50
    v_lshlrev_b32 v98, 16, v51
    v_and_b32 v99, 0xffff0000, v51
    s_waitcnt lgkmcnt(0)
    v_lshlrev_b32 v100, 16, v52
    v_and_b32 v101, 0xffff0000, v52
    v_lshlrev_b32 v102, 16, v53
    v_and_b32 v103, 0xffff0000, v53
    v_pk_mul_f32 v[104:105], v[84:85], v[54:55]
    v_pk_mul_f32 v[106:107], v[86:87], v[56:57]
    v_pk_mul_f32 v[108:109], v[88:89], v[58:59]
    v_pk_mul_f32 v[110:111], v[90:91], v[60:61]
    v_pk_mul_f32 v[112:113], v[92:93], v[62:63]
    v_pk_mul_f32 v[114:115], v[94:95], v[64:65]
    v_pk_mul_f32 v[116:117], v[96:97], v[66:67]
    v_pk_mul_f32 v[118:119], v[98:99], v[68:69]
    v_pk_mul_f32 v[120:121], v[100:101], v[70:71]
    v_pk_mul_f32 v[122:123], v[102:103], v[72:73]
    s_add_u32 m0, s22, 12288
    s_add_u32 s13, s28, 14336
    buffer_load_dwordx4 v6, s[40:43], s13 offen offset:0 sc1 lds
    v_pk_add_f32 v[124:125], v[84:85], v[86:87]
    v_pk_mul_f32 v[126:127], v[84:85], v[84:85]
    v_pk_add_f32 v[128:129], v[104:105], v[106:107]
    v_pk_mul_f32 v[130:131], v[104:105], v[104:105]
    v_pk_mul_f32 v[132:133], v[104:105], v[54:55]
    v_pk_mul_f32 v[134:135], v[104:105], v[24:25]
    buffer_load_dwordx4 v6, s[40:43], s13 offen offset:1024 sc1 lds
    v_pk_fma_f32 v[126:127], v[86:87], v[86:87], v[126:127]
    v_pk_fma_f32 v[130:131], v[106:107], v[106:107], v[130:131]
    v_pk_fma_f32 v[132:133], v[106:107], v[56:57], v[132:133]
    v_pk_fma_f32 v[134:135], v[106:107], v[26:27], v[134:135]
    s_add_u32 m0, s22, 14336
    s_add_u32 s13, s28, 16384
    buffer_load_dwordx4 v6, s[40:43], s13 offen offset:0 sc1 lds
    v_pk_add_f32 v[124:125], v[124:125], v[88:89]
    v_pk_fma_f32 v[126:127], v[88:89], v[88:89], v[126:127]
    v_pk_add_f32 v[128:129], v[128:129], v[108:109]
    v_pk_fma_f32 v[130:131], v[108:109], v[108:109], v[130:131]
    v_pk_fma_f32 v[132:133], v[108:109], v[58:59], v[132:133]
    v_pk_fma_f32 v[134:135], v[108:109], v[28:29], v[134:135]
    buffer_load_dwordx4 v6, s[40:43], s13 offen offset:1024 sc1 lds
    v_pk_add_f32 v[124:125], v[124:125], v[90:91]
    v_pk_fma_f32 v[126:127], v[90:91], v[90:91], v[126:127]
    v_pk_add_f32 v[128:129], v[128:129], v[110:111]
    v_pk_fma_f32 v[130:131], v[110:111], v[110:111], v[130:131]
    v_pk_fma_f32 v[132:133], v[110:111], v[60:61], v[132:133]
    v_pk_fma_f32 v[134:135], v[110:111], v[30:31], v[134:135]
    s_add_u32 m0, s22, 16384
    s_add_u32 s13, s28, 8192
    buffer_load_dwordx4 v6, s[40:43], s13 offen offset:0 sc1 lds
    v_pk_add_f32 v[124:125], v[124:125], v[92:93]
    v_pk_fma_f32 v[126:127], v[92:93], v[92:93], v[126:127]
    v_pk_add_f32 v[128:129], v[128:129], v[112:113]
    v_pk_fma_f32 v[130:131], v[112:113], v[112:113], v[130:131]
    v_pk_fma_f32 v[132:133], v[112:113], v[62:63], v[132:133]
    v_pk_fma_f32 v[134:135], v[112:113], v[32:33], v[134:135]
    buffer_load_dwordx4 v6, s[40:43], s13 offen offset:1024 sc1 lds
    v_pk_add_f32 v[124:125], v[124:125], v[94:95]
    v_pk_fma_f32 v[126:127], v[94:95], v[94:95], v[126:127]
    v_pk_add_f32 v[128:129], v[128:129], v[114:115]
    v_pk_fma_f32 v[130:131], v[114:115], v[114:115], v[130:131]
    v_pk_fma_f32 v[132:133], v[114:115], v[64:65], v[132:133]
    v_pk_fma_f32 v[134:135], v[114:115], v[34:35], v[134:135]
    s_add_u32 m0, s22, 18432
    s_add_u32 s13, s28, 18432
    buffer_load_dwordx4 v6, s[40:43], s13 offen offset:0 sc1 lds
    v_pk_add_f32 v[124:125], v[124:125], v[96:97]
    v_pk_fma_f32 v[126:127], v[96:97], v[96:97], v[126:127]
    v_pk_add_f32 v[128:129], v[128:129], v[116:117]
    v_pk_fma_f32 v[130:131], v[116:117], v[116:117], v[130:131]
    v_pk_fma_f32 v[132:133], v[116:117], v[66:67], v[132:133]
    v_pk_fma_f32 v[134:135], v[116:117], v[36:37], v[134:135]
    buffer_load_dwordx4 v6, s[40:43], s13 offen offset:1024 sc1 lds
    v_pk_add_f32 v[124:125], v[124:125], v[98:99]
    v_pk_fma_f32 v[126:127], v[98:99], v[98:99], v[126:127]
    v_pk_add_f32 v[128:129], v[128:129], v[118:119]
    v_pk_fma_f32 v[130:131], v[118:119], v[118:119], v[130:131]
    v_pk_fma_f32 v[132:133], v[118:119], v[68:69], v[132:133]
    v_pk_fma_f32 v[134:135], v[118:119], v[38:39], v[134:135]
    v_pk_add_f32 v[124:125], v[124:125], v[100:101]
    v_pk_fma_f32 v[126:127], v[100:101], v[100:101], v[126:127]
    v_pk_add_f32 v[128:129], v[128:129], v[120:121]
    v_pk_fma_f32 v[130:131], v[120:121], v[120:121], v[130:131]
    v_pk_fma_f32 v[132:133], v[120:121], v[70:71], v[132:133]
    v_pk_fma_f32 v[134:135], v[120:121], v[40:41], v[134:135]
    v_pk_add_f32 v[124:125], v[124:125], v[102:103]
    v_pk_fma_f32 v[126:127], v[102:103], v[102:103], v[126:127]
    v_pk_add_f32 v[128:129], v[128:129], v[122:123]
    v_pk_fma_f32 v[130:131], v[122:123], v[122:123], v[130:131]
    v_pk_fma_f32 v[132:133], v[122:123], v[72:73], v[132:133]
    v_pk_fma_f32 v[134:135], v[122:123], v[42:43], v[134:135]
    s_waitcnt vmcnt(16)
    ds_read_b64_tr_b16 v[156:157], v8 offset:0
    ds_read_b64_tr_b16 v[158:159], v8 offset:2048
    ds_read_b64_tr_b16 v[160:161], v9 offset:0
    ds_read_b64_tr_b16 v[162:163], v9 offset:2048
    ds_read_b64_tr_b16 v[164:165], v10 offset:0
    ds_read_b64_tr_b16 v[166:167], v10 offset:2048
    ds_read_b64_tr_b16 v[168:169], v11 offset:0
    ds_read_b64_tr_b16 v[170:171], v11 offset:2048
    v_add_f32 v84, v124, v125
    v_add_f32 v85, v126, v127
    v_add_f32 v86, v128, v129
    v_add_f32 v88, v130, v131
    v_add_f32 v89, v132, v133
    v_add_f32 v90, v134, v135
    v_permlane16_swap_b32 v84, v88
    v_permlane16_swap_b32 v85, v89
    v_permlane16_swap_b32 v86, v90
    v_add_f32 v84, v84, v88
    v_add_f32 v85, v85, v89
    v_add_f32 v86, v86, v90
    v_mov_b32 v88, v84
    v_mov_b32 v89, v85
    v_mov_b32 v90, v86
    v_mov_b32 v87, s38
    v_permlane32_swap_b32 v84, v88
    v_permlane32_swap_b32 v85, v89
    v_permlane32_swap_b32 v86, v90
    v_add_f32 v84, v84, v88
    v_add_f32 v85, v85, v89
    v_add_f32 v86, v86, v90
    s_mov_b32 exec_hi, 0
    s_bitcmp1_b32 s36, 0
    s_cbranch_scc1 L_DF0
    buffer_store_dwordx4 v[84:87], v4, s[40:43], s12 offen sc1
    s_branch L_DE0
L_DF0:
    buffer_store_dwordx4 v[84:87], v4, s[40:43], s12 offen
L_DE0:
    s_mov_b32 exec_hi, -1
    s_waitcnt lgkmcnt(0)
    v_mfma_f32_16x16x32_bf16 v[116:119], a[0:3], v[156:159], 0
    v_mfma_f32_16x16x32_bf16 v[120:123], a[4:7], v[156:159], 0
    s_waitcnt vmcnt(13)
    v_mfma_f32_16x16x32_bf16 v[124:127], a[8:11], v[156:159], 0
    ds_read_b64_tr_b16 v[172:173], v8 offset:4096
    v_mfma_f32_16x16x32_bf16 v[128:131], a[12:15], v[156:159], 0
    buffer_load_dwordx4 v[208:211], v4, s[40:43], s3 offen offset:1024 sc1
    v_mfma_f32_16x16x32_bf16 v[132:135], a[16:19], v[156:159], 0
    ds_read_b64_tr_b16 v[174:175], v8 offset:6144
    v_mfma_f32_16x16x32_bf16 v[136:139], a[0:3], v[160:163], 0
    ds_read_b64_tr_b16 v[176:177], v9 offset:4096
    v_mfma_f32_16x16x32_bf16 v[140:143], a[4:7], v[160:163], 0
    ds_read_b64_tr_b16 v[178:179], v9 offset:6144
    v_mfma_f32_16x16x32_bf16 v[144:147], a[8:11], v[160:163], 0
    v_mfma_f32_16x16x32_bf16 v[148:151], a[12:15], v[160:163], 0
    buffer_load_dwordx4 v[212:215], v4, s[40:43], s3 offen offset:2048 sc1
    v_mfma_f32_16x16x32_bf16 v[152:155], a[16:19], v[160:163], 0
    ds_read_b64_tr_b16 v[180:181], v10 offset:4096
    v_mfma_f32_16x16x32_bf16 v[76:79], a[0:3], v[164:167], 0
    ds_read_b64_tr_b16 v[182:183], v10 offset:6144
    v_mfma_f32_16x16x32_bf16 v[80:83], a[4:7], v[164:167], 0
    ds_read_b64_tr_b16 v[184:185], v11 offset:4096
    v_mfma_f32_16x16x32_bf16 v[84:87], a[8:11], v[164:167], 0
    buffer_load_dwordx4 v[216:219], v4, s[40:43], s3 offen offset:3072 sc1
    v_mfma_f32_16x16x32_bf16 v[88:91], a[12:15], v[164:167], 0
    ds_read_b64_tr_b16 v[186:187], v11 offset:6144
    v_mfma_f32_16x16x32_bf16 v[92:95], a[16:19], v[164:167], 0
    v_mfma_f32_16x16x32_bf16 v[96:99], a[0:3], v[168:171], 0
    v_mfma_f32_16x16x32_bf16 v[100:103], a[4:7], v[168:171], 0
    s_add_u32 s3, s18, 20480
    v_mfma_f32_16x16x32_bf16 v[104:107], a[8:11], v[168:171], 0
    v_mfma_f32_16x16x32_bf16 v[108:111], a[12:15], v[168:171], 0
    v_mfma_f32_16x16x32_bf16 v[112:115], a[16:19], v[168:171], 0
    buffer_load_dwordx4 v[220:223], v4, s[40:43], s3 offen offset:0 sc1
    s_waitcnt lgkmcnt(0)
    v_mfma_f32_16x16x32_bf16 v[116:119], a[20:23], v[172:175], v[116:119]
    v_mfma_f32_16x16x32_bf16 v[120:123], a[24:27], v[172:175], v[120:123]
    s_waitcnt vmcnt(13)
    v_mfma_f32_16x16x32_bf16 v[124:127], a[28:31], v[172:175], v[124:127]
    ds_read_b64_tr_b16 v[156:157], v8 offset:8192
    v_mfma_f32_16x16x32_bf16 v[128:131], a[32:35], v[172:175], v[128:131]
    buffer_load_dwordx4 v[224:227], v4, s[40:43], s3 offen offset:1024 sc1
    v_mfma_f32_16x16x32_bf16 v[132:135], a[36:39], v[172:175], v[132:135]
    ds_read_b64_tr_b16 v[158:159], v8 offset:10240
    v_mfma_f32_16x16x32_bf16 v[136:139], a[20:23], v[176:179], v[136:139]
    ds_read_b64_tr_b16 v[160:161], v9 offset:8192
    v_mfma_f32_16x16x32_bf16 v[140:143], a[24:27], v[176:179], v[140:143]
    ds_read_b64_tr_b16 v[162:163], v9 offset:10240
    v_mfma_f32_16x16x32_bf16 v[144:147], a[28:31], v[176:179], v[144:147]
    v_mfma_f32_16x16x32_bf16 v[148:151], a[32:35], v[176:179], v[148:151]
    buffer_load_dwordx4 v[228:231], v4, s[40:43], s3 offen offset:2048 sc1
    v_mfma_f32_16x16x32_bf16 v[152:155], a[36:39], v[176:179], v[152:155]
    ds_read_b64_tr_b16 v[164:165], v10 offset:8192
    v_mfma_f32_16x16x32_bf16 v[76:79], a[20:23], v[180:183], v[76:79]
    ds_read_b64_tr_b16 v[166:167], v10 offset:10240
    v_mfma_f32_16x16x32_bf16 v[80:83], a[24:27], v[180:183], v[80:83]
    ds_read_b64_tr_b16 v[168:169], v11 offset:8192
    v_mfma_f32_16x16x32_bf16 v[84:87], a[28:31], v[180:183], v[84:87]
    buffer_load_dwordx4 v[232:235], v4, s[40:43], s3 offen offset:3072 sc1
    v_mfma_f32_16x16x32_bf16 v[88:91], a[32:35], v[180:183], v[88:91]
    ds_read_b64_tr_b16 v[170:171], v11 offset:10240
    v_mfma_f32_16x16x32_bf16 v[92:95], a[36:39], v[180:183], v[92:95]
    v_mfma_f32_16x16x32_bf16 v[96:99], a[20:23], v[184:187], v[96:99]
    v_mfma_f32_16x16x32_bf16 v[100:103], a[24:27], v[184:187], v[100:103]
    s_add_u32 s3, s18, 24576
    v_mfma_f32_16x16x32_bf16 v[104:107], a[28:31], v[184:187], v[104:107]
    v_mfma_f32_16x16x32_bf16 v[108:111], a[32:35], v[184:187], v[108:111]
    v_mfma_f32_16x16x32_bf16 v[112:115], a[36:39], v[184:187], v[112:115]
    buffer_load_dwordx4 v[236:239], v4, s[40:43], s3 offen offset:0 sc1
    s_waitcnt lgkmcnt(0)
    v_mfma_f32_16x16x32_bf16 v[116:119], a[40:43], v[156:159], v[116:119]
    v_mfma_f32_16x16x32_bf16 v[120:123], a[44:47], v[156:159], v[120:123]
    s_waitcnt vmcnt(13)
    v_mfma_f32_16x16x32_bf16 v[124:127], a[48:51], v[156:159], v[124:127]
    ds_read_b64_tr_b16 v[172:173], v8 offset:12288
    v_mfma_f32_16x16x32_bf16 v[128:131], a[52:55], v[156:159], v[128:131]
    buffer_load_dwordx4 v[240:243], v4, s[40:43], s3 offen offset:1024 sc1
    v_mfma_f32_16x16x32_bf16 v[132:135], a[56:59], v[156:159], v[132:135]
    ds_read_b64_tr_b16 v[174:175], v8 offset:14336
    v_mfma_f32_16x16x32_bf16 v[136:139], a[40:43], v[160:163], v[136:139]
    ds_read_b64_tr_b16 v[176:177], v9 offset:12288
    v_mfma_f32_16x16x32_bf16 v[140:143], a[44:47], v[160:163], v[140:143]
    ds_read_b64_tr_b16 v[178:179], v9 offset:14336
    v_mfma_f32_16x16x32_bf16 v[144:147], a[48:51], v[160:163], v[144:147]
    v_mfma_f32_16x16x32_bf16 v[148:151], a[52:55], v[160:163], v[148:151]
    buffer_load_dwordx4 v[244:247], v4, s[40:43], s3 offen offset:2048 sc1
    v_mfma_f32_16x16x32_bf16 v[152:155], a[56:59], v[160:163], v[152:155]
    ds_read_b64_tr_b16 v[180:181], v10 offset:12288
    v_mfma_f32_16x16x32_bf16 v[76:79], a[40:43], v[164:167], v[76:79]
    ds_read_b64_tr_b16 v[182:183], v10 offset:14336
    v_mfma_f32_16x16x32_bf16 v[80:83], a[44:47], v[164:167], v[80:83]
    ds_read_b64_tr_b16 v[184:185], v11 offset:12288
    v_mfma_f32_16x16x32_bf16 v[84:87], a[48:51], v[164:167], v[84:87]
    buffer_load_dwordx4 v[248:251], v4, s[40:43], s3 offen offset:3072 sc1
    v_mfma_f32_16x16x32_bf16 v[88:91], a[52:55], v[164:167], v[88:91]
    ds_read_b64_tr_b16 v[186:187], v11 offset:14336
    v_mfma_f32_16x16x32_bf16 v[92:95], a[56:59], v[164:167], v[92:95]
    v_mfma_f32_16x16x32_bf16 v[96:99], a[40:43], v[168:171], v[96:99]
    v_mfma_f32_16x16x32_bf16 v[100:103], a[44:47], v[168:171], v[100:103]
    s_add_u32 s3, s18, 28672
    v_mfma_f32_16x16x32_bf16 v[104:107], a[48:51], v[168:171], v[104:107]
    v_mfma_f32_16x16x32_bf16 v[108:111], a[52:55], v[168:171], v[108:111]
    v_mfma_f32_16x16x32_bf16 v[112:115], a[56:59], v[168:171], v[112:115]
    buffer_load_dwordx4 v[252:255], v4, s[40:43], s3 offen offset:0 sc1
    s_waitcnt lgkmcnt(0)
    v_mfma_f32_16x16x32_bf16 v[116:119], a[60:63], v[172:175], v[116:119]
    s_waitcnt vmcnt(13)
    v_mfma_f32_16x16x32_bf16 v[120:123], a[64:67], v[172:175], v[120:123]
    s_add_u32 s3, s19, 16384
    v_mfma_f32_16x16x32_bf16 v[124:127], a[68:71], v[172:175], v[124:127]
    ds_read_b64_tr_b16 v[156:157], v8 offset:16384
    v_mfma_f32_16x16x32_bf16 v[128:131], a[72:75], v[172:175], v[128:131]
    ds_read_b64_tr_b16 v[158:159], v8 offset:18432
    v_mfma_f32_16x16x32_bf16 v[132:135], a[76:79], v[172:175], v[132:135]
    s_add_u32 m0, s20, 1024
    v_mfma_f32_16x16x32_bf16 v[136:139], a[60:63], v[176:179], v[136:139]
    ds_read_b64_tr_b16 v[160:161], v9 offset:16384
    v_mfma_f32_16x16x32_bf16 v[140:143], a[64:67], v[176:179], v[140:143]
    ds_read_b64_tr_b16 v[162:163], v9 offset:18432
    v_mfma_f32_16x16x32_bf16 v[144:147], a[68:71], v[176:179], v[144:147]
    buffer_load_dwordx4 v4, s[40:43], s3 offen offset:3072 sc1  lds
    v_mfma_f32_16x16x32_bf16 v[148:151], a[72:75], v[176:179], v[148:151]
    ds_read_b64_tr_b16 v[164:165], v10 offset:16384
    v_mfma_f32_16x16x32_bf16 v[152:155], a[76:79], v[176:179], v[152:155]
    s_add_u32 s3, s19, 20480
    v_mfma_f32_16x16x32_bf16 v[76:79], a[60:63], v[180:183], v[76:79]
    ds_read_b64_tr_b16 v[166:167], v10 offset:18432
    v_mfma_f32_16x16x32_bf16 v[80:83], a[64:67], v[180:183], v[80:83]
    ds_read_b64_tr_b16 v[168:169], v11 offset:16384
    v_mfma_f32_16x16x32_bf16 v[84:87], a[68:71], v[180:183], v[84:87]
    s_add_u32 m0, s20, 5120
    v_mfma_f32_16x16x32_bf16 v[88:91], a[72:75], v[180:183], v[88:91]
    ds_read_b64_tr_b16 v[170:171], v11 offset:18432
    v_mfma_f32_16x16x32_bf16 v[92:95], a[76:79], v[180:183], v[92:95]
    v_mfma_f32_16x16x32_bf16 v[96:99], a[60:63], v[184:187], v[96:99]
    buffer_load_dwordx4 v4, s[40:43], s3 offen offset:0 sc1  lds
    v_mfma_f32_16x16x32_bf16 v[100:103], a[64:67], v[184:187], v[100:103]
    v_mfma_f32_16x16x32_bf16 v[104:107], a[68:71], v[184:187], v[104:107]
    buffer_load_dwordx4 v4, s[40:43], s3 offen offset:1024 sc1  lds
    v_mfma_f32_16x16x32_bf16 v[108:111], a[72:75], v[184:187], v[108:111]
    v_mfma_f32_16x16x32_bf16 v[112:115], a[76:79], v[184:187], v[112:115]
    buffer_load_dwordx4 v4, s[40:43], s3 offen offset:2048 sc1  lds
    s_and_b32 s28, s12, 0xfffff000
    s_waitcnt lgkmcnt(0)
    v_mfma_f32_16x16x32_bf16 v[116:119], a[80:83], v[156:159], v[116:119]
    v_mfma_f32_16x16x32_bf16 v[120:123], a[84:87], v[156:159], v[120:123]
    v_mfma_f32_16x16x32_bf16 v[124:127], a[88:91], v[156:159], v[124:127]
    buffer_load_dwordx4 v[172:175], v4, s[40:43], s28 offen offset:0 sc1
    v_mfma_f32_16x16x32_bf16 v[128:131], a[92:95], v[156:159], v[128:131]
    v_mfma_f32_16x16x32_bf16 v[132:135], a[96:99], v[156:159], v[132:135]
    buffer_load_dwordx4 v[176:179], v4, s[40:43], s28 offen offset:1024 sc1
    v_mfma_f32_16x16x32_bf16 v[136:139], a[80:83], v[160:163], v[136:139]
    v_mfma_f32_16x16x32_bf16 v[140:143], a[84:87], v[160:163], v[140:143]
    v_mfma_f32_16x16x32_bf16 v[144:147], a[88:91], v[160:163], v[144:147]
    buffer_load_dwordx4 v[180:183], v4, s[40:43], s28 offen offset:2048 sc1
    v_mfma_f32_16x16x32_bf16 v[148:151], a[92:95], v[160:163], v[148:151]
    v_mfma_f32_16x16x32_bf16 v[152:155], a[96:99], v[160:163], v[152:155]
    buffer_load_dwordx4 v[184:187], v4, s[40:43], s28 offen offset:3072 sc1
    v_mfma_f32_16x16x32_bf16 v[76:79], a[80:83], v[164:167], v[76:79]
    ds_write_b128 v13, v[116:119] offset:0
    v_mfma_f32_16x16x32_bf16 v[80:83], a[84:87], v[164:167], v[80:83]
    ds_write_b128 v13, v[120:123] offset:1024
    v_mfma_f32_16x16x32_bf16 v[84:87], a[88:91], v[164:167], v[84:87]
    ds_write_b128 v13, v[124:127] offset:2048
    v_mfma_f32_16x16x32_bf16 v[88:91], a[92:95], v[164:167], v[88:91]
    ds_write_b128 v13, v[128:131] offset:3072
    v_mfma_f32_16x16x32_bf16 v[92:95], a[96:99], v[164:167], v[92:95]
    ds_write_b128 v13, v[132:135] offset:4096
    v_mfma_f32_16x16x32_bf16 v[96:99], a[80:83], v[168:171], v[96:99]
    ds_write_b128 v14, v[136:139] offset:0
    v_mfma_f32_16x16x32_bf16 v[100:103], a[84:87], v[168:171], v[100:103]
    ds_write_b128 v14, v[140:143] offset:1024
    v_mfma_f32_16x16x32_bf16 v[104:107], a[88:91], v[168:171], v[104:107]
    ds_write_b128 v14, v[144:147] offset:2048
    v_mfma_f32_16x16x32_bf16 v[108:111], a[92:95], v[168:171], v[108:111]
    ds_write_b128 v14, v[148:151] offset:3072
    v_mfma_f32_16x16x32_bf16 v[112:115], a[96:99], v[168:171], v[112:115]
    ds_write_b128 v14, v[152:155] offset:4096
    ds_write_b128 v15, v[76:79] offset:0
    s_lshr_b32 s39, s54, 2
    s_add_u32 s39, s39, 1
    s_sub_u32 s59, 0, s39
    s_bitcmp1_b32 s54, 1
    s_cselect_b32 s39, s59, s39
    ds_write_b128 v15, v[80:83] offset:1024
    v_add_u32 v17, s39, v20
    v_and_b32 v19, 15, v17
    v_lshlrev_b32 v19, 4, v19
    v_lshl_add_u32 v19, v3, 8, v19
    v_bfe_u32 v18, v17, 4, 2
    ds_write_b128 v15, v[84:87] offset:2048
    v_lshl_add_u32 v18, v18, 10, v19
    v_add_u32 v10, 4096, v19
    v_lshrrev_b32 v19, 1, v18
    v_lshrrev_b32 v11, 1, v10
    v_cmp_gt_u32 vcc, 0x800, v17
    v_lshrrev_b32 v17, 6, v17
    ds_write_b128 v15, v[88:91] offset:3072
    v_lshlrev_b32 v9, 17, v17
    v_cndmask_b32 v9, 2.0, v9, vcc
    v_cmp_eq_u32 vcc, s53, v17
    s_mul_i32 s13, s54, 12800
    s_nop 0
    ds_write_b128 v15, v[92:95] offset:4096
    v_cndmask_b32 v8, v9, 2.0, vcc
    v_cndmask_b32 v9, 2.0, v9, vcc
    v_add_u32 v10, v10, v8
    v_add_u32 v11, v11, v8
    v_add_u32 v18, v18, v9
    v_add_u32 v19, v19, v9
    s_waitcnt lgkmcnt(0)
    s_barrier
    ds_read_b128 v[116:119], v16 offset:0
    ds_read_b128 v[120:123], v16 offset:1024
    ds_read_b128 v[124:127], v16 offset:2048
    ds_read_b128 v[128:131], v16 offset:3072
    ds_read_b128 v[132:135], v16 offset:4096
    ds_read_b128 v[136:139], v16 offset:5120
    ds_read_b128 v[140:143], v16 offset:6144
    ds_read_b128 v[144:147], v16 offset:7168
    ds_read_b128 v[148:151], v16 offset:8192
    ds_read_b128 v[152:155], v16 offset:9216
    ds_read_b128 v[76:79], v16 offset:10240
    ds_read_b128 v[80:83], v16 offset:11264
    ds_read_b128 v[84:87], v16 offset:12288
    ds_read_b128 v[88:91], v16 offset:13312
    ds_read_b128 v[92:95], v16 offset:14336
    s_waitcnt vmcnt(3)
    v_xor_b32 v156, s38, v175
    s_waitcnt vmcnt(2)
    v_xor_b32 v157, s38, v179
    s_waitcnt vmcnt(1)
    v_xor_b32 v158, s38, v183
    s_waitcnt vmcnt(0)
    v_xor_b32 v159, s38, v187
    v_pk_add_f32 v[172:173], v[172:173], v[176:177]
    v_pk_add_f32 v[174:175], v[174:175], v[178:179]
    v_or3_b32 v156, v156, v157, v158
    v_pk_add_f32 v[180:181], v[180:181], v[184:185]
    v_pk_add_f32 v[182:183], v[182:183], v[186:187]
    v_or_b32 v156, v156, v159
    v_pk_add_f32 v[172:173], v[172:173], v[180:181]
    v_pk_add_f32 v[174:175], v[174:175], v[182:183]
    v_cmp_ne_u32 vcc, 0, v156
    s_cbranch_vccz L_SOK
    s_mov_b32 s59, 0
L_SRT:
    buffer_load_dwordx4 v[172:175], v4, s[40:43], s28 offen offset:0 sc1
    buffer_load_dwordx4 v[176:179], v4, s[40:43], s28 offen offset:1024 sc1
    buffer_load_dwordx4 v[180:183], v4, s[40:43], s28 offen offset:2048 sc1
    buffer_load_dwordx4 v[184:187], v4, s[40:43], s28 offen offset:3072 sc1
    s_add_u32 s59, s59, 1
    s_cmp_gt_u32 s59, 0x100000
    s_waitcnt vmcnt(0)
    s_cbranch_scc1 L_SOK
    v_xor_b32 v156, s38, v175
    v_xor_b32 v157, s38, v179
    v_xor_b32 v158, s38, v183
    v_xor_b32 v159, s38, v187
    v_pk_add_f32 v[172:173], v[172:173], v[176:177]
    v_pk_add_f32 v[174:175], v[174:175], v[178:179]
    v_or3_b32 v156, v156, v157, v158
    v_pk_add_f32 v[180:181], v[180:181], v[184:185]
    v_pk_add_f32 v[182:183], v[182:183], v[186:187]
    v_or_b32 v156, v156, v159
    v_pk_add_f32 v[172:173], v[172:173], v[180:181]
    v_pk_add_f32 v[174:175], v[174:175], v[182:183]
    v_cmp_ne_u32 vcc, 0, v156
    s_cbranch_vccnz L_SRT
L_SOK:
    v_mov_b32 v176, v172
    v_mov_b32 v177, v173
    v_mov_b32 v178, v174
    v_permlane32_swap_b32 v172, v176
    v_permlane32_swap_b32 v173, v177
    v_permlane32_swap_b32 v174, v178
    v_add_f32 v172, v172, v176
    v_add_f32 v173, v173, v177
    v_add_f32 v174, v174, v178
    v_mov_b32 v176, v172
    v_mov_b32 v177, v173
    v_mov_b32 v178, v174
    v_permlane16_swap_b32 v172, v176
    v_permlane16_swap_b32 v173, v177
    v_permlane16_swap_b32 v174, v178
    s_waitcnt lgkmcnt(0)
    v_pk_add_f32 v[96:97], v[96:97], v[116:117]
    v_pk_add_f32 v[98:99], v[98:99], v[118:119]
    v_mul_f32 v181, 0x3acccccd, v172
    v_pk_add_f32 v[100:101], v[100:101], v[120:121]
    v_mul_f32 v180, 0x3acccccd, v173
    v_pk_add_f32 v[102:103], v[102:103], v[122:123]
    v_fma_f32 v180, -v181, v181, v180
    v_pk_add_f32 v[104:105], v[104:105], v[124:125]
    v_max_f32 v180, 0, v180
    s_add_u32 s3, s18, 28672
    buffer_load_dwordx4 a[0:3], v4, s[40:43], s3 offen offset:1024 sc1
    v_pk_add_f32 v[106:107], v[106:107], v[126:127]
    v_pk_add_f32 v[108:109], v[108:109], v[128:129]
    v_add_f32 v180, 0x3727c5ac, v180
    v_pk_add_f32 v[110:111], v[110:111], v[130:131]
    v_rsq_f32 v180, v180
    v_pk_add_f32 v[112:113], v[112:113], v[132:133]
    v_fma_f32 v174, -v181, v194, v174
    v_pk_add_f32 v[114:115], v[114:115], v[134:135]
    v_fma_f32 v178, -v181, v189, v178
    v_pk_add_f32 v[96:97], v[96:97], v[136:137]
    v_add_f32 v177, v177, v177
    v_pk_add_f32 v[98:99], v[98:99], v[138:139]
    ds_read_b128 v[116:119], v12 offset:0
    v_pk_add_f32 v[100:101], v[100:101], v[140:141]
    buffer_load_dwordx4 a[4:7], v4, s[40:43], s3 offen offset:2048 sc1
    v_fma_f32 v177, -v181, v193, v177
    v_pk_add_f32 v[102:103], v[102:103], v[142:143]
    ds_read_b128 v[120:123], v12 offset:64
    v_fma_f32 v176, -v181, v177, v176
    v_pk_add_f32 v[104:105], v[104:105], v[144:145]
    v_fma_f32 v174, v180, v174, v190
    v_pk_add_f32 v[106:107], v[106:107], v[146:147]
    ds_read_b128 v[124:127], v12 offset:128
    v_pk_add_f32 v[108:109], v[108:109], v[148:149]
    v_add_f32 v178, v178, v178
    v_fma_f32 v176, v180, v176, v178
    v_pk_add_f32 v[110:111], v[110:111], v[150:151]
    ds_read_b128 v[128:131], v12 offset:192
    v_pk_add_f32 v[112:113], v[112:113], v[152:153]
    buffer_load_dwordx4 a[8:11], v4, s[40:43], s3 offen offset:3072 sc1
    v_fma_f32 v176, v180, v176, v188
    v_pk_add_f32 v[114:115], v[114:115], v[154:155]
    ds_read_b128 v[132:135], v12 offset:256
    v_mul_f32 v182, 0x3acccccd, v174
    v_pk_add_f32 v[96:97], v[96:97], v[76:77]
    v_mul_f32 v183, 0x3acccccd, v176
    v_pk_add_f32 v[98:99], v[98:99], v[78:79]
    ds_read_b128 v[136:139], v12 offset:384
    v_pk_add_f32 v[100:101], v[100:101], v[80:81]
    v_fma_f32 v183, -v182, v182, v183
    v_max_f32 v183, 0, v183
    v_pk_add_f32 v[102:103], v[102:103], v[82:83]
    ds_read_b128 v[140:143], v12 offset:448
    v_pk_add_f32 v[104:105], v[104:105], v[84:85]
    s_add_u32 s3, s18, 32768
    buffer_load_dwordx4 a[12:15], v4, s[40:43], s3 offen offset:0 sc1
    v_add_f32 v183, 0x3727c5ac, v183
    ds_read_b128 v[144:147], v12 offset:512
    v_pk_add_f32 v[106:107], v[106:107], v[86:87]
    v_rsq_f32 v183, v183
    v_pk_add_f32 v[108:109], v[108:109], v[88:89]
    v_mul_f32 v181, -v181, v180
    v_pk_add_f32 v[110:111], v[110:111], v[90:91]
    ds_read_b128 v[148:151], v12 offset:576
    v_mul_f32 v184, v183, v180
    v_pk_add_f32 v[112:113], v[112:113], v[92:93]
    v_mul_f32 v185, v183, v181
    v_pk_add_f32 v[114:115], v[114:115], v[94:95]
    ds_read_b128 v[152:155], v12 offset:640
    v_mul_f32 v182, -v182, v183
    buffer_load_dwordx4 a[16:19], v4, s[40:43], s3 offen offset:1024 sc1
    ds_read_b128 v[76:79], v12 offset:768
    ds_read_b128 v[80:83], v12 offset:832
    ds_read_b128 v[84:87], v12 offset:896
    ds_read_b128 v[88:91], v12 offset:960
    ds_read_b128 v[92:95], v12 offset:1024
    v_pk_mul_f32 v[96:97], v[96:97], v[184:185] op_sel_hi:[1,0]
    v_pk_mul_f32 v[98:99], v[98:99], v[184:185] op_sel_hi:[1,0]
    v_pk_mul_f32 v[100:101], v[100:101], v[184:185] op_sel_hi:[1,0]
    v_pk_mul_f32 v[102:103], v[102:103], v[184:185] op_sel_hi:[1,0]
    v_pk_mul_f32 v[104:105], v[104:105], v[184:185] op_sel_hi:[1,0]
    v_pk_mul_f32 v[106:107], v[106:107], v[184:185] op_sel_hi:[1,0]
    v_pk_mul_f32 v[108:109], v[108:109], v[184:185] op_sel_hi:[1,0]
    v_pk_mul_f32 v[110:111], v[110:111], v[184:185] op_sel_hi:[1,0]
    v_pk_mul_f32 v[112:113], v[112:113], v[184:185] op_sel_hi:[1,0]
    buffer_load_dwordx4 a[20:23], v4, s[40:43], s3 offen offset:2048 sc1
    v_pk_mul_f32 v[114:115], v[114:115], v[184:185] op_sel_hi:[1,0]
    s_waitcnt lgkmcnt(5)
    v_pk_fma_f32 v[96:97], v[116:117], v[182:183], v[96:97] op_sel:[0,1,0] op_sel_hi:[1,1,1]
    v_pk_fma_f32 v[98:99], v[118:119], v[182:183], v[98:99] op_sel:[0,1,0] op_sel_hi:[1,1,1]
    v_pk_fma_f32 v[100:101], v[120:121], v[182:183], v[100:101] op_sel:[0,1,0] op_sel_hi:[1,1,1]
    v_pk_fma_f32 v[102:103], v[122:123], v[182:183], v[102:103] op_sel:[0,1,0] op_sel_hi:[1,1,1]
    v_pk_fma_f32 v[104:105], v[124:125], v[182:183], v[104:105] op_sel:[0,1,0] op_sel_hi:[1,1,1]
    v_pk_fma_f32 v[106:107], v[126:127], v[182:183], v[106:107] op_sel:[0,1,0] op_sel_hi:[1,1,1]
    v_pk_fma_f32 v[108:109], v[128:129], v[182:183], v[108:109] op_sel:[0,1,0] op_sel_hi:[1,1,1]
    v_pk_fma_f32 v[110:111], v[130:131], v[182:183], v[110:111] op_sel:[0,1,0] op_sel_hi:[1,1,1]
    v_pk_fma_f32 v[112:113], v[132:133], v[182:183], v[112:113] op_sel:[0,1,0] op_sel_hi:[1,1,1]
    v_pk_fma_f32 v[114:115], v[134:135], v[182:183], v[114:115] op_sel:[0,1,0] op_sel_hi:[1,1,1]
    v_pk_fma_f32 v[96:97], v[136:137], v[184:185], v[96:97] op_sel:[0,1,0] op_sel_hi:[1,1,1]
    v_pk_fma_f32 v[98:99], v[138:139], v[184:185], v[98:99] op_sel:[0,1,0] op_sel_hi:[1,1,1]
    v_pk_fma_f32 v[100:101], v[140:141], v[184:185], v[100:101] op_sel:[0,1,0] op_sel_hi:[1,1,1]
    buffer_load_dwordx4 a[24:27], v4, s[40:43], s3 offen offset:3072 sc1
    v_pk_fma_f32 v[102:103], v[142:143], v[184:185], v[102:103] op_sel:[0,1,0] op_sel_hi:[1,1,1]
    v_pk_fma_f32 v[104:105], v[144:145], v[184:185], v[104:105] op_sel:[0,1,0] op_sel_hi:[1,1,1]
    v_pk_fma_f32 v[106:107], v[146:147], v[184:185], v[106:107] op_sel:[0,1,0] op_sel_hi:[1,1,1]
    v_pk_fma_f32 v[108:109], v[148:149], v[184:185], v[108:109] op_sel:[0,1,0] op_sel_hi:[1,1,1]
    v_pk_fma_f32 v[110:111], v[150:151], v[184:185], v[110:111] op_sel:[0,1,0] op_sel_hi:[1,1,1]
    v_pk_fma_f32 v[112:113], v[152:153], v[184:185], v[112:113] op_sel:[0,1,0] op_sel_hi:[1,1,1]
    v_pk_fma_f32 v[114:115], v[154:155], v[184:185], v[114:115] op_sel:[0,1,0] op_sel_hi:[1,1,1]
    s_waitcnt lgkmcnt(0)
    v_pk_fma_f32 v[96:97], v[76:77], v[182:183], v[96:97] op_sel_hi:[1,0,1]
    v_pk_fma_f32 v[98:99], v[78:79], v[182:183], v[98:99] op_sel_hi:[1,0,1]
    v_pk_fma_f32 v[100:101], v[80:81], v[182:183], v[100:101] op_sel_hi:[1,0,1]
    v_pk_fma_f32 v[102:103], v[82:83], v[182:183], v[102:103] op_sel_hi:[1,0,1]
    v_pk_fma_f32 v[104:105], v[84:85], v[182:183], v[104:105] op_sel_hi:[1,0,1]
    v_pk_fma_f32 v[106:107], v[86:87], v[182:183], v[106:107] op_sel_hi:[1,0,1]
    v_pk_fma_f32 v[108:109], v[88:89], v[182:183], v[108:109] op_sel_hi:[1,0,1]
    s_add_u32 s3, s18, 36864
    buffer_load_dwordx4 a[28:31], v4, s[40:43], s3 offen offset:0 sc1
    v_pk_fma_f32 v[110:111], v[90:91], v[182:183], v[110:111] op_sel_hi:[1,0,1]
    v_pk_fma_f32 v[112:113], v[92:93], v[182:183], v[112:113] op_sel_hi:[1,0,1]
    v_pk_fma_f32 v[114:115], v[94:95], v[182:183], v[114:115] op_sel_hi:[1,0,1]
    v_pk_mul_f32 v[116:117], v[96:97], v[96:97]
    v_pk_mul_f32 v[118:119], v[98:99], v[98:99]
    v_pk_mul_f32 v[120:121], v[100:101], v[100:101]
    v_pk_mul_f32 v[122:123], v[102:103], v[102:103]
    v_pk_mul_f32 v[124:125], v[104:105], v[104:105]
    v_pk_mul_f32 v[126:127], v[106:107], v[106:107]
    v_pk_mul_f32 v[128:129], v[108:109], v[108:109]
    v_pk_mul_f32 v[130:131], v[110:111], v[110:111]
    v_pk_mul_f32 v[132:133], v[112:113], v[112:113]
    v_pk_mul_f32 v[134:135], v[114:115], v[114:115]
    v_pk_fma_f32 v[116:117], v[116:117], v[74:75], v[74:75] op_sel:[0,1,0] op_sel_hi:[1,1,0]
    buffer_load_dwordx4 a[32:35], v4, s[40:43], s3 offen offset:1024 sc1
    v_pk_fma_f32 v[118:119], v[118:119], v[74:75], v[74:75] op_sel:[0,1,0] op_sel_hi:[1,1,0]
    v_pk_fma_f32 v[120:121], v[120:121], v[74:75], v[74:75] op_sel:[0,1,0] op_sel_hi:[1,1,0]
    v_pk_fma_f32 v[122:123], v[122:123], v[74:75], v[74:75] op_sel:[0,1,0] op_sel_hi:[1,1,0]
    v_pk_fma_f32 v[124:125], v[124:125], v[74:75], v[74:75] op_sel:[0,1,0] op_sel_hi:[1,1,0]
    v_pk_fma_f32 v[126:127], v[126:127], v[74:75], v[74:75] op_sel:[0,1,0] op_sel_hi:[1,1,0]
    v_pk_fma_f32 v[128:129], v[128:129], v[74:75], v[74:75] op_sel:[0,1,0] op_sel_hi:[1,1,0]
    v_pk_fma_f32 v[130:131], v[130:131], v[74:75], v[74:75] op_sel:[0,1,0] op_sel_hi:[1,1,0]
    v_pk_fma_f32 v[132:133], v[132:133], v[74:75], v[74:75] op_sel:[0,1,0] op_sel_hi:[1,1,0]
    v_pk_fma_f32 v[134:135], v[134:135], v[74:75], v[74:75] op_sel:[0,1,0] op_sel_hi:[1,1,0]
    v_pk_mul_f32 v[116:117], v[116:117], v[96:97]
    v_pk_mul_f32 v[118:119], v[118:119], v[98:99]
    v_pk_mul_f32 v[120:121], v[120:121], v[100:101]
    v_pk_mul_f32 v[122:123], v[122:123], v[102:103]
    v_pk_mul_f32 v[124:125], v[124:125], v[104:105]
    buffer_load_dwordx4 a[36:39], v4, s[40:43], s3 offen offset:2048 sc1
    v_pk_mul_f32 v[126:127], v[126:127], v[106:107]
    v_pk_mul_f32 v[128:129], v[128:129], v[108:109]
    v_pk_mul_f32 v[130:131], v[130:131], v[110:111]
    v_pk_mul_f32 v[132:133], v[132:133], v[112:113]
    v_pk_mul_f32 v[134:135], v[134:135], v[114:115]
    v_exp_f32 v116, v116
    v_exp_f32 v117, v117
    v_exp_f32 v118, v118
    v_exp_f32 v119, v119
    v_exp_f32 v120, v120
    v_exp_f32 v121, v121
    v_exp_f32 v122, v122
    v_exp_f32 v123, v123
    v_exp_f32 v124, v124
    buffer_load_dwordx4 a[40:43], v4, s[40:43], s3 offen offset:3072 sc1
    v_exp_f32 v125, v125
    v_exp_f32 v126, v126
    v_exp_f32 v127, v127
    v_exp_f32 v128, v128
    v_exp_f32 v129, v129
    v_exp_f32 v130, v130
    v_exp_f32 v131, v131
    v_exp_f32 v132, v132
    v_exp_f32 v133, v133
    v_exp_f32 v134, v134
    v_exp_f32 v135, v135
    v_pk_add_f32 v[116:117], v[116:117], 1.0 op_sel_hi:[1,0]
    v_pk_add_f32 v[118:119], v[118:119], 1.0 op_sel_hi:[1,0]
    v_pk_add_f32 v[120:121], v[120:121], 1.0 op_sel_hi:[1,0]
    s_add_u32 s3, s18, 40960
    buffer_load_dwordx4 a[44:47], v4, s[40:43], s3 offen offset:0 sc1
    v_pk_add_f32 v[122:123], v[122:123], 1.0 op_sel_hi:[1,0]
    v_pk_add_f32 v[124:125], v[124:125], 1.0 op_sel_hi:[1,0]
    v_pk_add_f32 v[126:127], v[126:127], 1.0 op_sel_hi:[1,0]
    v_pk_add_f32 v[128:129], v[128:129], 1.0 op_sel_hi:[1,0]
    v_pk_add_f32 v[130:131], v[130:131], 1.0 op_sel_hi:[1,0]
    v_pk_add_f32 v[132:133], v[132:133], 1.0 op_sel_hi:[1,0]
    v_pk_add_f32 v[134:135], v[134:135], 1.0 op_sel_hi:[1,0]
    v_rcp_f32 v116, v116
    v_rcp_f32 v117, v117
    v_rcp_f32 v118, v118
    v_rcp_f32 v119, v119
    v_rcp_f32 v120, v120
    v_rcp_f32 v121, v121
    v_rcp_f32 v122, v122
    buffer_load_dwordx4 a[48:51], v4, s[40:43], s3 offen offset:1024 sc1
    v_rcp_f32 v123, v123
    v_rcp_f32 v124, v124
    v_rcp_f32 v125, v125
    v_rcp_f32 v126, v126
    v_rcp_f32 v127, v127
    v_rcp_f32 v128, v128
    v_rcp_f32 v129, v129
    v_rcp_f32 v130, v130
    v_rcp_f32 v131, v131
    v_rcp_f32 v132, v132
    v_rcp_f32 v133, v133
    v_rcp_f32 v134, v134
    v_rcp_f32 v135, v135
    v_pk_mul_f32 v[96:97], v[96:97], v[116:117]
    buffer_load_dwordx4 a[52:55], v4, s[40:43], s3 offen offset:2048 sc1
    v_pk_mul_f32 v[98:99], v[98:99], v[118:119]
    v_pk_mul_f32 v[100:101], v[100:101], v[120:121]
    v_pk_mul_f32 v[102:103], v[102:103], v[122:123]
    v_pk_mul_f32 v[104:105], v[104:105], v[124:125]
    v_pk_mul_f32 v[106:107], v[106:107], v[126:127]
    v_pk_mul_f32 v[108:109], v[108:109], v[128:129]
    v_pk_mul_f32 v[110:111], v[110:111], v[130:131]
    v_pk_mul_f32 v[112:113], v[112:113], v[132:133]
    v_pk_mul_f32 v[114:115], v[114:115], v[134:135]
    v_cvt_pk_bf16_f32 v76, v96, v97
    v_cvt_pk_bf16_f32 v77, v98, v99
    v_cvt_pk_bf16_f32 v78, v100, v101
    v_cvt_pk_bf16_f32 v79, v102, v103
    v_cvt_pk_bf16_f32 v80, v104, v105
    v_cvt_pk_bf16_f32 v81, v106, v107
    v_cvt_pk_bf16_f32 v82, v108, v109
    v_cvt_pk_bf16_f32 v83, v110, v111
    v_cvt_pk_bf16_f32 v84, v112, v113
    v_cvt_pk_bf16_f32 v85, v114, v115
    s_bitcmp1_b32 s36, 0
    s_cbranch_scc1 L_DF1
    s_add_u32 s39, s13, 3670016
    buffer_store_dwordx4 v[76:79], v18, s[40:43], s39 offen sc1
    s_add_u32 s39, s13, 3675136
    buffer_store_dwordx4 v[80:83], v18, s[40:43], s39 offen sc1
    s_add_u32 s39, s13, 3680256
    buffer_store_dwordx2 v[84:85], v19, s[40:43], s39 offen sc1
    s_branch L_DE1
L_DF1:
    s_add_u32 s39, s13, 3670016
    buffer_store_dwordx4 v[76:79], v18, s[40:43], s39 offen
    s_add_u32 s39, s13, 3675136
    buffer_store_dwordx4 v[80:83], v18, s[40:43], s39 offen
    s_add_u32 s39, s13, 3680256
    buffer_store_dwordx2 v[84:85], v19, s[40:43], s39 offen
L_DE1:
    s_bitcmp1_b32 s36, 1
    s_cbranch_scc1 L_DF2
    s_add_u32 s39, s13, 3670016
    buffer_store_dwordx4 v[76:79], v10, s[40:43], s39 offen sc1
    s_add_u32 s39, s13, 3675136
    buffer_store_dwordx4 v[80:83], v10, s[40:43], s39 offen sc1
    s_add_u32 s39, s13, 3680256
    buffer_store_dwordx2 v[84:85], v11, s[40:43], s39 offen sc1
    s_branch L_DE2
L_DF2:
    s_add_u32 s39, s13, 3670016
    buffer_store_dwordx4 v[76:79], v10, s[40:43], s39 offen
    s_add_u32 s39, s13, 3675136
    buffer_store_dwordx4 v[80:83], v10, s[40:43], s39 offen
    s_add_u32 s39, s13, 3680256
    buffer_store_dwordx2 v[84:85], v11, s[40:43], s39 offen
L_DE2:
    v_mov_b32 v21, 0
    v_mov_b32 v22, s38
    s_waitcnt vmcnt(3)
    s_mov_b64 exec, 1
    s_bitcmp1_b32 s36, 0
    s_cbranch_scc1 L_DF3
    buffer_store_dword v22, v21, s[40:43], s27 offen sc1
    s_branch L_DE3
L_DF3:
    buffer_store_dword v22, v21, s[40:43], s27 offen
L_DE3:
    s_mov_b64 exec, -1
    s_lshr_b32 s39, s52, 1
    s_add_u32 s39, s39, 1
    s_sub_u32 s59, 0, s39
    s_bitcmp1_b32 s52, 0
    s_cselect_b32 s28, s39, s59
    s_cselect_b32 s26, 32, -29
    s_lshl_b32 s26, s26, 7
    s_lshl_b32 s59, s53, 12
    s_add_u32 s39, s59, s26
    s_cmp_gt_u32 s39, 131071
    s_cselect_b32 s26, 0, s26
    s_cselect_b32 s60, 2.0, 4096
    v_add_u32 v19, s60, v4
    s_lshl_b32 s39, s30, 10
    v_add_u32 v8, s39, v4
    s_lshl_b32 s39, s31, 10
    v_add_u32 v9, s39, v4
    s_lshl_b32 s39, s31, 4
    s_add_u32 s39, s39, s28
    v_add_u32 v17, s39, v2
    v_cmp_gt_u32 vcc, 64, v17
    s_nop 1
    v_cndmask_b32 v9, v19, v9, vcc
    s_lshl_b32 s39, s32, 10
    v_add_u32 v10, s39, v4
    s_lshl_b32 s39, s33, 10
    v_add_u32 v11, s39, v4
    s_lshl_b32 s39, s33, 4
    s_add_u32 s39, s39, s28
    v_add_u32 v17, s39, v2
    v_cmp_gt_u32 vcc, 64, v17
    s_nop 1
    v_cndmask_b32 v11, v19, v11, vcc
    s_lshl_b32 s39, s52, 10
    s_add_u32 s59, s59, s39
    v_min_u32 v7, 7, v1
    v_lshl_add_u32 v7, v7, 7, s59
    s_add_u32 s59, s59, s26
    v_lshrrev_b32 v17, 5, v1
    v_lshl_add_u32 v12, v17, 9, s59
    s_lshl_b32 s35, s53, 17
    s_add_u32 s35, s35, 3670016
    s_mul_i32 s39, s52, 25600
    s_add_u32 s39, s39, s35
    s_add_u32 s4, s39, 0
    s_add_u32 s5, s39, 5120
    s_add_u32 s6, s39, 12800
    s_add_u32 s7, s39, 17920
    s_add_u32 s8, s39, 10240
    s_add_u32 s9, s39, 23040
    s_add_u32 s29, s29, s23
    v_mov_b32 v21, 393216
    v_mov_b32 v22, s38
    s_waitcnt vmcnt(1)
    s_mov_b64 exec, 1
    s_bitcmp1_b32 s36, 1
    s_cbranch_scc1 L_DF4
    buffer_store_dword v22, v21, s[40:43], s27 offen sc1
    s_branch L_DE4
L_DF4:
    buffer_store_dword v22, v21, s[40:43], s27 offen
L_DE4:
    s_mov_b64 exec, -1
    s_barrier
    v_mov_b32 v21, v7
    s_mov_b32 s39, 14942208
    buffer_load_dword v22, v21, s[40:43], s39 offen sc1
    v_lshlrev_b32 v116, 16, v44
    buffer_load_dwordx4 a[56:59], v4, s[40:43], s3 offen offset:3072 sc1
    v_and_b32 v117, 0xffff0000, v44
    v_pk_fma_f32 v[116:117], v[116:117], v[180:181], v[180:181] op_sel:[0,0,1] op_sel_hi:[1,0,1]
    v_pk_fma_f32 v[24:25], v[116:117], v[54:55], v[24:25]
    v_lshlrev_b32 v118, 16, v45
    v_and_b32 v119, 0xffff0000, v45
    v_pk_fma_f32 v[118:119], v[118:119], v[180:181], v[180:181] op_sel:[0,0,1] op_sel_hi:[1,0,1]
    v_pk_fma_f32 v[26:27], v[118:119], v[56:57], v[26:27]
    v_lshlrev_b32 v120, 16, v46
    s_add_u32 s3, s18, 45056
    buffer_load_dwordx4 a[60:63], v4, s[40:43], s3 offen offset:0 sc1
    v_and_b32 v121, 0xffff0000, v46
    v_pk_fma_f32 v[120:121], v[120:121], v[180:181], v[180:181] op_sel:[0,0,1] op_sel_hi:[1,0,1]
    v_pk_fma_f32 v[28:29], v[120:121], v[58:59], v[28:29]
    v_lshlrev_b32 v122, 16, v47
    v_and_b32 v123, 0xffff0000, v47
    v_pk_fma_f32 v[122:123], v[122:123], v[180:181], v[180:181] op_sel:[0,0,1] op_sel_hi:[1,0,1]
    v_pk_fma_f32 v[30:31], v[122:123], v[60:61], v[30:31]
    v_lshlrev_b32 v116, 16, v48
    buffer_load_dwordx4 a[64:67], v4, s[40:43], s3 offen offset:1024 sc1
    v_and_b32 v117, 0xffff0000, v48
    v_pk_fma_f32 v[116:117], v[116:117], v[180:181], v[180:181] op_sel:[0,0,1] op_sel_hi:[1,0,1]
    v_pk_fma_f32 v[32:33], v[116:117], v[62:63], v[32:33]
    v_lshlrev_b32 v118, 16, v49
    v_and_b32 v119, 0xffff0000, v49
    v_pk_fma_f32 v[118:119], v[118:119], v[180:181], v[180:181] op_sel:[0,0,1] op_sel_hi:[1,0,1]
    v_pk_fma_f32 v[34:35], v[118:119], v[64:65], v[34:35]
    v_lshlrev_b32 v120, 16, v50
    v_and_b32 v121, 0xffff0000, v50
    v_pk_fma_f32 v[120:121], v[120:121], v[180:181], v[180:181] op_sel:[0,0,1] op_sel_hi:[1,0,1]
    v_pk_fma_f32 v[36:37], v[120:121], v[66:67], v[36:37]
    v_lshlrev_b32 v122, 16, v51
    v_and_b32 v123, 0xffff0000, v51
    v_pk_fma_f32 v[122:123], v[122:123], v[180:181], v[180:181] op_sel:[0,0,1] op_sel_hi:[1,0,1]
    v_pk_fma_f32 v[38:39], v[122:123], v[68:69], v[38:39]
    v_lshlrev_b32 v116, 16, v52
    v_and_b32 v117, 0xffff0000, v52
    v_pk_fma_f32 v[116:117], v[116:117], v[180:181], v[180:181] op_sel:[0,0,1] op_sel_hi:[1,0,1]
    v_pk_fma_f32 v[40:41], v[116:117], v[70:71], v[40:41]
    v_lshlrev_b32 v118, 16, v53
    v_and_b32 v119, 0xffff0000, v53
    v_pk_fma_f32 v[118:119], v[118:119], v[180:181], v[180:181] op_sel:[0,0,1] op_sel_hi:[1,0,1]
    v_pk_fma_f32 v[42:43], v[118:119], v[72:73], v[42:43]
    v_add_u32 v17, 81024, v5
    ds_read_b128 v[54:57], v17 offset:0
    ds_read_b128 v[58:61], v17 offset:64
    ds_read_b128 v[62:65], v17 offset:128
    ds_read_b128 v[66:69], v17 offset:192
    ds_read_b128 v[70:73], v17 offset:256
    s_waitcnt vmcnt(3)
    v_cmp_ne_u32 vcc, s38, v22
    s_cbranch_vccz L_PD0
    s_mov_b32 s59, 0
L_PL0:
    s_mov_b32 s39, 14942208
    buffer_load_dword v22, v21, s[40:43], s39 offen sc1
    s_add_u32 s59, s59, 1
    s_cmp_gt_u32 s59, 0x100000
    s_waitcnt vmcnt(0)
    s_cbranch_scc1 L_PD0
    v_cmp_ne_u32 vcc, s38, v22
    s_cbranch_vccnz L_PL0
L_PD0:
    v_mov_b32 v21, v12
    s_mov_b32 s39, 15335424
    buffer_load_dword v22, v21, s[40:43], s39 offen sc1
    buffer_load_dwordx4 v[116:119], v8, s[40:43], s4 offen sc1
    buffer_load_dwordx4 v[120:123], v8, s[40:43], s5 offen sc1
    buffer_load_dwordx4 v[124:127], v8, s[40:43], s6 offen sc1
    buffer_load_dwordx4 v[128:131], v8, s[40:43], s7 offen sc1
    v_lshrrev_b32 v8, 1, v8
    buffer_load_dwordx2 v[132:133], v8, s[40:43], s8 offen sc1
    buffer_load_dwordx2 v[134:135], v8, s[40:43], s9 offen sc1
    buffer_load_dwordx4 v[156:159], v10, s[40:43], s4 offen sc1
    buffer_load_dwordx4 v[160:163], v10, s[40:43], s5 offen sc1
    buffer_load_dwordx4 v[164:167], v10, s[40:43], s6 offen sc1
    buffer_load_dwordx4 v[168:171], v10, s[40:43], s7 offen sc1
    v_lshrrev_b32 v10, 1, v10
    buffer_load_dwordx2 v[172:173], v10, s[40:43], s8 offen sc1
    buffer_load_dwordx2 v[174:175], v10, s[40:43], s9 offen sc1
    s_waitcnt vmcnt(12)
    v_cmp_ne_u32 vcc, s38, v22
    s_cbranch_vccz L_PDh
    s_mov_b32 s59, 0
L_PLh:
    s_mov_b32 s39, 15335424
    buffer_load_dword v22, v21, s[40:43], s39 offen sc1
    s_add_u32 s59, s59, 1
    s_cmp_gt_u32 s59, 0x100000
    s_waitcnt vmcnt(0)
    s_cbranch_scc1 L_PDh
    v_cmp_ne_u32 vcc, s38, v22
    s_cbranch_vccnz L_PLh
L_PDh:
    s_waitcnt vmcnt(11)
    v_mfma_f32_16x16x32_bf16 v[76:79], a[100:103], v[116:119], 0
    v_mfma_f32_16x16x32_bf16 v[80:83], a[104:107], v[116:119], 0
    v_mfma_f32_16x16x32_bf16 v[84:87], a[108:111], v[116:119], 0
    v_mfma_f32_16x16x32_bf16 v[88:91], a[112:115], v[116:119], 0
    buffer_load_dwordx4 v[136:139], v9, s[40:43], s4 offen sc1
    v_mfma_f32_16x16x32_bf16 v[92:95], a[116:119], v[116:119], 0
    s_waitcnt vmcnt(11)
    v_mfma_f32_16x16x32_bf16 v[76:79], a[120:123], v[120:123], v[76:79]
    v_mfma_f32_16x16x32_bf16 v[80:83], a[124:127], v[120:123], v[80:83]
    v_mfma_f32_16x16x32_bf16 v[84:87], a[128:131], v[120:123], v[84:87]
    buffer_load_dwordx4 v[140:143], v9, s[40:43], s5 offen sc1
    v_mfma_f32_16x16x32_bf16 v[88:91], a[132:135], v[120:123], v[88:91]
    v_mfma_f32_16x16x32_bf16 v[92:95], a[136:139], v[120:123], v[92:95]
    s_waitcnt vmcnt(11)
    v_mfma_f32_16x16x32_bf16 v[76:79], a[140:143], v[124:127], v[76:79]
    buffer_load_dwordx4 v[144:147], v9, s[40:43], s6 offen sc1
    v_mfma_f32_16x16x32_bf16 v[80:83], a[144:147], v[124:127], v[80:83]
    v_mfma_f32_16x16x32_bf16 v[84:87], a[148:151], v[124:127], v[84:87]
    v_mfma_f32_16x16x32_bf16 v[88:91], a[152:155], v[124:127], v[88:91]
    v_mfma_f32_16x16x32_bf16 v[92:95], a[156:159], v[124:127], v[92:95]
    buffer_load_dwordx4 v[148:151], v9, s[40:43], s7 offen sc1
    s_waitcnt vmcnt(12)
    v_mfma_f32_16x16x32_bf16 v[76:79], a[160:163], v[128:131], v[76:79]
    v_mfma_f32_16x16x32_bf16 v[80:83], a[164:167], v[128:131], v[80:83]
    v_mfma_f32_16x16x32_bf16 v[84:87], a[168:171], v[128:131], v[84:87]
    v_lshrrev_b32 v9, 1, v9
    v_mfma_f32_16x16x32_bf16 v[88:91], a[172:175], v[128:131], v[88:91]
    v_mfma_f32_16x16x32_bf16 v[92:95], a[176:179], v[128:131], v[92:95]
    s_waitcnt vmcnt(10)
    v_mfma_f32_16x16x32_bf16 v[76:79], a[180:183], v[132:135], v[76:79]
    v_mfma_f32_16x16x32_bf16 v[80:83], a[184:187], v[132:135], v[80:83]
    buffer_load_dwordx2 v[152:153], v9, s[40:43], s8 offen sc1
    v_mfma_f32_16x16x32_bf16 v[84:87], a[188:191], v[132:135], v[84:87]
    v_mfma_f32_16x16x32_bf16 v[88:91], a[192:195], v[132:135], v[88:91]
    v_mfma_f32_16x16x32_bf16 v[92:95], a[196:199], v[132:135], v[92:95]
    buffer_load_dwordx2 v[154:155], v9, s[40:43], s9 offen sc1
    s_waitcnt vmcnt(11)
    v_mfma_f32_16x16x32_bf16 v[96:99], a[100:103], v[156:159], 0
    v_mfma_f32_16x16x32_bf16 v[100:103], a[104:107], v[156:159], 0
    v_mfma_f32_16x16x32_bf16 v[104:107], a[108:111], v[156:159], 0
    v_mfma_f32_16x16x32_bf16 v[108:111], a[112:115], v[156:159], 0
    v_mfma_f32_16x16x32_bf16 v[112:115], a[116:119], v[156:159], 0
    s_waitcnt vmcnt(10)
    v_mfma_f32_16x16x32_bf16 v[96:99], a[120:123], v[160:163], v[96:99]
    buffer_load_dwordx4 v[176:179], v11, s[40:43], s4 offen sc1
    v_mfma_f32_16x16x32_bf16 v[100:103], a[124:127], v[160:163], v[100:103]
    v_mfma_f32_16x16x32_bf16 v[104:107], a[128:131], v[160:163], v[104:107]
    ds_write_b128 v13, v[76:79] offset:0
    v_mfma_f32_16x16x32_bf16 v[108:111], a[132:135], v[160:163], v[108:111]
    v_mfma_f32_16x16x32_bf16 v[112:115], a[136:139], v[160:163], v[112:115]
    buffer_load_dwordx4 v[180:183], v11, s[40:43], s5 offen sc1
    s_waitcnt vmcnt(11)
    v_mfma_f32_16x16x32_bf16 v[96:99], a[140:143], v[164:167], v[96:99]
    ds_write_b128 v13, v[80:83] offset:1024
    v_mfma_f32_16x16x32_bf16 v[100:103], a[144:147], v[164:167], v[100:103]
    v_mfma_f32_16x16x32_bf16 v[104:107], a[148:151], v[164:167], v[104:107]
    buffer_load_dwordx4 v[184:187], v11, s[40:43], s6 offen sc1
    v_mfma_f32_16x16x32_bf16 v[108:111], a[152:155], v[164:167], v[108:111]
    v_mfma_f32_16x16x32_bf16 v[112:115], a[156:159], v[164:167], v[112:115]
    ds_write_b128 v13, v[84:87] offset:2048
    s_waitcnt vmcnt(11)
    v_mfma_f32_16x16x32_bf16 v[96:99], a[160:163], v[168:171], v[96:99]
    v_mfma_f32_16x16x32_bf16 v[100:103], a[164:167], v[168:171], v[100:103]
    buffer_load_dwordx4 v[188:191], v11, s[40:43], s7 offen sc1
    v_mfma_f32_16x16x32_bf16 v[104:107], a[168:171], v[168:171], v[104:107]
    v_lshrrev_b32 v11, 1, v11
    v_mfma_f32_16x16x32_bf16 v[108:111], a[172:175], v[168:171], v[108:111]
    v_mfma_f32_16x16x32_bf16 v[112:115], a[176:179], v[168:171], v[112:115]
    ds_write_b128 v13, v[88:91] offset:3072
    s_waitcnt vmcnt(10)
    v_mfma_f32_16x16x32_bf16 v[96:99], a[180:183], v[172:175], v[96:99]
    v_mfma_f32_16x16x32_bf16 v[100:103], a[184:187], v[172:175], v[100:103]
    buffer_load_dwordx2 v[192:193], v11, s[40:43], s8 offen sc1
    v_mfma_f32_16x16x32_bf16 v[104:107], a[188:191], v[172:175], v[104:107]
    v_mfma_f32_16x16x32_bf16 v[108:111], a[192:195], v[172:175], v[108:111]
    ds_write_b128 v13, v[92:95] offset:4096
    v_mfma_f32_16x16x32_bf16 v[112:115], a[196:199], v[172:175], v[112:115]
    buffer_load_dwordx2 v[194:195], v11, s[40:43], s9 offen sc1
    s_waitcnt vmcnt(11)
    v_mfma_f32_16x16x32_bf16 v[76:79], a[100:103], v[136:139], 0
    v_mfma_f32_16x16x32_bf16 v[80:83], a[104:107], v[136:139], 0
    v_mfma_f32_16x16x32_bf16 v[84:87], a[108:111], v[136:139], 0
    v_mfma_f32_16x16x32_bf16 v[88:91], a[112:115], v[136:139], 0
    v_mfma_f32_16x16x32_bf16 v[92:95], a[116:119], v[136:139], 0
    v_lshlrev_b32 v12, 3, v1
    s_waitcnt vmcnt(10)
    v_mfma_f32_16x16x32_bf16 v[76:79], a[120:123], v[140:143], v[76:79]
    s_lshr_b32 s28, s54, 1
    v_mfma_f32_16x16x32_bf16 v[80:83], a[124:127], v[140:143], v[80:83]
    buffer_load_dwordx4 a[68:71], v4, s[40:43], s3 offen offset:2048 sc1
    ds_write_b128 v15, v[96:99] offset:0
    v_mfma_f32_16x16x32_bf16 v[84:87], a[128:131], v[140:143], v[84:87]
    s_add_u32 s34, s34, s23
    v_mfma_f32_16x16x32_bf16 v[88:91], a[132:135], v[140:143], v[88:91]
    s_xor_b32 s39, s28, 3
    s_lshl_b32 s4, s39, 10
    v_mfma_f32_16x16x32_bf16 v[92:95], a[136:139], v[140:143], v[92:95]
    buffer_load_dwordx4 a[72:75], v4, s[40:43], s3 offen offset:3072 sc1
    s_waitcnt vmcnt(11)
    v_mfma_f32_16x16x32_bf16 v[76:79], a[140:143], v[144:147], v[76:79]
    s_add_u32 s8, s4, s34
    ds_write_b128 v15, v[100:103] offset:1024
    v_mfma_f32_16x16x32_bf16 v[80:83], a[144:147], v[144:147], v[80:83]
    s_xor_b32 s39, s28, 2
    v_mfma_f32_16x16x32_bf16 v[84:87], a[148:151], v[144:147], v[84:87]
    s_lshl_b32 s5, s39, 10
    s_add_u32 s3, s18, 49152
    v_mfma_f32_16x16x32_bf16 v[88:91], a[152:155], v[144:147], v[88:91]
    s_add_u32 s9, s5, s34
    v_mfma_f32_16x16x32_bf16 v[92:95], a[156:159], v[144:147], v[92:95]
    s_xor_b32 s39, s28, 1
    ds_write_b128 v15, v[104:107] offset:2048
    s_waitcnt vmcnt(10)
    v_mfma_f32_16x16x32_bf16 v[76:79], a[160:163], v[148:151], v[76:79]
    s_lshl_b32 s6, s39, 10
    v_mfma_f32_16x16x32_bf16 v[80:83], a[164:167], v[148:151], v[80:83]
    s_add_u32 s10, s6, s34
    buffer_load_dwordx4 a[76:79], v4, s[40:43], s3 offen offset:0 sc1
    v_mfma_f32_16x16x32_bf16 v[84:87], a[168:171], v[148:151], v[84:87]
    s_xor_b32 s39, s28, 0
    v_mfma_f32_16x16x32_bf16 v[88:91], a[172:175], v[148:151], v[88:91]
    s_lshl_b32 s7, s39, 10
    ds_write_b128 v15, v[108:111] offset:3072
    v_mfma_f32_16x16x32_bf16 v[92:95], a[176:179], v[148:151], v[92:95]
    s_add_u32 s11, s7, s34
    s_waitcnt vmcnt(9)
    v_mfma_f32_16x16x32_bf16 v[76:79], a[180:183], v[152:155], v[76:79]
    buffer_load_dwordx4 a[80:83], v4, s[40:43], s3 offen offset:1024 sc1
    v_and_b32 v6, 31, v1
    v_mfma_f32_16x16x32_bf16 v[80:83], a[184:187], v[152:155], v[80:83]
    v_lshlrev_b32 v6, 4, v6
    v_mfma_f32_16x16x32_bf16 v[84:87], a[188:191], v[152:155], v[84:87]
    v_lshrrev_b32 v17, 5, v1
    ds_write_b128 v15, v[112:115] offset:4096
    v_mfma_f32_16x16x32_bf16 v[88:91], a[192:195], v[152:155], v[88:91]
    buffer_load_dwordx4 a[84:87], v4, s[40:43], s3 offen offset:2048 sc1
    v_mfma_f32_16x16x32_bf16 v[92:95], a[196:199], v[152:155], v[92:95]
    v_mul_u32_u24 v17, 10240, v17
    v_add_u32 v6, v6, v17
    s_waitcnt vmcnt(10)
    v_mfma_f32_16x16x32_bf16 v[96:99], a[100:103], v[176:179], v[24:27]
    v_mfma_f32_16x16x32_bf16 v[100:103], a[104:107], v[176:179], v[28:31]
    v_mfma_f32_16x16x32_bf16 v[104:107], a[108:111], v[176:179], v[32:35]
    v_mfma_f32_16x16x32_bf16 v[108:111], a[112:115], v[176:179], v[36:39]
    v_mfma_f32_16x16x32_bf16 v[112:115], a[116:119], v[176:179], v[40:43]
    v_add_u32 v8, 40960, v4
    s_waitcnt vmcnt(9)
    v_mfma_f32_16x16x32_bf16 v[96:99], a[120:123], v[180:183], v[96:99]
    buffer_load_dwordx4 a[88:91], v4, s[40:43], s3 offen offset:3072 sc1
    v_mfma_f32_16x16x32_bf16 v[100:103], a[124:127], v[180:183], v[100:103]
    v_add_u32 v9, 40960, v12
    s_waitcnt lgkmcnt(14)
    ds_write_b128 v14, v[76:79] offset:0
    v_mfma_f32_16x16x32_bf16 v[104:107], a[128:131], v[180:183], v[104:107]
    s_add_u32 s3, s18, 53248
    v_mfma_f32_16x16x32_bf16 v[108:111], a[132:135], v[180:183], v[108:111]
    s_lshl_b32 s39, s21, 12
    s_add_u32 s14, s35, s39
    v_mfma_f32_16x16x32_bf16 v[112:115], a[136:139], v[180:183], v[112:115]
    buffer_load_dwordx4 a[92:95], v4, s[40:43], s3 offen offset:0 sc1
    s_waitcnt vmcnt(10)
    v_mfma_f32_16x16x32_bf16 v[96:99], a[140:143], v[184:187], v[96:99]
    s_lshl_b32 s39, s21, 11
    s_waitcnt lgkmcnt(14)
    ds_write_b128 v14, v[80:83] offset:1024
    v_mfma_f32_16x16x32_bf16 v[100:103], a[144:147], v[184:187], v[100:103]
    s_add_u32 s15, s23, s39
    v_mfma_f32_16x16x32_bf16 v[104:107], a[148:151], v[184:187], v[104:107]
    buffer_load_dwordx4 a[96:99], v4, s[40:43], s3 offen offset:1024 sc1
    s_add_u32 s15, s15, 1048576
    v_mfma_f32_16x16x32_bf16 v[108:111], a[152:155], v[184:187], v[108:111]
    s_add_u32 s3, s19, 20480
    v_mfma_f32_16x16x32_bf16 v[112:115], a[156:159], v[184:187], v[112:115]
    s_lshl_b32 s26, s53, 12
    s_waitcnt lgkmcnt(14)
    ds_write_b128 v14, v[84:87] offset:2048
    s_waitcnt vmcnt(10)
    v_mfma_f32_16x16x32_bf16 v[96:99], a[160:163], v[188:191], v[96:99]
    s_add_u32 s26, s26, 131072
    v_mfma_f32_16x16x32_bf16 v[100:103], a[164:167], v[188:191], v[100:103]
    s_add_u32 m0, s20, 5120
    s_lshl_b32 s39, s33, 10
    v_mfma_f32_16x16x32_bf16 v[104:107], a[168:171], v[188:191], v[104:107]
    buffer_load_dwordx4 v4, s[40:43], s3 offen offset:3072 sc1  lds
    v_mfma_f32_16x16x32_bf16 v[108:111], a[172:175], v[188:191], v[108:111]
    s_lshl_b32 s59, s54, 7
    s_waitcnt lgkmcnt(14)
    ds_write_b128 v14, v[88:91] offset:3072
    v_mfma_f32_16x16x32_bf16 v[112:115], a[176:179], v[188:191], v[112:115]
    s_add_u32 s39, s39, s59
    s_waitcnt vmcnt(9)
    v_mfma_f32_16x16x32_bf16 v[96:99], a[180:183], v[192:195], v[96:99]
    s_add_u32 s3, s19, 24576
    s_add_u32 s13, s39, s26
    v_mfma_f32_16x16x32_bf16 v[100:103], a[184:187], v[192:195], v[100:103]
    s_lshl_b32 s39, s52, 10
    v_mfma_f32_16x16x32_bf16 v[104:107], a[188:191], v[192:195], v[104:107]
    s_add_u32 m0, s20, 9216
    s_waitcnt lgkmcnt(14)
    ds_write_b128 v14, v[92:95] offset:4096
    v_mfma_f32_16x16x32_bf16 v[108:111], a[192:195], v[192:195], v[108:111]
    v_add_u32 v18, s39, v4
    v_mfma_f32_16x16x32_bf16 v[112:115], a[196:199], v[192:195], v[112:115]
    buffer_load_dwordx4 v4, s[40:43], s3 offen offset:0 sc1  lds
    v_lshrrev_b32 v19, 1, v18
    s_waitcnt lgkmcnt(0)
    s_barrier
    ds_read_b128 v[116:119], v16 offset:0
    ds_read_b128 v[120:123], v16 offset:1024
    ds_read_b128 v[124:127], v16 offset:2048
    ds_read_b128 v[128:131], v16 offset:3072
    ds_read_b128 v[132:135], v16 offset:4096
    ds_read_b128 v[136:139], v16 offset:5120
    ds_read_b128 v[140:143], v16 offset:6144
    ds_read_b128 v[144:147], v16 offset:7168
    ds_read_b128 v[148:151], v16 offset:8192
    ds_read_b128 v[152:155], v16 offset:9216
    ds_read_b128 v[76:79], v16 offset:10240
    ds_read_b128 v[80:83], v16 offset:11264
    ds_read_b128 v[84:87], v16 offset:12288
    ds_read_b128 v[88:91], v16 offset:13312
    ds_read_b128 v[92:95], v16 offset:14336
    s_waitcnt lgkmcnt(10)
    v_pk_add_f32 v[96:97], v[96:97], v[116:117]
    s_add_u32 s3, s18, 53248
    buffer_load_dwordx4 a[100:103], v4, s[40:43], s3 offen offset:2048 sc1
    v_pk_add_f32 v[98:99], v[98:99], v[118:119]
    v_pk_add_f32 v[100:101], v[100:101], v[120:121]
    v_pk_add_f32 v[102:103], v[102:103], v[122:123]
    v_pk_add_f32 v[104:105], v[104:105], v[124:125]
    v_pk_add_f32 v[106:107], v[106:107], v[126:127]
    v_pk_add_f32 v[108:109], v[108:109], v[128:129]
    v_pk_add_f32 v[110:111], v[110:111], v[130:131]
    v_pk_add_f32 v[112:113], v[112:113], v[132:133]
    v_pk_add_f32 v[114:115], v[114:115], v[134:135]
    s_waitcnt lgkmcnt(5)
    v_pk_add_f32 v[96:97], v[96:97], v[136:137]
    v_pk_add_f32 v[98:99], v[98:99], v[138:139]
    v_pk_add_f32 v[100:101], v[100:101], v[140:141]
    v_pk_add_f32 v[102:103], v[102:103], v[142:143]
    v_pk_add_f32 v[104:105], v[104:105], v[144:145]
    buffer_load_dwordx4 a[104:107], v4, s[40:43], s3 offen offset:3072 sc1
    v_pk_add_f32 v[106:107], v[106:107], v[146:147]
    v_pk_add_f32 v[108:109], v[108:109], v[148:149]
    v_pk_add_f32 v[110:111], v[110:111], v[150:151]
    v_pk_add_f32 v[112:113], v[112:113], v[152:153]
    v_pk_add_f32 v[114:115], v[114:115], v[154:155]
    s_waitcnt lgkmcnt(0)
    v_pk_add_f32 v[96:97], v[96:97], v[76:77]
    v_pk_add_f32 v[98:99], v[98:99], v[78:79]
    v_pk_add_f32 v[100:101], v[100:101], v[80:81]
    v_pk_add_f32 v[102:103], v[102:103], v[82:83]
    v_pk_add_f32 v[104:105], v[104:105], v[84:85]
    v_pk_add_f32 v[106:107], v[106:107], v[86:87]
    v_pk_add_f32 v[108:109], v[108:109], v[88:89]
    v_pk_add_f32 v[110:111], v[110:111], v[90:91]
    v_pk_add_f32 v[112:113], v[112:113], v[92:93]
    s_add_u32 s3, s18, 57344
    buffer_load_dwordx4 a[108:111], v4, s[40:43], s3 offen offset:0 sc1
    v_pk_add_f32 v[114:115], v[114:115], v[94:95]
    v_cvt_pk_bf16_f32 v76, v96, v97
    v_cvt_pk_bf16_f32 v77, v98, v99
    v_cvt_pk_bf16_f32 v78, v100, v101
    v_cvt_pk_bf16_f32 v79, v102, v103
    v_cvt_pk_bf16_f32 v80, v104, v105
    v_cvt_pk_bf16_f32 v81, v106, v107
    v_cvt_pk_bf16_f32 v82, v108, v109
    v_cvt_pk_bf16_f32 v83, v110, v111
    v_cvt_pk_bf16_f32 v84, v112, v113
    v_cvt_pk_bf16_f32 v85, v114, v115
    s_bitcmp1_b32 s36, 0
    s_cbranch_scc1 L_DF5
    s_add_u32 s39, s29, 0
    buffer_store_dwordx4 v[76:79], v18, s[44:47], s39 offen sc1
    s_add_u32 s39, s29, 4096
    buffer_store_dwordx4 v[80:83], v18, s[44:47], s39 offen sc1
    s_add_u32 s39, s29, 8192
    buffer_store_dwordx2 v[84:85], v19, s[44:47], s39 offen sc1
    s_branch L_DE5
L_DF5:
    s_add_u32 s39, s29, 0
    buffer_store_dwordx4 v[76:79], v18, s[44:47], s39 offen
    s_add_u32 s39, s29, 4096
    buffer_store_dwordx4 v[80:83], v18, s[44:47], s39 offen
    s_add_u32 s39, s29, 8192
    buffer_store_dwordx2 v[84:85], v19, s[44:47], s39 offen
L_DE5:
    v_lshlrev_b32 v116, 16, v76
    v_and_b32 v117, 0xffff0000, v76
    v_lshlrev_b32 v118, 16, v77
    v_and_b32 v119, 0xffff0000, v77
    v_lshlrev_b32 v120, 16, v78
    v_and_b32 v121, 0xffff0000, v78
    v_lshlrev_b32 v122, 16, v79
    v_and_b32 v123, 0xffff0000, v79
    v_lshlrev_b32 v124, 16, v80
    v_and_b32 v125, 0xffff0000, v80
    v_lshlrev_b32 v126, 16, v81
    v_and_b32 v127, 0xffff0000, v81
    v_lshlrev_b32 v128, 16, v82
    v_and_b32 v129, 0xffff0000, v82
    v_lshlrev_b32 v130, 16, v83
    v_and_b32 v131, 0xffff0000, v83
    v_lshlrev_b32 v132, 16, v84
    v_and_b32 v133, 0xffff0000, v84
    v_lshlrev_b32 v134, 16, v85
    v_and_b32 v135, 0xffff0000, v85
    v_pk_add_f32 v[136:137], v[116:117], v[118:119]
    v_pk_mul_f32 v[138:139], v[116:117], v[116:117]
    v_pk_add_f32 v[140:141], v[120:121], v[122:123]
    v_pk_mul_f32 v[142:143], v[120:121], v[120:121]
    v_pk_fma_f32 v[138:139], v[118:119], v[118:119], v[138:139]
    v_pk_fma_f32 v[142:143], v[122:123], v[122:123], v[142:143]
    v_pk_add_f32 v[136:137], v[136:137], v[124:125]
    v_pk_fma_f32 v[138:139], v[124:125], v[124:125], v[138:139]
    v_pk_add_f32 v[140:141], v[140:141], v[126:127]
    v_pk_fma_f32 v[142:143], v[126:127], v[126:127], v[142:143]
    v_pk_add_f32 v[136:137], v[136:137], v[128:129]
    v_pk_fma_f32 v[138:139], v[128:129], v[128:129], v[138:139]
    v_pk_add_f32 v[140:141], v[140:141], v[130:131]
    v_pk_fma_f32 v[142:143], v[130:131], v[130:131], v[142:143]
    v_pk_add_f32 v[136:137], v[136:137], v[132:133]
    v_pk_fma_f32 v[138:139], v[132:133], v[132:133], v[138:139]
    v_pk_add_f32 v[140:141], v[140:141], v[134:135]
    v_pk_fma_f32 v[142:143], v[134:135], v[134:135], v[142:143]
    v_pk_add_f32 v[136:137], v[136:137], v[140:141]
    v_pk_add_f32 v[138:139], v[138:139], v[142:143]
    v_add_f32 v136, v136, v137
    v_add_f32 v137, v138, v139
    v_mov_b32 v140, v136
    v_mov_b32 v141, v137
    s_nop 0
    v_permlane16_swap_b32 v136, v140
    v_permlane16_swap_b32 v137, v141
    v_add_f32 v136, v136, v140
    v_add_f32 v137, v137, v141
    v_mov_b32 v140, v136
    v_mov_b32 v141, v137
    s_nop 0
    v_permlane32_swap_b32 v136, v140
    v_permlane32_swap_b32 v137, v141
    v_add_f32 v136, v136, v140
    v_add_f32 v137, v137, v141
    s_mov_b64 exec, 0xffff
    s_bitcmp1_b32 s36, 0
    s_cbranch_scc1 L_DF6
    buffer_store_dwordx2 v[136:137], v12, s[40:43], s13 offen sc1
    s_branch L_DE6
L_DF6:
    buffer_store_dwordx2 v[136:137], v12, s[40:43], s13 offen
L_DE6:
    s_mov_b64 exec, -1
    v_mov_b32 v21, 131072
    v_mov_b32 v22, s38
    s_waitcnt vmcnt(0)
    s_mov_b64 exec, 1
    s_bitcmp1_b32 s36, 0
    s_cbranch_scc1 L_DF7
    buffer_store_dword v22, v21, s[40:43], s27 offen sc1
    s_branch L_DE7
L_DF7:
    buffer_store_dword v22, v21, s[40:43], s27 offen
L_DE7:
    s_mov_b64 exec, -1
    v_lshlrev_b32 v24, 16, v44
    v_and_b32 v25, 0xffff0000, v44
    v_pk_fma_f32 v[24:25], v[54:55], v[116:117], v[24:25]
    v_lshlrev_b32 v26, 16, v45
    v_and_b32 v27, 0xffff0000, v45
    v_pk_fma_f32 v[26:27], v[56:57], v[118:119], v[26:27]
    v_lshlrev_b32 v28, 16, v46
    v_and_b32 v29, 0xffff0000, v46
    v_pk_fma_f32 v[28:29], v[58:59], v[120:121], v[28:29]
    v_lshlrev_b32 v30, 16, v47
    v_and_b32 v31, 0xffff0000, v47
    v_pk_fma_f32 v[30:31], v[60:61], v[122:123], v[30:31]
    v_lshlrev_b32 v32, 16, v48
    v_and_b32 v33, 0xffff0000, v48
    v_pk_fma_f32 v[32:33], v[62:63], v[124:125], v[32:33]
    v_lshlrev_b32 v34, 16, v49
    v_and_b32 v35, 0xffff0000, v49
    v_pk_fma_f32 v[34:35], v[64:65], v[126:127], v[34:35]
    v_lshlrev_b32 v36, 16, v50
    v_and_b32 v37, 0xffff0000, v50
    v_pk_fma_f32 v[36:37], v[66:67], v[128:129], v[36:37]
    v_lshlrev_b32 v38, 16, v51
    v_and_b32 v39, 0xffff0000, v51
    v_pk_fma_f32 v[38:39], v[68:69], v[130:131], v[38:39]
    v_lshlrev_b32 v40, 16, v52
    v_and_b32 v41, 0xffff0000, v52
    v_pk_fma_f32 v[40:41], v[70:71], v[132:133], v[40:41]
    v_lshlrev_b32 v42, 16, v53
    v_and_b32 v43, 0xffff0000, v53
    v_pk_fma_f32 v[42:43], v[72:73], v[134:135], v[42:43]
    s_barrier
    v_mov_b32 v21, v7
    s_mov_b32 s39, 15073280
    buffer_load_dword v22, v21, s[40:43], s39 offen sc1
    v_mov_b32 v188, 0x3f803f80
    v_mov_b32 v189, 0x3f803f80
    v_mov_b32 v190, 0x3f803f80
    v_mov_b32 v191, 0x3f803f80
    s_mul_i32 s29, s52, 5120
    s_nop 0
    v_mfma_f32_16x16x32_bf16 v[132:135], a[200:203], v[188:191], 0
    v_mfma_f32_16x16x32_bf16 v[136:139], a[204:207], v[188:191], 0
    v_mfma_f32_16x16x32_bf16 v[140:143], a[208:211], v[188:191], 0
    buffer_load_dwordx4 a[112:115], v4, s[40:43], s3 offen offset:1024 sc1
    v_mfma_f32_16x16x32_bf16 v[132:135], a[212:215], v[188:191], v[132:135]
    v_mfma_f32_16x16x32_bf16 v[136:139], a[216:219], v[188:191], v[136:139]
    v_mfma_f32_16x16x32_bf16 v[140:143], a[220:223], v[188:191], v[140:143]
    buffer_load_dwordx4 a[116:119], v4, s[40:43], s3 offen offset:2048 sc1
    v_mfma_f32_16x16x32_bf16 v[132:135], a[224:227], v[188:191], v[132:135]
    v_mfma_f32_16x16x32_bf16 v[136:139], a[228:231], v[188:191], v[136:139]
    v_mfma_f32_16x16x32_bf16 v[140:143], a[232:235], v[188:191], v[140:143]
    buffer_load_dwordx4 a[120:123], v4, s[40:43], s3 offen offset:3072 sc1
    v_mfma_f32_16x16x32_bf16 v[132:135], a[236:239], v[188:191], v[132:135]
    v_mfma_f32_16x16x32_bf16 v[136:139], a[240:243], v[188:191], v[136:139]
    v_mfma_f32_16x16x32_bf16 v[140:143], a[244:247], v[188:191], v[140:143]
    s_add_u32 s3, s19, 24576
    v_mfma_f32_16x16x32_bf16 v[132:135], a[248:251], v[188:191], v[132:135]
    v_mfma_f32_16x16x32_bf16 v[136:139], a[252:255], v[188:191], v[136:139]
    v_mfma_f32_16x16x32_bf16 v[140:143], v[196:199], v[188:191], v[140:143]
    s_add_u32 m0, s20, 9216
    v_mfma_f32_16x16x32_bf16 v[132:135], v[200:203], v[188:191], v[132:135]
    v_mfma_f32_16x16x32_bf16 v[136:139], v[204:207], v[188:191], v[136:139]
    v_mfma_f32_16x16x32_bf16 v[140:143], v[208:211], v[188:191], v[140:143]
    buffer_load_dwordx4 v4, s[40:43], s3 offen offset:1024 sc1  lds
    s_waitcnt vmcnt(4)
    v_cmp_ne_u32 vcc, s38, v22
    s_cbranch_vccz L_PD1
    s_mov_b32 s59, 0
L_PL1:
    s_mov_b32 s39, 15073280
    buffer_load_dword v22, v21, s[40:43], s39 offen sc1
    s_add_u32 s59, s59, 1
    s_cmp_gt_u32 s59, 0x100000
    s_waitcnt vmcnt(0)
    s_cbranch_scc1 L_PD1
    v_cmp_ne_u32 vcc, s38, v22
    s_cbranch_vccnz L_PL1
L_PD1:
    s_add_u32 m0, s29, 0
    s_add_u32 s39, s8, 0
    buffer_load_dwordx4 v4, s[44:47], s39 offen sc1 lds
    s_add_u32 m0, s29, 1024
    s_add_u32 s39, s8, 4096
    buffer_load_dwordx4 v4, s[44:47], s39 offen sc1 lds
    s_add_u32 m0, s29, 2048
    s_add_u32 s39, s8, 10240
    buffer_load_dwordx4 v4, s[44:47], s39 offen sc1 lds
    s_add_u32 m0, s29, 3072
    s_add_u32 s39, s8, 14336
    buffer_load_dwordx4 v4, s[44:47], s39 offen sc1 lds
    s_add_u32 m0, s29, 4096
    s_lshr_b32 s39, s4, 1
    s_add_u32 s39, s39, s34
    s_add_u32 s39, s39, 8192
    buffer_load_dwordx4 v6, s[44:47], s39 offen sc1 lds
    v_mfma_f32_16x16x32_bf16 v[132:135], v[212:215], v[188:191], v[132:135]
    v_mfma_f32_16x16x32_bf16 v[136:139], v[216:219], v[188:191], v[136:139]
    s_add_u32 m0, s29, 20480
    v_mfma_f32_16x16x32_bf16 v[140:143], v[220:223], v[188:191], v[140:143]
    s_add_u32 s39, s9, 0
    v_mfma_f32_16x16x32_bf16 v[132:135], v[224:227], v[188:191], v[132:135]
    buffer_load_dwordx4 v4, s[44:47], s39 offen sc1 lds
    v_mfma_f32_16x16x32_bf16 v[136:139], v[228:231], v[188:191], v[136:139]
    s_add_u32 m0, s29, 21504
    v_mfma_f32_16x16x32_bf16 v[140:143], v[232:235], v[188:191], v[140:143]
    v_mfma_f32_16x16x32_bf16 v[132:135], v[236:239], v[188:191], v[132:135]
    s_add_u32 s39, s9, 4096
    v_mfma_f32_16x16x32_bf16 v[136:139], v[240:243], v[188:191], v[136:139]
    buffer_load_dwordx4 v4, s[44:47], s39 offen sc1 lds
    v_mfma_f32_16x16x32_bf16 v[140:143], v[244:247], v[188:191], v[140:143]
    s_add_u32 m0, s29, 22528
    v_mfma_f32_16x16x32_bf16 v[132:135], v[248:251], v[188:191], v[132:135]
    s_add_u32 s39, s9, 10240
    v_mfma_f32_16x16x32_bf16 v[136:139], v[252:255], v[188:191], v[136:139]
    v_mfma_f32_16x16x32_bf16 v[140:143], a[0:3], v[188:191], v[140:143]
    buffer_load_dwordx4 v4, s[44:47], s39 offen sc1 lds
    v_mfma_f32_16x16x32_bf16 v[132:135], a[4:7], v[188:191], v[132:135]
    s_add_u32 m0, s29, 23552
    v_mfma_f32_16x16x32_bf16 v[136:139], a[8:11], v[188:191], v[136:139]
    s_add_u32 s39, s9, 14336
    v_mfma_f32_16x16x32_bf16 v[140:143], a[12:15], v[188:191], v[140:143]
    buffer_load_dwordx4 v4, s[44:47], s39 offen sc1 lds
    v_mfma_f32_16x16x32_bf16 v[132:135], a[16:19], v[188:191], v[132:135]
    v_mfma_f32_16x16x32_bf16 v[136:139], a[20:23], v[188:191], v[136:139]
    s_add_u32 m0, s29, 24576
    v_mfma_f32_16x16x32_bf16 v[140:143], a[24:27], v[188:191], v[140:143]
    s_lshr_b32 s39, s5, 1
    v_mfma_f32_16x16x32_bf16 v[132:135], a[28:31], v[188:191], v[132:135]
    s_add_u32 s39, s39, s34
    v_mfma_f32_16x16x32_bf16 v[136:139], a[32:35], v[188:191], v[136:139]
    s_add_u32 s39, s39, 8192
    v_mfma_f32_16x16x32_bf16 v[140:143], a[36:39], v[188:191], v[140:143]
    buffer_load_dwordx4 v6, s[44:47], s39 offen sc1 lds
    v_mfma_f32_16x16x32_bf16 v[132:135], a[40:43], v[188:191], v[132:135]
    v_mfma_f32_16x16x32_bf16 v[136:139], a[44:47], v[188:191], v[136:139]
    s_add_u32 m0, s29, 40960
    v_mfma_f32_16x16x32_bf16 v[140:143], a[48:51], v[188:191], v[140:143]
    s_add_u32 s39, s10, 0
    v_mfma_f32_16x16x32_bf16 v[132:135], a[52:55], v[188:191], v[132:135]
    buffer_load_dwordx4 v4, s[44:47], s39 offen sc1 lds
    v_mfma_f32_16x16x32_bf16 v[136:139], a[56:59], v[188:191], v[136:139]
    s_add_u32 m0, s29, 41984
    v_mfma_f32_16x16x32_bf16 v[140:143], a[60:63], v[188:191], v[140:143]
    v_mfma_f32_16x16x32_bf16 v[132:135], a[64:67], v[188:191], v[132:135]
    s_add_u32 s39, s10, 4096
    v_mfma_f32_16x16x32_bf16 v[136:139], a[68:71], v[188:191], v[136:139]
    buffer_load_dwordx4 v4, s[44:47], s39 offen sc1 lds
    v_mfma_f32_16x16x32_bf16 v[140:143], a[72:75], v[188:191], v[140:143]
    s_add_u32 m0, s29, 43008
    v_mfma_f32_16x16x32_bf16 v[132:135], a[76:79], v[188:191], v[132:135]
    s_add_u32 s39, s10, 10240
    v_mfma_f32_16x16x32_bf16 v[136:139], a[80:83], v[188:191], v[136:139]
    v_mfma_f32_16x16x32_bf16 v[140:143], a[84:87], v[188:191], v[140:143]
    buffer_load_dwordx4 v4, s[44:47], s39 offen sc1 lds
    v_mfma_f32_16x16x32_bf16 v[132:135], a[88:91], v[188:191], v[132:135]
    s_add_u32 m0, s29, 44032
    v_mfma_f32_16x16x32_bf16 v[136:139], a[92:95], v[188:191], v[136:139]
    s_add_u32 s39, s10, 14336
    v_mfma_f32_16x16x32_bf16 v[140:143], a[96:99], v[188:191], v[140:143]
    buffer_load_dwordx4 v4, s[44:47], s39 offen sc1 lds
    v_mfma_f32_16x16x32_bf16 v[132:135], a[100:103], v[188:191], v[132:135]
    v_mfma_f32_16x16x32_bf16 v[136:139], a[104:107], v[188:191], v[136:139]
    s_add_u32 m0, s29, 45056
    v_mfma_f32_16x16x32_bf16 v[140:143], a[108:111], v[188:191], v[140:143]
    s_lshr_b32 s39, s6, 1
    s_waitcnt vmcnt(17)
    v_mfma_f32_16x16x32_bf16 v[132:135], a[112:115], v[188:191], v[132:135]
    s_add_u32 s39, s39, s34
    s_waitcnt vmcnt(16)
    v_mfma_f32_16x16x32_bf16 v[136:139], a[116:119], v[188:191], v[136:139]
    s_add_u32 s39, s39, 8192
    s_waitcnt vmcnt(15)
    v_mfma_f32_16x16x32_bf16 v[140:143], a[120:123], v[188:191], v[140:143]
    buffer_load_dwordx4 v6, s[44:47], s39 offen sc1 lds
    s_getpc_b64 s[48:49]
L_CPF2:
    s_mov_b32 s50, CODE_END-L_CPF2
    s_mov_b32 s51, 0x20000
    s_lshr_b32 s39, s2, 3
    s_lshl_b32 s39, s39, 2
    s_add_u32 s39, s39, s52
    s_mul_i32 s39, s39, 256
    v_min_u32 v17, 1, v1
    v_lshlrev_b32 v17, 7, v17
    buffer_load_dword v23, v17, s[48:51], s39 offen
    v_cmp_eq_u32 vcc, 0, v1
    v_mov_b32 v10, 262144
    s_nop 0
    v_cndmask_b32 v10, 2.0, v10, vcc
    s_mov_b32 s13, 15204352
    s_waitcnt vmcnt(11)
    s_barrier
    ds_read_b128 v[100:103], v4 offset:0
    ds_read_b128 v[104:107], v4 offset:1024
    ds_read_b128 v[108:111], v4 offset:2048
    ds_read_b128 v[112:115], v4 offset:3072
    ds_read_b64 v[116:117], v12 offset:4096
    ds_read_b64 v[118:119], v12 offset:4608
    ds_read_b128 v[120:123], v4 offset:5120
    v_mov_b32 v22, s38
    s_waitcnt lgkmcnt(6)
    v_mfma_f32_16x16x32_bf16 v[76:79], a[200:203], v[100:103], 0
    ds_read_b128 v[124:127], v4 offset:6144
    v_mfma_f32_16x16x32_bf16 v[80:83], a[204:207], v[100:103], 0
    s_add_u32 s39, s4, s26
    buffer_load_dwordx2 v[144:145], v12, s[40:43], s39 offen offset:0 sc1
    v_mfma_f32_16x16x32_bf16 v[84:87], a[208:211], v[100:103], 0
    buffer_load_dwordx2 v[146:147], v12, s[40:43], s39 offen offset:512 sc1
    s_waitcnt lgkmcnt(6)
    v_mfma_f32_16x16x32_bf16 v[76:79], a[212:215], v[104:107], v[76:79]
    ds_read_b128 v[128:131], v4 offset:7168
    s_add_u32 s39, s5, s26
    v_mfma_f32_16x16x32_bf16 v[80:83], a[216:219], v[104:107], v[80:83]
    buffer_load_dwordx2 v[148:149], v12, s[40:43], s39 offen offset:0 sc1
    v_mfma_f32_16x16x32_bf16 v[84:87], a[220:223], v[104:107], v[84:87]
    s_waitcnt lgkmcnt(5)
    buffer_load_dwordx2 v[150:151], v12, s[40:43], s39 offen offset:512 sc1
    v_mfma_f32_16x16x32_bf16 v[76:79], a[224:227], v[108:111], v[76:79]
    ds_read_b128 v[100:103], v4 offset:8192
    v_mfma_f32_16x16x32_bf16 v[80:83], a[228:231], v[108:111], v[80:83]
    s_add_u32 m0, s29, 61440
    v_mfma_f32_16x16x32_bf16 v[84:87], a[232:235], v[108:111], v[84:87]
    s_add_u32 s39, s11, 0
    buffer_load_dwordx4 v4, s[44:47], s39 offen sc1 lds
    v_mfma_f32_16x16x32_bf16 v[76:79], a[236:239], v[112:115], v[76:79]
    ds_read_b64 v[104:105], v12 offset:9216
    ds_read_b64 v[106:107], v12 offset:9728
    v_mfma_f32_16x16x32_bf16 v[80:83], a[240:243], v[112:115], v[80:83]
    s_add_u32 m0, s29, 62464
    v_mfma_f32_16x16x32_bf16 v[84:87], a[244:247], v[112:115], v[84:87]
    s_waitcnt lgkmcnt(5)
    v_mfma_f32_16x16x32_bf16 v[76:79], a[248:251], v[116:119], v[76:79]
    ds_read_b128 v[108:111], v4 offset:10240
    s_add_u32 s39, s11, 4096
    v_mfma_f32_16x16x32_bf16 v[80:83], a[252:255], v[116:119], v[80:83]
    buffer_load_dwordx4 v4, s[44:47], s39 offen sc1 lds
    v_mfma_f32_16x16x32_bf16 v[84:87], v[196:199], v[116:119], v[84:87]
    s_add_u32 m0, s29, 63488
    s_add_u32 s39, s11, 10240
    v_mfma_f32_16x16x32_bf16 v[76:79], v[200:203], v[120:123], v[76:79]
    ds_read_b128 v[112:115], v4 offset:11264
    v_mfma_f32_16x16x32_bf16 v[80:83], v[204:207], v[120:123], v[80:83]
    buffer_load_dwordx4 v4, s[44:47], s39 offen sc1 lds
    v_mfma_f32_16x16x32_bf16 v[84:87], v[208:211], v[120:123], v[84:87]
    s_waitcnt lgkmcnt(5)
    s_add_u32 m0, s29, 64512
    v_mfma_f32_16x16x32_bf16 v[76:79], v[212:215], v[124:127], v[76:79]
    ds_read_b128 v[116:119], v4 offset:12288
    v_mfma_f32_16x16x32_bf16 v[80:83], v[216:219], v[124:127], v[80:83]
    s_add_u32 s39, s11, 14336
    buffer_load_dwordx4 v4, s[44:47], s39 offen sc1 lds
    v_mfma_f32_16x16x32_bf16 v[84:87], v[220:223], v[124:127], v[84:87]
    s_add_u32 m0, s29, 65536
    v_mfma_f32_16x16x32_bf16 v[76:79], v[224:227], v[128:131], v[76:79]
    ds_read_b128 v[120:123], v4 offset:13312
    s_lshr_b32 s39, s7, 1
    v_mfma_f32_16x16x32_bf16 v[80:83], v[228:231], v[128:131], v[80:83]
    s_add_u32 s39, s39, s34
    v_mfma_f32_16x16x32_bf16 v[84:87], v[232:235], v[128:131], v[84:87]
    s_waitcnt lgkmcnt(4)
    v_mfma_f32_16x16x32_bf16 v[76:79], v[236:239], v[100:103], v[76:79]
    ds_read_b64 v[124:125], v12 offset:14336
    ds_read_b64 v[126:127], v12 offset:14848
    v_mfma_f32_16x16x32_bf16 v[80:83], v[240:243], v[100:103], v[80:83]
    s_add_u32 s39, s39, 8192
    v_mfma_f32_16x16x32_bf16 v[84:87], v[244:247], v[100:103], v[84:87]
    buffer_load_dwordx4 v6, s[44:47], s39 offen sc1 lds
    s_add_u32 s39, s6, s26
    v_mfma_f32_16x16x32_bf16 v[76:79], v[248:251], v[104:107], v[76:79]
    ds_read_b128 v[128:131], v4 offset:15360
    v_mfma_f32_16x16x32_bf16 v[80:83], v[252:255], v[104:107], v[80:83]
    buffer_load_dwordx2 v[152:153], v12, s[40:43], s39 offen offset:0 sc1
    buffer_load_dwordx2 v[154:155], v12, s[40:43], s39 offen offset:512 sc1
    v_mfma_f32_16x16x32_bf16 v[84:87], a[0:3], v[104:107], v[84:87]
    s_waitcnt lgkmcnt(5)
    v_mfma_f32_16x16x32_bf16 v[76:79], a[4:7], v[108:111], v[76:79]
    ds_read_b128 v[100:103], v4 offset:16384
    v_mfma_f32_16x16x32_bf16 v[80:83], a[8:11], v[108:111], v[80:83]
    s_add_u32 s39, s7, s26
    buffer_load_dwordx2 v[156:157], v12, s[40:43], s39 offen offset:0 sc1
    v_mfma_f32_16x16x32_bf16 v[84:87], a[12:15], v[108:111], v[84:87]
    buffer_load_dwordx2 v[158:159], v12, s[40:43], s39 offen offset:512 sc1
    v_mfma_f32_16x16x32_bf16 v[76:79], a[16:19], v[112:115], v[76:79]
    ds_read_b128 v[104:107], v4 offset:17408
    s_waitcnt vmcnt(11)
    v_add_f32 v144, v144, v146
    v_mfma_f32_16x16x32_bf16 v[80:83], a[20:23], v[112:115], v[80:83]
    v_add_f32 v145, v145, v147
    v_mfma_f32_16x16x32_bf16 v[84:87], a[24:27], v[112:115], v[84:87]
    s_waitcnt lgkmcnt(5)
    v_mov_b32 v146, v144
    v_mfma_f32_16x16x32_bf16 v[76:79], a[28:31], v[116:119], v[76:79]
    ds_read_b128 v[108:111], v4 offset:18432
    v_mfma_f32_16x16x32_bf16 v[80:83], a[32:35], v[116:119], v[80:83]
    v_mov_b32 v147, v145
    v_mfma_f32_16x16x32_bf16 v[84:87], a[36:39], v[116:119], v[84:87]
    v_permlane16_swap_b32 v144, v146
    v_permlane16_swap_b32 v145, v147
    v_mfma_f32_16x16x32_bf16 v[76:79], a[40:43], v[120:123], v[76:79]
    ds_read_b64 v[112:113], v12 offset:19456
    ds_read_b64 v[114:115], v12 offset:19968
    v_mfma_f32_16x16x32_bf16 v[80:83], a[44:47], v[120:123], v[80:83]
    v_add_f32 v144, v144, v146
    v_mfma_f32_16x16x32_bf16 v[84:87], a[48:51], v[120:123], v[84:87]
    s_waitcnt lgkmcnt(5)
    v_mfma_f32_16x16x32_bf16 v[76:79], a[52:55], v[124:127], v[76:79]
    s_barrier
    ds_read_b128 v[116:119], v4 offset:20480
    v_mfma_f32_16x16x32_bf16 v[80:83], a[56:59], v[124:127], v[80:83]
    v_mfma_f32_16x16x32_bf16 v[84:87], a[60:63], v[124:127], v[84:87]
    v_add_f32 v145, v145, v147
    v_mov_b32 v146, v144
    v_mfma_f32_16x16x32_bf16 v[76:79], a[64:67], v[128:131], v[76:79]
    ds_read_b128 v[120:123], v4 offset:21504
    v_mfma_f32_16x16x32_bf16 v[80:83], a[68:71], v[128:131], v[80:83]
    v_mov_b32 v147, v145
    v_mfma_f32_16x16x32_bf16 v[84:87], a[72:75], v[128:131], v[84:87]
    s_waitcnt lgkmcnt(5)
    v_permlane32_swap_b32 v144, v146
    v_mfma_f32_16x16x32_bf16 v[76:79], a[76:79], v[100:103], v[76:79]
    ds_read_b128 v[124:127], v4 offset:22528
    v_mfma_f32_16x16x32_bf16 v[80:83], a[80:83], v[100:103], v[80:83]
    v_permlane32_swap_b32 v145, v147
    v_add_f32 v144, v144, v146
    v_mfma_f32_16x16x32_bf16 v[84:87], a[84:87], v[100:103], v[84:87]
    v_add_f32 v145, v145, v147
    v_mfma_f32_16x16x32_bf16 v[76:79], a[88:91], v[104:107], v[76:79]
    ds_read_b128 v[128:131], v4 offset:23552
    v_mul_f32 v146, 0x3acccccd, v144
    v_mfma_f32_16x16x32_bf16 v[80:83], a[92:95], v[104:107], v[80:83]
    v_mul_f32 v147, 0x3acccccd, v145
    v_mfma_f32_16x16x32_bf16 v[84:87], a[96:99], v[104:107], v[84:87]
    s_waitcnt lgkmcnt(4)
    v_mfma_f32_16x16x32_bf16 v[76:79], a[100:103], v[108:111], v[76:79]
    ds_read_b64 v[100:101], v12 offset:24576
    ds_read_b64 v[102:103], v12 offset:25088
    v_mfma_f32_16x16x32_bf16 v[80:83], a[104:107], v[108:111], v[80:83]
    v_fma_f32 v147, -v146, v146, v147
    v_mfma_f32_16x16x32_bf16 v[84:87], a[108:111], v[108:111], v[84:87]
    v_max_f32 v147, 0, v147
    v_add_f32 v147, 0x3727c5ac, v147
    v_mfma_f32_16x16x32_bf16 v[76:79], a[112:115], v[112:115], v[76:79]
    ds_read_b128 v[104:107], v4 offset:25600
    v_mfma_f32_16x16x32_bf16 v[80:83], a[116:119], v[112:115], v[80:83]
    v_rsq_f32 v147, v147
    v_mfma_f32_16x16x32_bf16 v[84:87], a[120:123], v[112:115], v[84:87]
    s_waitcnt lgkmcnt(5)
    v_mfma_f32_16x16x32_bf16 v[88:91], a[200:203], v[116:119], 0
    v_mfma_f32_16x16x32_bf16 v[92:95], a[204:207], v[116:119], 0
    v_mfma_f32_16x16x32_bf16 v[96:99], a[208:211], v[116:119], 0
    ds_read_b128 v[108:111], v4 offset:26624
    v_pk_fma_f32 v[76:77], v[132:133], v[146:147], v[76:77] op_sel_hi:[1,0,1] neg_lo:[0,1,0] neg_hi:[0,1,0]
    v_pk_fma_f32 v[78:79], v[134:135], v[146:147], v[78:79] op_sel_hi:[1,0,1] neg_lo:[0,1,0] neg_hi:[0,1,0]
    v_pk_fma_f32 v[80:81], v[136:137], v[146:147], v[80:81] op_sel_hi:[1,0,1] neg_lo:[0,1,0] neg_hi:[0,1,0]
    v_pk_fma_f32 v[82:83], v[138:139], v[146:147], v[82:83] op_sel_hi:[1,0,1] neg_lo:[0,1,0] neg_hi:[0,1,0]
    v_pk_fma_f32 v[84:85], v[140:141], v[146:147], v[84:85] op_sel_hi:[1,0,1] neg_lo:[0,1,0] neg_hi:[0,1,0]
    v_pk_fma_f32 v[86:87], v[142:143], v[146:147], v[86:87] op_sel_hi:[1,0,1] neg_lo:[0,1,0] neg_hi:[0,1,0]
    v_pk_mul_f32 v[76:77], v[76:77], v[146:147] op_sel:[0,1] op_sel_hi:[1,1]
    v_pk_mul_f32 v[78:79], v[78:79], v[146:147] op_sel:[0,1] op_sel_hi:[1,1]
    v_pk_mul_f32 v[80:81], v[80:81], v[146:147] op_sel:[0,1] op_sel_hi:[1,1]
    v_pk_mul_f32 v[82:83], v[82:83], v[146:147] op_sel:[0,1] op_sel_hi:[1,1]
    v_pk_mul_f32 v[84:85], v[84:85], v[146:147] op_sel:[0,1] op_sel_hi:[1,1]
    v_pk_mul_f32 v[86:87], v[86:87], v[146:147] op_sel:[0,1] op_sel_hi:[1,1]
    v_pk_mul_f32 v[160:161], v[76:77], v[76:77]
    v_pk_mul_f32 v[162:163], v[78:79], v[78:79]
    v_pk_mul_f32 v[164:165], v[80:81], v[80:81]
    v_pk_mul_f32 v[166:167], v[82:83], v[82:83]
    v_pk_mul_f32 v[168:169], v[84:85], v[84:85]
    v_pk_mul_f32 v[170:171], v[86:87], v[86:87]
    v_pk_fma_f32 v[160:161], v[160:161], v[74:75], v[74:75] op_sel:[0,1,0] op_sel_hi:[1,1,0]
    v_pk_fma_f32 v[162:163], v[162:163], v[74:75], v[74:75] op_sel:[0,1,0] op_sel_hi:[1,1,0]
    v_pk_fma_f32 v[164:165], v[164:165], v[74:75], v[74:75] op_sel:[0,1,0] op_sel_hi:[1,1,0]
    v_pk_fma_f32 v[166:167], v[166:167], v[74:75], v[74:75] op_sel:[0,1,0] op_sel_hi:[1,1,0]
    v_pk_fma_f32 v[168:169], v[168:169], v[74:75], v[74:75] op_sel:[0,1,0] op_sel_hi:[1,1,0]
    v_pk_fma_f32 v[170:171], v[170:171], v[74:75], v[74:75] op_sel:[0,1,0] op_sel_hi:[1,1,0]
    v_pk_mul_f32 v[160:161], v[160:161], v[76:77]
    v_pk_mul_f32 v[162:163], v[162:163], v[78:79]
    v_pk_mul_f32 v[164:165], v[164:165], v[80:81]
    v_pk_mul_f32 v[166:167], v[166:167], v[82:83]
    v_pk_mul_f32 v[168:169], v[168:169], v[84:85]
    v_pk_mul_f32 v[170:171], v[170:171], v[86:87]
    v_mfma_f32_16x16x32_bf16 v[88:91], a[212:215], v[120:123], v[88:91]
    ds_read_b128 v[112:115], v4 offset:27648
    v_exp_f32 v160, v160
    v_mfma_f32_16x16x32_bf16 v[92:95], a[216:219], v[120:123], v[92:95]
    v_exp_f32 v161, v161
    v_mfma_f32_16x16x32_bf16 v[96:99], a[220:223], v[120:123], v[96:99]
    s_waitcnt lgkmcnt(5)
    s_add_u32 m0, s20, 9216
    v_exp_f32 v162, v162
    v_mfma_f32_16x16x32_bf16 v[88:91], a[224:227], v[124:127], v[88:91]
    ds_read_b128 v[116:119], v4 offset:28672
    v_exp_f32 v163, v163
    v_mfma_f32_16x16x32_bf16 v[92:95], a[228:231], v[124:127], v[92:95]
    v_exp_f32 v164, v164
    v_mfma_f32_16x16x32_bf16 v[96:99], a[232:235], v[124:127], v[96:99]
    v_exp_f32 v165, v165
    v_mfma_f32_16x16x32_bf16 v[88:91], a[236:239], v[128:131], v[88:91]
    ds_read_b64 v[120:121], v12 offset:29696
    ds_read_b64 v[122:123], v12 offset:30208
    buffer_load_dwordx4 v4, s[40:43], s3 offen offset:2048 sc1  lds
    v_mfma_f32_16x16x32_bf16 v[92:95], a[240:243], v[128:131], v[92:95]
    v_exp_f32 v166, v166
    v_mfma_f32_16x16x32_bf16 v[96:99], a[244:247], v[128:131], v[96:99]
    s_waitcnt lgkmcnt(5)
    v_exp_f32 v167, v167
    v_mfma_f32_16x16x32_bf16 v[88:91], a[248:251], v[100:103], v[88:91]
    ds_read_b128 v[124:127], v4 offset:30720
    v_exp_f32 v168, v168
    v_mfma_f32_16x16x32_bf16 v[92:95], a[252:255], v[100:103], v[92:95]
    v_exp_f32 v169, v169
    buffer_load_dwordx4 v4, s[40:43], s3 offen offset:3072 sc1  lds
    v_mfma_f32_16x16x32_bf16 v[96:99], v[196:199], v[100:103], v[96:99]
    v_exp_f32 v170, v170
    v_mfma_f32_16x16x32_bf16 v[88:91], v[200:203], v[104:107], v[88:91]
    ds_read_b128 v[128:131], v4 offset:31744
    v_exp_f32 v171, v171
    v_add_f32 v160, 1.0, v160
    v_mfma_f32_16x16x32_bf16 v[92:95], v[204:207], v[104:107], v[92:95]
    s_add_u32 s3, s19, 28672
    v_add_f32 v161, 1.0, v161
    v_mfma_f32_16x16x32_bf16 v[96:99], v[208:211], v[104:107], v[96:99]
    s_waitcnt lgkmcnt(5)
    v_add_f32 v162, 1.0, v162
    v_add_f32 v163, 1.0, v163
    v_mfma_f32_16x16x32_bf16 v[88:91], v[212:215], v[108:111], v[88:91]
    ds_read_b128 v[100:103], v4 offset:32768
    v_add_f32 v164, 1.0, v164
    s_add_u32 m0, s20, 13312
    v_mfma_f32_16x16x32_bf16 v[92:95], v[216:219], v[108:111], v[92:95]
    v_add_f32 v165, 1.0, v165
    v_add_f32 v166, 1.0, v166
    v_add_f32 v167, 1.0, v167
    v_mfma_f32_16x16x32_bf16 v[96:99], v[220:223], v[108:111], v[96:99]
    v_add_f32 v168, 1.0, v168
    buffer_load_dwordx4 v4, s[40:43], s3 offen offset:0 sc1  lds
    v_mfma_f32_16x16x32_bf16 v[88:91], v[224:227], v[112:115], v[88:91]
    ds_read_b128 v[104:107], v4 offset:33792
    v_add_f32 v169, 1.0, v169
    v_add_f32 v170, 1.0, v170
    v_mfma_f32_16x16x32_bf16 v[92:95], v[228:231], v[112:115], v[92:95]
    v_add_f32 v171, 1.0, v171
    v_rcp_f32 v160, v160
    v_mfma_f32_16x16x32_bf16 v[96:99], v[232:235], v[112:115], v[96:99]
    s_waitcnt lgkmcnt(4)
    buffer_load_dwordx4 v4, s[40:43], s3 offen offset:1024 sc1  lds
    v_mfma_f32_16x16x32_bf16 v[88:91], v[236:239], v[116:119], v[88:91]
    ds_read_b64 v[108:109], v12 offset:34816
    ds_read_b64 v[110:111], v12 offset:35328
    v_rcp_f32 v161, v161
    v_mfma_f32_16x16x32_bf16 v[92:95], v[240:243], v[116:119], v[92:95]
    v_rcp_f32 v162, v162
    v_mfma_f32_16x16x32_bf16 v[96:99], v[244:247], v[116:119], v[96:99]
    v_rcp_f32 v163, v163
    v_mfma_f32_16x16x32_bf16 v[88:91], v[248:251], v[120:123], v[88:91]
    ds_read_b128 v[112:115], v4 offset:35840
    v_rcp_f32 v164, v164
    v_mfma_f32_16x16x32_bf16 v[92:95], v[252:255], v[120:123], v[92:95]
    buffer_load_dwordx4 v4, s[40:43], s3 offen offset:2048 sc1  lds
    v_rcp_f32 v165, v165
    v_mfma_f32_16x16x32_bf16 v[96:99], a[0:3], v[120:123], v[96:99]
    s_waitcnt lgkmcnt(5)
    v_rcp_f32 v166, v166
    v_mfma_f32_16x16x32_bf16 v[88:91], a[4:7], v[124:127], v[88:91]
    ds_read_b128 v[116:119], v4 offset:36864
    v_rcp_f32 v167, v167
    v_mfma_f32_16x16x32_bf16 v[92:95], a[8:11], v[124:127], v[92:95]
    buffer_load_dwordx4 v4, s[40:43], s3 offen offset:3072 sc1  lds
    v_rcp_f32 v168, v168
    v_mfma_f32_16x16x32_bf16 v[96:99], a[12:15], v[124:127], v[96:99]
    v_rcp_f32 v169, v169
    v_mfma_f32_16x16x32_bf16 v[88:91], a[16:19], v[128:131], v[88:91]
    ds_read_b128 v[120:123], v4 offset:37888
    v_rcp_f32 v170, v170
    v_mfma_f32_16x16x32_bf16 v[92:95], a[20:23], v[128:131], v[92:95]
    v_rcp_f32 v171, v171
    s_add_u32 s3, s19, 32768
    v_mfma_f32_16x16x32_bf16 v[96:99], a[24:27], v[128:131], v[96:99]
    s_waitcnt lgkmcnt(5)
    v_mul_f32 v76, v76, v160
    v_mfma_f32_16x16x32_bf16 v[88:91], a[28:31], v[100:103], v[88:91]
    ds_read_b128 v[124:127], v4 offset:38912
    v_mul_f32 v77, v77, v161
    v_mul_f32 v78, v78, v162
    v_mfma_f32_16x16x32_bf16 v[92:95], a[32:35], v[100:103], v[92:95]
    v_mul_f32 v79, v79, v163
    s_add_u32 m0, s20, 17408
    v_mul_f32 v80, v80, v164
    v_mfma_f32_16x16x32_bf16 v[96:99], a[36:39], v[100:103], v[96:99]
    v_mul_f32 v81, v81, v165
    v_mul_f32 v82, v82, v166
    v_mul_f32 v83, v83, v167
    v_mfma_f32_16x16x32_bf16 v[88:91], a[40:43], v[104:107], v[88:91]
    ds_read_b64 v[128:129], v12 offset:39936
    ds_read_b64 v[130:131], v12 offset:40448
    v_mfma_f32_16x16x32_bf16 v[92:95], a[44:47], v[104:107], v[92:95]
    buffer_load_dwordx4 v4, s[40:43], s3 offen offset:0 sc1  lds
    v_mul_f32 v84, v84, v168
    v_mul_f32 v85, v85, v169
    v_mfma_f32_16x16x32_bf16 v[96:99], a[48:51], v[104:107], v[96:99]
    s_waitcnt lgkmcnt(5)
    v_mul_f32 v86, v86, v170
    v_mul_f32 v87, v87, v171
    v_mfma_f32_16x16x32_bf16 v[88:91], a[52:55], v[108:111], v[88:91]
    s_barrier
    ds_read_b128 v[100:103], v8 offset:0
    v_mfma_f32_16x16x32_bf16 v[92:95], a[56:59], v[108:111], v[92:95]
    buffer_load_dwordx4 v4, s[40:43], s3 offen offset:1024 sc1  lds
    v_cvt_pk_bf16_f32 v172, v76, v77
    v_mfma_f32_16x16x32_bf16 v[96:99], a[60:63], v[108:111], v[96:99]
    v_cvt_pk_bf16_f32 v173, v78, v79
    v_cvt_pk_bf16_f32 v174, v80, v81
    buffer_load_dwordx4 v4, s[40:43], s3 offen offset:2048 sc1  lds
    v_mfma_f32_16x16x32_bf16 v[88:91], a[64:67], v[112:115], v[88:91]
    ds_read_b128 v[104:107], v8 offset:1024
    v_cvt_pk_bf16_f32 v175, v82, v83
    s_add_u32 s60, s4, s14
    v_mfma_f32_16x16x32_bf16 v[92:95], a[68:71], v[112:115], v[92:95]
    s_bitcmp1_b32 s36, 0
    s_cbranch_scc1 L_DF8
    buffer_store_dwordx4 v[172:175], v4, s[40:43], s60 offen sc1
    s_branch L_DE8
L_DF8:
    buffer_store_dwordx4 v[172:175], v4, s[40:43], s60 offen
L_DE8:
    v_cvt_pk_bf16_f32 v180, v84, v85
    v_mfma_f32_16x16x32_bf16 v[96:99], a[72:75], v[112:115], v[96:99]
    s_waitcnt lgkmcnt(5)
    buffer_load_dwordx4 v4, s[40:43], s3 offen offset:3072 sc1  lds
    v_cvt_pk_bf16_f32 v181, v86, v87
    v_mfma_f32_16x16x32_bf16 v[88:91], a[76:79], v[116:119], v[88:91]
    ds_read_b128 v[108:111], v8 offset:2048
    s_waitcnt vmcnt(20)
    v_add_f32 v148, v148, v150
    v_add_f32 v149, v149, v151
    v_mfma_f32_16x16x32_bf16 v[92:95], a[80:83], v[116:119], v[92:95]
    v_mov_b32 v150, v148
    s_add_u32 s3, s19, 36864
    v_mov_b32 v151, v149
    v_mfma_f32_16x16x32_bf16 v[96:99], a[84:87], v[116:119], v[96:99]
    v_permlane16_swap_b32 v148, v150
    v_permlane16_swap_b32 v149, v151
    v_mfma_f32_16x16x32_bf16 v[88:91], a[88:91], v[120:123], v[88:91]
    ds_read_b128 v[112:115], v8 offset:3072
    v_add_f32 v148, v148, v150
    s_add_u32 m0, s20, 21504
    v_mfma_f32_16x16x32_bf16 v[92:95], a[92:95], v[120:123], v[92:95]
    v_add_f32 v149, v149, v151
    v_mov_b32 v150, v148
    v_mov_b32 v151, v149
    v_mfma_f32_16x16x32_bf16 v[96:99], a[96:99], v[120:123], v[96:99]
    s_waitcnt lgkmcnt(4)
    v_permlane32_swap_b32 v148, v150
    buffer_load_dwordx4 v4, s[40:43], s3 offen offset:0 sc1  lds
    v_mfma_f32_16x16x32_bf16 v[88:91], a[100:103], v[124:127], v[88:91]
    ds_read_b64 v[116:117], v9 offset:4096
    ds_read_b64 v[118:119], v9 offset:4608
    v_mfma_f32_16x16x32_bf16 v[92:95], a[104:107], v[124:127], v[92:95]
    v_permlane32_swap_b32 v149, v151
    v_add_f32 v148, v148, v150
    v_add_f32 v149, v149, v151
    v_mfma_f32_16x16x32_bf16 v[96:99], a[108:111], v[124:127], v[96:99]
    buffer_load_dwordx4 v4, s[40:43], s3 offen offset:1024 sc1  lds
    v_mul_f32 v150, 0x3acccccd, v148
    v_mul_f32 v151, 0x3acccccd, v149
    v_mfma_f32_16x16x32_bf16 v[88:91], a[112:115], v[128:131], v[88:91]
    ds_read_b128 v[120:123], v8 offset:5120
    v_fma_f32 v151, -v150, v150, v151
    v_max_f32 v151, 0, v151
    v_mfma_f32_16x16x32_bf16 v[92:95], a[116:119], v[128:131], v[92:95]
    buffer_load_dwordx4 v4, s[40:43], s3 offen offset:2048 sc1  lds
    v_add_f32 v151, 0x3727c5ac, v151
    v_mfma_f32_16x16x32_bf16 v[96:99], a[120:123], v[128:131], v[96:99]
    s_waitcnt lgkmcnt(5)
    v_rsq_f32 v151, v151
    v_mfma_f32_16x16x32_bf16 v[76:79], a[200:203], v[100:103], 0
    v_mfma_f32_16x16x32_bf16 v[80:83], a[204:207], v[100:103], 0
    v_mfma_f32_16x16x32_bf16 v[84:87], a[208:211], v[100:103], 0
    ds_read_b128 v[124:127], v8 offset:6144
    v_pk_fma_f32 v[88:89], v[132:133], v[150:151], v[88:89] op_sel_hi:[1,0,1] neg_lo:[0,1,0] neg_hi:[0,1,0]
    v_pk_fma_f32 v[90:91], v[134:135], v[150:151], v[90:91] op_sel_hi:[1,0,1] neg_lo:[0,1,0] neg_hi:[0,1,0]
    v_pk_fma_f32 v[92:93], v[136:137], v[150:151], v[92:93] op_sel_hi:[1,0,1] neg_lo:[0,1,0] neg_hi:[0,1,0]
    v_pk_fma_f32 v[94:95], v[138:139], v[150:151], v[94:95] op_sel_hi:[1,0,1] neg_lo:[0,1,0] neg_hi:[0,1,0]
    v_pk_fma_f32 v[96:97], v[140:141], v[150:151], v[96:97] op_sel_hi:[1,0,1] neg_lo:[0,1,0] neg_hi:[0,1,0]
    v_pk_fma_f32 v[98:99], v[142:143], v[150:151], v[98:99] op_sel_hi:[1,0,1] neg_lo:[0,1,0] neg_hi:[0,1,0]
    v_pk_mul_f32 v[88:89], v[88:89], v[150:151] op_sel:[0,1] op_sel_hi:[1,1]
    v_pk_mul_f32 v[90:91], v[90:91], v[150:151] op_sel:[0,1] op_sel_hi:[1,1]
    v_pk_mul_f32 v[92:93], v[92:93], v[150:151] op_sel:[0,1] op_sel_hi:[1,1]
    v_pk_mul_f32 v[94:95], v[94:95], v[150:151] op_sel:[0,1] op_sel_hi:[1,1]
    v_pk_mul_f32 v[96:97], v[96:97], v[150:151] op_sel:[0,1] op_sel_hi:[1,1]
    v_pk_mul_f32 v[98:99], v[98:99], v[150:151] op_sel:[0,1] op_sel_hi:[1,1]
    v_pk_mul_f32 v[160:161], v[88:89], v[88:89]
    v_pk_mul_f32 v[162:163], v[90:91], v[90:91]
    v_pk_mul_f32 v[164:165], v[92:93], v[92:93]
    v_pk_mul_f32 v[166:167], v[94:95], v[94:95]
    v_pk_mul_f32 v[168:169], v[96:97], v[96:97]
    v_pk_mul_f32 v[170:171], v[98:99], v[98:99]
    v_pk_fma_f32 v[160:161], v[160:161], v[74:75], v[74:75] op_sel:[0,1,0] op_sel_hi:[1,1,0]
    v_pk_fma_f32 v[162:163], v[162:163], v[74:75], v[74:75] op_sel:[0,1,0] op_sel_hi:[1,1,0]
    v_pk_fma_f32 v[164:165], v[164:165], v[74:75], v[74:75] op_sel:[0,1,0] op_sel_hi:[1,1,0]
    v_pk_fma_f32 v[166:167], v[166:167], v[74:75], v[74:75] op_sel:[0,1,0] op_sel_hi:[1,1,0]
    v_pk_fma_f32 v[168:169], v[168:169], v[74:75], v[74:75] op_sel:[0,1,0] op_sel_hi:[1,1,0]
    v_pk_fma_f32 v[170:171], v[170:171], v[74:75], v[74:75] op_sel:[0,1,0] op_sel_hi:[1,1,0]
    v_pk_mul_f32 v[160:161], v[160:161], v[88:89]
    v_pk_mul_f32 v[162:163], v[162:163], v[90:91]
    v_pk_mul_f32 v[164:165], v[164:165], v[92:93]
    v_pk_mul_f32 v[166:167], v[166:167], v[94:95]
    v_pk_mul_f32 v[168:169], v[168:169], v[96:97]
    v_pk_mul_f32 v[170:171], v[170:171], v[98:99]
    v_mfma_f32_16x16x32_bf16 v[76:79], a[212:215], v[104:107], v[76:79]
    ds_read_b128 v[128:131], v8 offset:7168
    v_exp_f32 v160, v160
    v_mfma_f32_16x16x32_bf16 v[80:83], a[216:219], v[104:107], v[80:83]
    v_exp_f32 v161, v161
    v_mfma_f32_16x16x32_bf16 v[84:87], a[220:223], v[104:107], v[84:87]
    s_waitcnt lgkmcnt(5)
    v_exp_f32 v162, v162
    v_mfma_f32_16x16x32_bf16 v[76:79], a[224:227], v[108:111], v[76:79]
    ds_read_b128 v[100:103], v8 offset:8192
    buffer_load_dwordx4 a[124:127], v4, s[40:43], s19 offen offset:0 sc1
    v_mfma_f32_16x16x32_bf16 v[80:83], a[228:231], v[108:111], v[80:83]
    v_exp_f32 v163, v163
    v_exp_f32 v164, v164
    v_mfma_f32_16x16x32_bf16 v[84:87], a[232:235], v[108:111], v[84:87]
    v_exp_f32 v165, v165
    v_mfma_f32_16x16x32_bf16 v[76:79], a[236:239], v[112:115], v[76:79]
    ds_read_b64 v[104:105], v9 offset:9216
    ds_read_b64 v[106:107], v9 offset:9728
    v_exp_f32 v166, v166
    v_mfma_f32_16x16x32_bf16 v[80:83], a[240:243], v[112:115], v[80:83]
    v_exp_f32 v167, v167
    v_mfma_f32_16x16x32_bf16 v[84:87], a[244:247], v[112:115], v[84:87]
    s_waitcnt lgkmcnt(5)
    buffer_load_dwordx4 a[128:131], v4, s[40:43], s19 offen offset:1024 sc1
    v_mfma_f32_16x16x32_bf16 v[76:79], a[248:251], v[116:119], v[76:79]
    ds_read_b128 v[108:111], v8 offset:10240
    v_exp_f32 v168, v168
    v_mfma_f32_16x16x32_bf16 v[80:83], a[252:255], v[116:119], v[80:83]
    v_exp_f32 v169, v169
    v_exp_f32 v170, v170
    v_mfma_f32_16x16x32_bf16 v[84:87], v[196:199], v[116:119], v[84:87]
    v_exp_f32 v171, v171
    v_mfma_f32_16x16x32_bf16 v[76:79], v[200:203], v[120:123], v[76:79]
    ds_read_b128 v[112:115], v8 offset:11264
    v_add_f32 v160, 1.0, v160
    buffer_load_dwordx4 a[132:135], v4, s[40:43], s19 offen offset:2048 sc1
    v_mfma_f32_16x16x32_bf16 v[80:83], v[204:207], v[120:123], v[80:83]
    v_add_f32 v161, 1.0, v161
    v_add_f32 v162, 1.0, v162
    v_mfma_f32_16x16x32_bf16 v[84:87], v[208:211], v[120:123], v[84:87]
    s_waitcnt lgkmcnt(5)
    v_add_f32 v163, 1.0, v163
    v_add_f32 v164, 1.0, v164
    v_mfma_f32_16x16x32_bf16 v[76:79], v[212:215], v[124:127], v[76:79]
    ds_read_b128 v[116:119], v8 offset:12288
    v_add_f32 v165, 1.0, v165
    buffer_load_dwordx4 a[136:139], v4, s[40:43], s19 offen offset:3072 sc1
    v_mfma_f32_16x16x32_bf16 v[80:83], v[216:219], v[124:127], v[80:83]
    v_add_f32 v166, 1.0, v166
    v_add_f32 v167, 1.0, v167
    v_add_f32 v168, 1.0, v168
    v_mfma_f32_16x16x32_bf16 v[84:87], v[220:223], v[124:127], v[84:87]
    v_add_f32 v169, 1.0, v169
    v_add_f32 v170, 1.0, v170
    v_mfma_f32_16x16x32_bf16 v[76:79], v[224:227], v[128:131], v[76:79]
    ds_read_b128 v[120:123], v8 offset:13312
    s_add_u32 s3, s19, 4096
    v_add_f32 v171, 1.0, v171
    v_mfma_f32_16x16x32_bf16 v[80:83], v[228:231], v[128:131], v[80:83]
    v_rcp_f32 v160, v160
    v_mfma_f32_16x16x32_bf16 v[84:87], v[232:235], v[128:131], v[84:87]
    s_waitcnt lgkmcnt(4)
    v_rcp_f32 v161, v161
    v_mfma_f32_16x16x32_bf16 v[76:79], v[236:239], v[100:103], v[76:79]
    ds_read_b64 v[124:125], v9 offset:14336
    ds_read_b64 v[126:127], v9 offset:14848
    v_rcp_f32 v162, v162
    v_mfma_f32_16x16x32_bf16 v[80:83], v[240:243], v[100:103], v[80:83]
    v_rcp_f32 v163, v163
    v_mfma_f32_16x16x32_bf16 v[84:87], v[244:247], v[100:103], v[84:87]
    buffer_load_dwordx4 a[140:143], v4, s[40:43], s3 offen offset:0 sc1
    v_rcp_f32 v164, v164
    v_mfma_f32_16x16x32_bf16 v[76:79], v[248:251], v[104:107], v[76:79]
    ds_read_b128 v[128:131], v8 offset:15360
    v_rcp_f32 v165, v165
    v_mfma_f32_16x16x32_bf16 v[80:83], v[252:255], v[104:107], v[80:83]
    v_rcp_f32 v166, v166
    v_mfma_f32_16x16x32_bf16 v[84:87], a[0:3], v[104:107], v[84:87]
    s_waitcnt lgkmcnt(5)
    v_rcp_f32 v167, v167
    v_mfma_f32_16x16x32_bf16 v[76:79], a[4:7], v[108:111], v[76:79]
    ds_read_b128 v[100:103], v8 offset:16384
    v_rcp_f32 v168, v168
    v_mfma_f32_16x16x32_bf16 v[80:83], a[8:11], v[108:111], v[80:83]
    buffer_load_dwordx4 a[144:147], v4, s[40:43], s3 offen offset:1024 sc1
    v_rcp_f32 v169, v169
    v_mfma_f32_16x16x32_bf16 v[84:87], a[12:15], v[108:111], v[84:87]
    v_rcp_f32 v170, v170
    v_mfma_f32_16x16x32_bf16 v[76:79], a[16:19], v[112:115], v[76:79]
    ds_read_b128 v[104:107], v8 offset:17408
    v_rcp_f32 v171, v171
    v_mfma_f32_16x16x32_bf16 v[80:83], a[20:23], v[112:115], v[80:83]
    v_mul_f32 v88, v88, v160
    v_mul_f32 v89, v89, v161
    buffer_load_dwordx4 a[148:151], v4, s[40:43], s3 offen offset:2048 sc1
    v_mfma_f32_16x16x32_bf16 v[84:87], a[24:27], v[112:115], v[84:87]
    s_waitcnt lgkmcnt(5)
    v_mul_f32 v90, v90, v162
    v_mfma_f32_16x16x32_bf16 v[76:79], a[28:31], v[116:119], v[76:79]
    ds_read_b128 v[108:111], v8 offset:18432
    v_mul_f32 v91, v91, v163
    v_mul_f32 v92, v92, v164
    v_mfma_f32_16x16x32_bf16 v[80:83], a[32:35], v[116:119], v[80:83]
    v_mul_f32 v93, v93, v165
    v_mul_f32 v94, v94, v166
    buffer_load_dwordx4 a[152:155], v4, s[40:43], s3 offen offset:3072 sc1
    v_mfma_f32_16x16x32_bf16 v[84:87], a[36:39], v[116:119], v[84:87]
    v_mul_f32 v95, v95, v167
    v_mul_f32 v96, v96, v168
    v_mul_f32 v97, v97, v169
    v_mfma_f32_16x16x32_bf16 v[76:79], a[40:43], v[120:123], v[76:79]
    ds_read_b64 v[112:113], v9 offset:19456
    ds_read_b64 v[114:115], v9 offset:19968
    v_mfma_f32_16x16x32_bf16 v[80:83], a[44:47], v[120:123], v[80:83]
    v_mul_f32 v98, v98, v170
    v_mul_f32 v99, v99, v171
    s_add_u32 s3, s19, 8192
    v_mfma_f32_16x16x32_bf16 v[84:87], a[48:51], v[120:123], v[84:87]
    s_waitcnt lgkmcnt(5)
    v_cvt_pk_bf16_f32 v176, v88, v89
    v_cvt_pk_bf16_f32 v177, v90, v91
    v_mfma_f32_16x16x32_bf16 v[76:79], a[52:55], v[124:127], v[76:79]
    s_waitcnt vmcnt(26)
    s_barrier
    ds_read_b128 v[116:119], v8 offset:30720
    v_mfma_f32_16x16x32_bf16 v[80:83], a[56:59], v[124:127], v[80:83]
    v_cvt_pk_bf16_f32 v178, v92, v93
    v_cvt_pk_bf16_f32 v179, v94, v95
    v_mfma_f32_16x16x32_bf16 v[84:87], a[60:63], v[124:127], v[84:87]
    s_add_u32 s60, s5, s14
    buffer_load_dwordx4 a[156:159], v4, s[40:43], s3 offen offset:0 sc1
    s_bitcmp1_b32 s36, 0
    s_cbranch_scc1 L_DF9
    buffer_store_dwordx4 v[176:179], v4, s[40:43], s60 offen sc1
    s_branch L_DE9
L_DF9:
    buffer_store_dwordx4 v[176:179], v4, s[40:43], s60 offen
L_DE9:
    v_mfma_f32_16x16x32_bf16 v[76:79], a[64:67], v[128:131], v[76:79]
    ds_read_b128 v[120:123], v8 offset:31744
    v_cvt_pk_bf16_f32 v182, v96, v97
    v_cvt_pk_bf16_f32 v183, v98, v99
    v_mfma_f32_16x16x32_bf16 v[80:83], a[68:71], v[128:131], v[80:83]
    s_lshr_b32 s60, s5, 11
    s_lshl_b32 s60, s60, 10
    v_mfma_f32_16x16x32_bf16 v[84:87], a[72:75], v[128:131], v[84:87]
    s_waitcnt lgkmcnt(5)
    buffer_load_dwordx4 a[160:163], v4, s[40:43], s3 offen offset:1024 sc1
    s_add_u32 s60, s60, s15
    v_mfma_f32_16x16x32_bf16 v[76:79], a[76:79], v[100:103], v[76:79]
    ds_read_b128 v[124:127], v8 offset:32768
    s_bitcmp1_b32 s36, 0
    s_cbranch_scc1 L_DF10
    buffer_store_dwordx4 v[180:183], v4, s[40:43], s60 offen sc1
    s_branch L_DE10
L_DF10:
    buffer_store_dwordx4 v[180:183], v4, s[40:43], s60 offen
L_DE10:
    s_waitcnt vmcnt(28)
    v_add_f32 v152, v152, v154
    v_mfma_f32_16x16x32_bf16 v[80:83], a[80:83], v[100:103], v[80:83]
    v_add_f32 v153, v153, v155
    v_mov_b32 v154, v152
    buffer_load_dwordx4 a[164:167], v4, s[40:43], s3 offen offset:2048 sc1
    v_mfma_f32_16x16x32_bf16 v[84:87], a[84:87], v[100:103], v[84:87]
    v_mov_b32 v155, v153
    v_permlane16_swap_b32 v152, v154
    v_mfma_f32_16x16x32_bf16 v[76:79], a[88:91], v[104:107], v[76:79]
    ds_read_b128 v[128:131], v8 offset:33792
    v_permlane16_swap_b32 v153, v155
    v_add_f32 v152, v152, v154
    v_mfma_f32_16x16x32_bf16 v[80:83], a[92:95], v[104:107], v[80:83]
    v_add_f32 v153, v153, v155
    buffer_load_dwordx4 a[168:171], v4, s[40:43], s3 offen offset:3072 sc1
    v_mov_b32 v154, v152
    v_mfma_f32_16x16x32_bf16 v[84:87], a[96:99], v[104:107], v[84:87]
    s_waitcnt lgkmcnt(4)
    v_mov_b32 v155, v153
    v_permlane32_swap_b32 v152, v154
    v_mfma_f32_16x16x32_bf16 v[76:79], a[100:103], v[108:111], v[76:79]
    ds_read_b64 v[100:101], v9 offset:34816
    ds_read_b64 v[102:103], v9 offset:35328
    v_mfma_f32_16x16x32_bf16 v[80:83], a[104:107], v[108:111], v[80:83]
    v_permlane32_swap_b32 v153, v155
    v_add_f32 v152, v152, v154
    s_add_u32 s3, s19, 12288
    v_mfma_f32_16x16x32_bf16 v[84:87], a[108:111], v[108:111], v[84:87]
    v_add_f32 v153, v153, v155
    v_mul_f32 v154, 0x3acccccd, v152
    v_mul_f32 v155, 0x3acccccd, v153
    v_mfma_f32_16x16x32_bf16 v[76:79], a[112:115], v[112:115], v[76:79]
    ds_read_b128 v[104:107], v8 offset:35840
    v_fma_f32 v155, -v154, v154, v155
    v_max_f32 v155, 0, v155
    v_mfma_f32_16x16x32_bf16 v[80:83], a[116:119], v[112:115], v[80:83]
    buffer_load_dwordx4 a[172:175], v4, s[40:43], s3 offen offset:0 sc1
    v_add_f32 v155, 0x3727c5ac, v155
    v_mfma_f32_16x16x32_bf16 v[84:87], a[120:123], v[112:115], v[84:87]
    s_waitcnt lgkmcnt(5)
    v_rsq_f32 v155, v155
    v_mfma_f32_16x16x32_bf16 v[88:91], a[4:7], v[116:119], 0
    v_mfma_f32_16x16x32_bf16 v[92:95], a[8:11], v[116:119], 0
    v_mfma_f32_16x16x32_bf16 v[96:99], a[12:15], v[116:119], 0
    ds_read_b128 v[108:111], v8 offset:36864
    v_pk_fma_f32 v[76:77], v[132:133], v[154:155], v[76:77] op_sel_hi:[1,0,1] neg_lo:[0,1,0] neg_hi:[0,1,0]
    v_pk_fma_f32 v[78:79], v[134:135], v[154:155], v[78:79] op_sel_hi:[1,0,1] neg_lo:[0,1,0] neg_hi:[0,1,0]
    v_pk_fma_f32 v[80:81], v[136:137], v[154:155], v[80:81] op_sel_hi:[1,0,1] neg_lo:[0,1,0] neg_hi:[0,1,0]
    v_pk_fma_f32 v[82:83], v[138:139], v[154:155], v[82:83] op_sel_hi:[1,0,1] neg_lo:[0,1,0] neg_hi:[0,1,0]
    v_pk_fma_f32 v[84:85], v[140:141], v[154:155], v[84:85] op_sel_hi:[1,0,1] neg_lo:[0,1,0] neg_hi:[0,1,0]
    v_pk_fma_f32 v[86:87], v[142:143], v[154:155], v[86:87] op_sel_hi:[1,0,1] neg_lo:[0,1,0] neg_hi:[0,1,0]
    v_pk_mul_f32 v[76:77], v[76:77], v[154:155] op_sel:[0,1] op_sel_hi:[1,1]
    v_pk_mul_f32 v[78:79], v[78:79], v[154:155] op_sel:[0,1] op_sel_hi:[1,1]
    v_pk_mul_f32 v[80:81], v[80:81], v[154:155] op_sel:[0,1] op_sel_hi:[1,1]
    v_pk_mul_f32 v[82:83], v[82:83], v[154:155] op_sel:[0,1] op_sel_hi:[1,1]
    v_pk_mul_f32 v[84:85], v[84:85], v[154:155] op_sel:[0,1] op_sel_hi:[1,1]
    v_pk_mul_f32 v[86:87], v[86:87], v[154:155] op_sel:[0,1] op_sel_hi:[1,1]
    v_pk_mul_f32 v[160:161], v[76:77], v[76:77]
    v_pk_mul_f32 v[162:163], v[78:79], v[78:79]
    v_pk_mul_f32 v[164:165], v[80:81], v[80:81]
    v_pk_mul_f32 v[166:167], v[82:83], v[82:83]
    v_pk_mul_f32 v[168:169], v[84:85], v[84:85]
    v_pk_mul_f32 v[170:171], v[86:87], v[86:87]
    v_pk_fma_f32 v[160:161], v[160:161], v[74:75], v[74:75] op_sel:[0,1,0] op_sel_hi:[1,1,0]
    v_pk_fma_f32 v[162:163], v[162:163], v[74:75], v[74:75] op_sel:[0,1,0] op_sel_hi:[1,1,0]
    v_pk_fma_f32 v[164:165], v[164:165], v[74:75], v[74:75] op_sel:[0,1,0] op_sel_hi:[1,1,0]
    v_pk_fma_f32 v[166:167], v[166:167], v[74:75], v[74:75] op_sel:[0,1,0] op_sel_hi:[1,1,0]
    v_pk_fma_f32 v[168:169], v[168:169], v[74:75], v[74:75] op_sel:[0,1,0] op_sel_hi:[1,1,0]
    v_pk_fma_f32 v[170:171], v[170:171], v[74:75], v[74:75] op_sel:[0,1,0] op_sel_hi:[1,1,0]
    v_pk_mul_f32 v[160:161], v[160:161], v[76:77]
    v_pk_mul_f32 v[162:163], v[162:163], v[78:79]
    v_pk_mul_f32 v[164:165], v[164:165], v[80:81]
    v_pk_mul_f32 v[166:167], v[166:167], v[82:83]
    v_pk_mul_f32 v[168:169], v[168:169], v[84:85]
    v_pk_mul_f32 v[170:171], v[170:171], v[86:87]
    v_mfma_f32_16x16x32_bf16 v[88:91], a[16:19], v[120:123], v[88:91]
    ds_read_b128 v[112:115], v8 offset:37888
    v_exp_f32 v160, v160
    v_mfma_f32_16x16x32_bf16 v[92:95], a[20:23], v[120:123], v[92:95]
    buffer_load_dwordx4 a[176:179], v4, s[40:43], s3 offen offset:1024 sc1
    v_exp_f32 v161, v161
    v_mfma_f32_16x16x32_bf16 v[96:99], a[24:27], v[120:123], v[96:99]
    s_waitcnt lgkmcnt(5)
    v_exp_f32 v162, v162
    v_mfma_f32_16x16x32_bf16 v[88:91], a[28:31], v[124:127], v[88:91]
    ds_read_b128 v[116:119], v8 offset:38912
    v_exp_f32 v163, v163
    v_mfma_f32_16x16x32_bf16 v[92:95], a[32:35], v[124:127], v[92:95]
    buffer_load_dwordx4 a[180:183], v4, s[40:43], s3 offen offset:2048 sc1
    v_exp_f32 v164, v164
    v_mfma_f32_16x16x32_bf16 v[96:99], a[36:39], v[124:127], v[96:99]
    v_exp_f32 v165, v165
    v_mfma_f32_16x16x32_bf16 v[88:91], a[40:43], v[128:131], v[88:91]
    ds_read_b64 v[120:121], v9 offset:39936
    ds_read_b64 v[122:123], v9 offset:40448
    buffer_load_dwordx4 a[184:187], v4, s[40:43], s3 offen offset:3072 sc1
    v_mfma_f32_16x16x32_bf16 v[92:95], a[44:47], v[128:131], v[92:95]
    v_exp_f32 v166, v166
    v_mfma_f32_16x16x32_bf16 v[96:99], a[48:51], v[128:131], v[96:99]
    s_waitcnt lgkmcnt(5)
    v_exp_f32 v167, v167
    s_add_u32 s3, s19, 16384
    v_mfma_f32_16x16x32_bf16 v[88:91], a[52:55], v[100:103], v[88:91]
    ds_read_b128 v[124:127], v8 offset:20480
    v_exp_f32 v168, v168
    v_mfma_f32_16x16x32_bf16 v[92:95], a[56:59], v[100:103], v[92:95]
    v_add_u32 v11, 2, v22
    s_waitcnt vmcnt(6)
    s_bitcmp1_b32 s36, 0
    s_cbranch_scc1 L_DF11
    buffer_store_dword v11, v10, s[40:43], s27 offen sc1
    s_branch L_DE11
L_DF11:
    buffer_store_dword v11, v10, s[40:43], s27 offen
L_DE11:
    v_mfma_f32_16x16x32_bf16 v[96:99], a[60:63], v[100:103], v[96:99]
    v_exp_f32 v169, v169
    v_mfma_f32_16x16x32_bf16 v[88:91], a[64:67], v[104:107], v[88:91]
    ds_read_b128 v[128:131], v8 offset:21504
    v_exp_f32 v170, v170
    v_mfma_f32_16x16x32_bf16 v[92:95], a[68:71], v[104:107], v[92:95]
    buffer_load_dwordx4 a[188:191], v4, s[40:43], s3 offen offset:0 sc1
    v_exp_f32 v171, v171
    v_mfma_f32_16x16x32_bf16 v[96:99], a[72:75], v[104:107], v[96:99]
    s_waitcnt lgkmcnt(5)
    v_add_f32 v160, 1.0, v160
    buffer_load_dwordx4 a[192:195], v4, s[40:43], s3 offen offset:1024 sc1
    v_mfma_f32_16x16x32_bf16 v[88:91], a[76:79], v[108:111], v[88:91]
    ds_read_b128 v[100:103], v8 offset:22528
    v_add_f32 v161, 1.0, v161
    v_add_f32 v162, 1.0, v162
    v_mfma_f32_16x16x32_bf16 v[92:95], a[80:83], v[108:111], v[92:95]
    buffer_load_dwordx4 a[196:199], v4, s[40:43], s3 offen offset:2048 sc1
    v_add_f32 v163, 1.0, v163
    v_add_f32 v164, 1.0, v164
    v_mfma_f32_16x16x32_bf16 v[96:99], a[84:87], v[108:111], v[96:99]
    v_add_f32 v165, 1.0, v165
    s_add_u32 s3, s19, 40960
    v_mfma_f32_16x16x32_bf16 v[88:91], a[88:91], v[112:115], v[88:91]
    ds_read_b128 v[104:107], v8 offset:23552
    v_add_f32 v166, 1.0, v166
    v_add_f32 v167, 1.0, v167
    v_mfma_f32_16x16x32_bf16 v[92:95], a[92:95], v[112:115], v[92:95]
    buffer_load_dwordx4 a[4:7], v4, s[40:43], s3 offen offset:0 sc1
    v_add_f32 v168, 1.0, v168
    v_add_f32 v169, 1.0, v169
    v_mfma_f32_16x16x32_bf16 v[96:99], a[96:99], v[112:115], v[96:99]
    s_waitcnt lgkmcnt(4)
    v_add_f32 v170, 1.0, v170
    buffer_load_dwordx4 a[8:11], v4, s[40:43], s3 offen offset:1024 sc1
    v_mfma_f32_16x16x32_bf16 v[88:91], a[100:103], v[116:119], v[88:91]
    ds_read_b64 v[108:109], v9 offset:24576
    ds_read_b64 v[110:111], v9 offset:25088
    v_add_f32 v171, 1.0, v171
    v_mfma_f32_16x16x32_bf16 v[92:95], a[104:107], v[116:119], v[92:95]
    v_rcp_f32 v160, v160
    buffer_load_dwordx4 a[12:15], v4, s[40:43], s3 offen offset:2048 sc1
    v_mfma_f32_16x16x32_bf16 v[96:99], a[108:111], v[116:119], v[96:99]
    v_rcp_f32 v161, v161
    v_mfma_f32_16x16x32_bf16 v[88:91], a[112:115], v[120:123], v[88:91]
    ds_read_b128 v[112:115], v8 offset:25600
    v_rcp_f32 v162, v162
    v_mfma_f32_16x16x32_bf16 v[92:95], a[116:119], v[120:123], v[92:95]
    buffer_load_dwordx4 a[16:19], v4, s[40:43], s3 offen offset:3072 sc1
    v_rcp_f32 v163, v163
    v_mfma_f32_16x16x32_bf16 v[96:99], a[120:123], v[120:123], v[96:99]
    s_waitcnt lgkmcnt(5)
    v_rcp_f32 v164, v164
    v_mfma_f32_16x16x32_bf16 v[88:91], a[200:203], v[124:127], v[88:91]
    ds_read_b128 v[116:119], v8 offset:26624
    v_rcp_f32 v165, v165
    v_mfma_f32_16x16x32_bf16 v[92:95], a[204:207], v[124:127], v[92:95]
    s_add_u32 s3, s19, 45056
    v_rcp_f32 v166, v166
    v_mfma_f32_16x16x32_bf16 v[96:99], a[208:211], v[124:127], v[96:99]
    v_rcp_f32 v167, v167
    buffer_load_dwordx4 a[20:23], v4, s[40:43], s3 offen offset:0 sc1
    v_mfma_f32_16x16x32_bf16 v[88:91], a[212:215], v[128:131], v[88:91]
    ds_read_b128 v[120:123], v8 offset:27648
    v_rcp_f32 v168, v168
    v_mfma_f32_16x16x32_bf16 v[92:95], a[216:219], v[128:131], v[92:95]
    v_rcp_f32 v169, v169
    buffer_load_dwordx4 a[24:27], v4, s[40:43], s3 offen offset:1024 sc1
    v_mfma_f32_16x16x32_bf16 v[96:99], a[220:223], v[128:131], v[96:99]
    s_waitcnt lgkmcnt(5)
    v_rcp_f32 v170, v170
    v_mfma_f32_16x16x32_bf16 v[88:91], a[224:227], v[100:103], v[88:91]
    ds_read_b128 v[124:127], v8 offset:28672
    v_rcp_f32 v171, v171
    v_mfma_f32_16x16x32_bf16 v[92:95], a[228:231], v[100:103], v[92:95]
    v_mul_f32 v76, v76, v160
    buffer_load_dwordx4 a[28:31], v4, s[40:43], s3 offen offset:2048 sc1
    v_mfma_f32_16x16x32_bf16 v[96:99], a[232:235], v[100:103], v[96:99]
    v_mul_f32 v77, v77, v161
    v_mul_f32 v78, v78, v162
    buffer_load_dwordx4 a[32:35], v4, s[40:43], s3 offen offset:3072 sc1
    v_mfma_f32_16x16x32_bf16 v[88:91], a[236:239], v[104:107], v[88:91]
    ds_read_b64 v[128:129], v9 offset:29696
    ds_read_b64 v[130:131], v9 offset:30208
    v_mul_f32 v79, v79, v163
    v_mfma_f32_16x16x32_bf16 v[92:95], a[240:243], v[104:107], v[92:95]
    buffer_load_dword v21, v7, s[40:43], s13 offen sc1
    v_mul_f32 v80, v80, v164
    v_mul_f32 v81, v81, v165
    v_mfma_f32_16x16x32_bf16 v[96:99], a[244:247], v[104:107], v[96:99]
    s_waitcnt lgkmcnt(5)
    s_add_u32 s3, s19, 49152
    v_mul_f32 v82, v82, v166
    v_mfma_f32_16x16x32_bf16 v[88:91], a[248:251], v[108:111], v[88:91]
    v_mul_f32 v83, v83, v167
    buffer_load_dwordx4 a[36:39], v4, s[40:43], s3 offen offset:0 sc1
    v_mfma_f32_16x16x32_bf16 v[92:95], a[252:255], v[108:111], v[92:95]
    v_mul_f32 v84, v84, v168
    v_mul_f32 v85, v85, v169
    buffer_load_dwordx4 a[40:43], v4, s[40:43], s3 offen offset:1024 sc1
    v_mfma_f32_16x16x32_bf16 v[96:99], v[196:199], v[108:111], v[96:99]
    v_mul_f32 v86, v86, v170
    v_mul_f32 v87, v87, v171
    v_cvt_pk_bf16_f32 v172, v76, v77
    v_mfma_f32_16x16x32_bf16 v[88:91], v[200:203], v[112:115], v[88:91]
    buffer_load_dwordx4 a[44:47], v4, s[40:43], s3 offen offset:2048 sc1
    v_cvt_pk_bf16_f32 v173, v78, v79
    v_cvt_pk_bf16_f32 v174, v80, v81
    v_mfma_f32_16x16x32_bf16 v[92:95], v[204:207], v[112:115], v[92:95]
    buffer_load_dwordx4 a[48:51], v4, s[40:43], s3 offen offset:3072 sc1
    v_cvt_pk_bf16_f32 v175, v82, v83
    s_add_u32 s60, s6, s14
    v_mfma_f32_16x16x32_bf16 v[96:99], v[208:211], v[112:115], v[96:99]
    s_waitcnt lgkmcnt(3)
    s_add_u32 s3, s19, 53248
    s_bitcmp1_b32 s36, 0
    s_cbranch_scc1 L_DF12
    buffer_store_dwordx4 v[172:175], v4, s[40:43], s60 offen sc1
    s_branch L_DE12
L_DF12:
    buffer_store_dwordx4 v[172:175], v4, s[40:43], s60 offen
L_DE12:
    v_mfma_f32_16x16x32_bf16 v[88:91], v[212:215], v[116:119], v[88:91]
    v_cvt_pk_bf16_f32 v184, v84, v85
    v_cvt_pk_bf16_f32 v185, v86, v87
    buffer_load_dwordx4 a[52:55], v4, s[40:43], s3 offen offset:0 sc1
    v_mfma_f32_16x16x32_bf16 v[92:95], v[216:219], v[116:119], v[92:95]
    v_add_f32 v156, v156, v158
    v_add_f32 v157, v157, v159
    v_mfma_f32_16x16x32_bf16 v[96:99], v[220:223], v[116:119], v[96:99]
    buffer_load_dwordx4 a[56:59], v4, s[40:43], s3 offen offset:1024 sc1
    v_mov_b32 v158, v156
    v_mov_b32 v159, v157
    v_mfma_f32_16x16x32_bf16 v[88:91], v[224:227], v[120:123], v[88:91]
    v_permlane16_swap_b32 v156, v158
    buffer_load_dwordx4 a[60:63], v4, s[40:43], s3 offen offset:2048 sc1
    v_permlane16_swap_b32 v157, v159
    v_mfma_f32_16x16x32_bf16 v[92:95], v[228:231], v[120:123], v[92:95]
    v_add_f32 v156, v156, v158
    buffer_load_dwordx4 a[64:67], v4, s[40:43], s3 offen offset:3072 sc1
    v_add_f32 v157, v157, v159
    v_mfma_f32_16x16x32_bf16 v[96:99], v[232:235], v[120:123], v[96:99]
    s_waitcnt lgkmcnt(0)
    v_mov_b32 v158, v156
    s_add_u32 s3, s19, 57344
    v_mfma_f32_16x16x32_bf16 v[88:91], v[236:239], v[124:127], v[88:91]
    v_mov_b32 v159, v157
    v_permlane32_swap_b32 v156, v158
    s_nop 0
    v_permlane32_swap_b32 v157, v159
    v_mfma_f32_16x16x32_bf16 v[92:95], v[240:243], v[124:127], v[92:95]
    buffer_load_dwordx4 a[68:71], v4, s[40:43], s3 offen offset:0 sc1
    v_add_f32 v156, v156, v158
    v_add_f32 v157, v157, v159
    v_mfma_f32_16x16x32_bf16 v[96:99], v[244:247], v[124:127], v[96:99]
    buffer_load_dwordx4 a[72:75], v4, s[40:43], s3 offen offset:1024 sc1
    v_mul_f32 v158, 0x3acccccd, v156
    v_mfma_f32_16x16x32_bf16 v[88:91], v[248:251], v[128:131], v[88:91]
    v_mul_f32 v159, 0x3acccccd, v157
    buffer_load_dwordx4 a[76:79], v4, s[40:43], s3 offen offset:2048 sc1
    v_fma_f32 v159, -v158, v158, v159
    v_mfma_f32_16x16x32_bf16 v[92:95], v[252:255], v[128:131], v[92:95]
    v_max_f32 v159, 0, v159
    v_add_f32 v159, 0x3727c5ac, v159
    buffer_load_dwordx4 a[80:83], v4, s[40:43], s3 offen offset:3072 sc1
    v_mfma_f32_16x16x32_bf16 v[96:99], a[0:3], v[128:131], v[96:99]
    v_rsq_f32 v159, v159
    s_lshl_b32 s39, s52, 15
    s_add_u32 s39, s39, s35
    s_add_u32 s8, s39, 0
    s_add_u32 s9, s39, 4096
    s_add_u32 s10, s39, 8192
    s_add_u32 s11, s39, 12288
    s_add_u32 s24, s39, 16384
    s_add_u32 s25, s39, 20480
    s_add_u32 s28, s39, 24576
    s_add_u32 s34, s39, 28672
    s_lshl_b32 s39, s30, 10
    v_add_u32 v8, s39, v4
    s_lshl_b32 s39, s31, 10
    v_add_u32 v9, s39, v4
    s_lshl_b32 s39, s32, 10
    v_add_u32 v18, s39, v4
    s_lshl_b32 s39, s33, 10
    v_add_u32 v19, s39, v4
    s_lshr_b32 s39, s30, 1
    s_lshl_b32 s39, s39, 10
    v_add_u32 v6, s39, v4
    s_lshr_b32 s39, s32, 1
    s_lshl_b32 s39, s39, 10
    v_add_u32 v12, s39, v4
    s_lshl_b32 s39, s52, 14
    s_add_u32 s39, s39, s23
    s_add_u32 s55, s39, 1048576
    s_add_u32 s56, s39, 1052672
    s_add_u32 s57, s39, 1056768
    s_add_u32 s58, s39, 1060864
    s_waitcnt vmcnt(13)
    v_sub_u32 v21, v21, v22
    v_subrev_u32 v21, 2, v21
    v_cmp_lt_u32 vcc, 1, v21
    s_cbranch_vccz L_SC2
    s_mov_b32 s59, 0
L_SL2:
    buffer_load_dword v21, v7, s[40:43], s13 offen sc1
    s_add_u32 s59, s59, 1
    s_cmp_gt_u32 s59, 0x100000
    s_waitcnt vmcnt(0)
    s_cbranch_scc1 L_SC2
    v_sub_u32 v21, v21, v22
    v_subrev_u32 v21, 2, v21
    v_cmp_lt_u32 vcc, 1, v21
    s_cbranch_vccnz L_SL2
L_SC2:
    v_pk_fma_f32 v[88:89], v[132:133], v[158:159], v[88:89] op_sel_hi:[1,0,1] neg_lo:[0,1,0] neg_hi:[0,1,0]
    v_pk_fma_f32 v[90:91], v[134:135], v[158:159], v[90:91] op_sel_hi:[1,0,1] neg_lo:[0,1,0] neg_hi:[0,1,0]
    v_pk_fma_f32 v[92:93], v[136:137], v[158:159], v[92:93] op_sel_hi:[1,0,1] neg_lo:[0,1,0] neg_hi:[0,1,0]
    v_pk_fma_f32 v[94:95], v[138:139], v[158:159], v[94:95] op_sel_hi:[1,0,1] neg_lo:[0,1,0] neg_hi:[0,1,0]
    v_pk_fma_f32 v[96:97], v[140:141], v[158:159], v[96:97] op_sel_hi:[1,0,1] neg_lo:[0,1,0] neg_hi:[0,1,0]
    v_pk_fma_f32 v[98:99], v[142:143], v[158:159], v[98:99] op_sel_hi:[1,0,1] neg_lo:[0,1,0] neg_hi:[0,1,0]
    s_add_u32 s3, s19, 36864
    v_pk_mul_f32 v[88:89], v[88:89], v[158:159] op_sel:[0,1] op_sel_hi:[1,1]
    v_pk_mul_f32 v[90:91], v[90:91], v[158:159] op_sel:[0,1] op_sel_hi:[1,1]
    v_pk_mul_f32 v[92:93], v[92:93], v[158:159] op_sel:[0,1] op_sel_hi:[1,1]
    v_pk_mul_f32 v[94:95], v[94:95], v[158:159] op_sel:[0,1] op_sel_hi:[1,1]
    v_pk_mul_f32 v[96:97], v[96:97], v[158:159] op_sel:[0,1] op_sel_hi:[1,1]
    v_pk_mul_f32 v[98:99], v[98:99], v[158:159] op_sel:[0,1] op_sel_hi:[1,1]
    buffer_load_dwordx4 a[0:3], v4, s[40:43], s3 offen offset:3072 sc1
    v_pk_mul_f32 v[160:161], v[88:89], v[88:89]
    v_pk_mul_f32 v[162:163], v[90:91], v[90:91]
    v_pk_mul_f32 v[164:165], v[92:93], v[92:93]
    v_pk_mul_f32 v[166:167], v[94:95], v[94:95]
    v_pk_mul_f32 v[168:169], v[96:97], v[96:97]
    v_pk_mul_f32 v[170:171], v[98:99], v[98:99]
    buffer_load_dwordx4 v[196:199], v8, s[40:43], s8 offen sc1
    v_pk_fma_f32 v[160:161], v[160:161], v[74:75], v[74:75] op_sel:[0,1,0] op_sel_hi:[1,1,0]
    v_pk_fma_f32 v[162:163], v[162:163], v[74:75], v[74:75] op_sel:[0,1,0] op_sel_hi:[1,1,0]
    v_pk_fma_f32 v[164:165], v[164:165], v[74:75], v[74:75] op_sel:[0,1,0] op_sel_hi:[1,1,0]
    v_pk_fma_f32 v[166:167], v[166:167], v[74:75], v[74:75] op_sel:[0,1,0] op_sel_hi:[1,1,0]
    v_pk_fma_f32 v[168:169], v[168:169], v[74:75], v[74:75] op_sel:[0,1,0] op_sel_hi:[1,1,0]
    v_pk_fma_f32 v[170:171], v[170:171], v[74:75], v[74:75] op_sel:[0,1,0] op_sel_hi:[1,1,0]
    buffer_load_dwordx4 v[200:203], v8, s[40:43], s9 offen sc1
    v_pk_mul_f32 v[160:161], v[160:161], v[88:89]
    v_pk_mul_f32 v[162:163], v[162:163], v[90:91]
    v_pk_mul_f32 v[164:165], v[164:165], v[92:93]
    v_pk_mul_f32 v[166:167], v[166:167], v[94:95]
    v_pk_mul_f32 v[168:169], v[168:169], v[96:97]
    v_pk_mul_f32 v[170:171], v[170:171], v[98:99]
    buffer_load_dwordx4 v[204:207], v8, s[40:43], s10 offen sc1
    v_exp_f32 v160, v160
    v_exp_f32 v161, v161
    v_exp_f32 v162, v162
    v_exp_f32 v163, v163
    v_exp_f32 v164, v164
    v_exp_f32 v165, v165
    buffer_load_dwordx4 v[208:211], v8, s[40:43], s11 offen sc1
    v_exp_f32 v166, v166
    v_exp_f32 v167, v167
    v_exp_f32 v168, v168
    v_exp_f32 v169, v169
    v_exp_f32 v170, v170
    v_exp_f32 v171, v171
    buffer_load_dwordx4 v[212:215], v8, s[40:43], s24 offen sc1
    v_pk_add_f32 v[160:161], v[160:161], 1.0 op_sel_hi:[1,0]
    v_pk_add_f32 v[162:163], v[162:163], 1.0 op_sel_hi:[1,0]
    v_pk_add_f32 v[164:165], v[164:165], 1.0 op_sel_hi:[1,0]
    v_pk_add_f32 v[166:167], v[166:167], 1.0 op_sel_hi:[1,0]
    v_pk_add_f32 v[168:169], v[168:169], 1.0 op_sel_hi:[1,0]
    v_pk_add_f32 v[170:171], v[170:171], 1.0 op_sel_hi:[1,0]
    buffer_load_dwordx4 v[216:219], v8, s[40:43], s25 offen sc1
    v_rcp_f32 v160, v160
    v_rcp_f32 v161, v161
    v_rcp_f32 v162, v162
    v_rcp_f32 v163, v163
    v_rcp_f32 v164, v164
    v_rcp_f32 v165, v165
    buffer_load_dwordx4 v[220:223], v8, s[40:43], s28 offen sc1
    v_rcp_f32 v166, v166
    v_rcp_f32 v167, v167
    v_rcp_f32 v168, v168
    v_rcp_f32 v169, v169
    v_rcp_f32 v170, v170
    v_rcp_f32 v171, v171
    buffer_load_dwordx4 v[44:47], v8, s[40:43], s34 offen sc1
    v_pk_mul_f32 v[88:89], v[88:89], v[160:161]
    v_pk_mul_f32 v[90:91], v[90:91], v[162:163]
    v_pk_mul_f32 v[92:93], v[92:93], v[164:165]
    v_pk_mul_f32 v[94:95], v[94:95], v[166:167]
    v_pk_mul_f32 v[96:97], v[96:97], v[168:169]
    v_pk_mul_f32 v[98:99], v[98:99], v[170:171]
    buffer_load_dwordx4 v[224:227], v6, s[40:43], s55 offen offset:0 sc1
    v_cvt_pk_bf16_f32 v176, v88, v89
    v_cvt_pk_bf16_f32 v177, v90, v91
    v_cvt_pk_bf16_f32 v178, v92, v93
    v_cvt_pk_bf16_f32 v179, v94, v95
    s_add_u32 s60, s7, s14
    s_bitcmp1_b32 s36, 0
    s_cbranch_scc1 L_DF13
    buffer_store_dwordx4 v[176:179], v4, s[40:43], s60 offen sc1
    s_branch L_DE13
L_DF13:
    buffer_store_dwordx4 v[176:179], v4, s[40:43], s60 offen
L_DE13:
    v_cvt_pk_bf16_f32 v186, v96, v97
    v_cvt_pk_bf16_f32 v187, v98, v99
    s_lshr_b32 s60, s7, 11
    s_lshl_b32 s60, s60, 10
    s_add_u32 s60, s60, s15
    s_bitcmp1_b32 s36, 0
    s_cbranch_scc1 L_DF14
    buffer_store_dwordx4 v[184:187], v4, s[40:43], s60 offen sc1
    s_branch L_DE14
L_DF14:
    buffer_store_dwordx4 v[184:187], v4, s[40:43], s60 offen
L_DE14:
    v_add_u32 v17, s22, v4
    ds_read_b128 a[200:203], v17 offset:0
    ds_read_b128 a[204:207], v17 offset:1024
    ds_read_b128 a[208:211], v17 offset:2048
    buffer_load_dwordx4 v[228:231], v6, s[40:43], s55 offen offset:2048 sc1
    ds_read_b128 a[212:215], v17 offset:3072
    ds_read_b128 a[216:219], v17 offset:4096
    ds_read_b128 a[220:223], v17 offset:5120
    buffer_load_dwordx4 v[232:235], v6, s[40:43], s56 offen offset:0 sc1
    ds_read_b128 a[224:227], v17 offset:6144
    ds_read_b128 a[228:231], v17 offset:7168
    ds_read_b128 a[232:235], v17 offset:8192
    buffer_load_dwordx4 v[236:239], v6, s[40:43], s56 offen offset:2048 sc1
    ds_read_b128 a[236:239], v17 offset:9216
    ds_read_b128 a[240:243], v17 offset:10240
    ds_read_b128 a[244:247], v17 offset:11264
    buffer_load_dwordx4 v[240:243], v6, s[40:43], s57 offen offset:0 sc1
    ds_read_b128 a[248:251], v17 offset:12288
    ds_read_b128 a[252:255], v17 offset:13312
    ds_read_b128 a[100:103], v17 offset:14336
    buffer_load_dwordx4 v[244:247], v6, s[40:43], s57 offen offset:2048 sc1
    s_waitcnt lgkmcnt(14)
    ds_read_b128 a[104:107], v17 offset:15360
    s_waitcnt lgkmcnt(14)
    ds_read_b128 a[108:111], v17 offset:16384
    s_waitcnt lgkmcnt(14)
    ds_read_b128 a[112:115], v17 offset:17408
    buffer_load_dwordx4 v[248:251], v6, s[40:43], s58 offen offset:0 sc1
    s_waitcnt lgkmcnt(14)
    ds_read_b128 a[116:119], v17 offset:18432
    s_waitcnt lgkmcnt(14)
    ds_read_b128 a[120:123], v17 offset:19456
    buffer_load_dwordx4 v[252:255], v6, s[40:43], s58 offen offset:2048 sc1
    v_mul_u32_u24 v17, 1280, v20
    v_lshl_add_u32 v17, v3, 3, v17
    s_mul_i32 s29, s54, 160
    s_waitcnt lgkmcnt(0)
    s_barrier
    v_add_u32 v11, 3, v22
    s_waitcnt vmcnt(7)
    s_bitcmp1_b32 s36, 0
    s_cbranch_scc1 L_DF15
    buffer_store_dword v11, v10, s[40:43], s27 offen sc1
    s_branch L_DE15
L_DF15:
    buffer_store_dword v11, v10, s[40:43], s27 offen
L_DE15:
    v_mfma_f32_16x16x32_bf16 v[76:79], a[124:127], v[196:199], 0
    buffer_load_dwordx4 v[116:119], v9, s[40:43], s8 offen sc1
    v_mfma_f32_16x16x32_bf16 v[80:83], a[128:131], v[196:199], 0
    v_mfma_f32_16x16x32_bf16 v[84:87], a[132:135], v[196:199], 0
    v_mfma_f32_16x16x32_bf16 v[88:91], a[136:139], v[196:199], 0
    v_mfma_f32_16x16x32_bf16 v[92:95], a[140:143], v[196:199], 0
    v_mfma_f32_16x16x32_bf16 v[76:79], a[144:147], v[200:203], v[76:79]
    buffer_load_dwordx4 v[120:123], v9, s[40:43], s9 offen sc1
    v_mfma_f32_16x16x32_bf16 v[80:83], a[148:151], v[200:203], v[80:83]
    v_mfma_f32_16x16x32_bf16 v[84:87], a[152:155], v[200:203], v[84:87]
    v_mfma_f32_16x16x32_bf16 v[88:91], a[156:159], v[200:203], v[88:91]
    v_mfma_f32_16x16x32_bf16 v[92:95], a[160:163], v[200:203], v[92:95]
    v_mfma_f32_16x16x32_bf16 v[76:79], a[164:167], v[204:207], v[76:79]
    buffer_load_dwordx4 v[124:127], v9, s[40:43], s10 offen sc1
    v_mfma_f32_16x16x32_bf16 v[80:83], a[168:171], v[204:207], v[80:83]
    v_mfma_f32_16x16x32_bf16 v[84:87], a[172:175], v[204:207], v[84:87]
    v_mfma_f32_16x16x32_bf16 v[88:91], a[176:179], v[204:207], v[88:91]
    v_mfma_f32_16x16x32_bf16 v[92:95], a[180:183], v[204:207], v[92:95]
    v_mfma_f32_16x16x32_bf16 v[76:79], a[184:187], v[208:211], v[76:79]
    buffer_load_dwordx4 v[128:131], v9, s[40:43], s11 offen sc1
    v_mfma_f32_16x16x32_bf16 v[80:83], a[188:191], v[208:211], v[80:83]
    v_mfma_f32_16x16x32_bf16 v[84:87], a[192:195], v[208:211], v[84:87]
    v_mfma_f32_16x16x32_bf16 v[88:91], a[196:199], v[208:211], v[88:91]
    buffer_load_dwordx4 v[132:135], v9, s[40:43], s24 offen sc1
    v_mfma_f32_16x16x32_bf16 v[92:95], a[200:203], v[208:211], v[92:95]
    v_mfma_f32_16x16x32_bf16 v[76:79], a[244:247], v[212:215], v[76:79]
    buffer_load_dwordx4 v[136:139], v9, s[40:43], s25 offen sc1
    v_mfma_f32_16x16x32_bf16 v[80:83], a[248:251], v[212:215], v[80:83]
    v_mfma_f32_16x16x32_bf16 v[84:87], a[252:255], v[212:215], v[84:87]
    v_mfma_f32_16x16x32_bf16 v[88:91], a[100:103], v[212:215], v[88:91]
    v_mfma_f32_16x16x32_bf16 v[92:95], a[104:107], v[212:215], v[92:95]
    buffer_load_dword v21, v7, s[40:43], s13 offen sc1
    v_mfma_f32_16x16x32_bf16 v[76:79], a[108:111], v[216:219], v[76:79]
    buffer_load_dwordx4 v[140:143], v9, s[40:43], s28 offen sc1
    v_mfma_f32_16x16x32_bf16 v[80:83], a[112:115], v[216:219], v[80:83]
    v_mfma_f32_16x16x32_bf16 v[84:87], a[116:119], v[216:219], v[84:87]
    v_mfma_f32_16x16x32_bf16 v[88:91], a[120:123], v[216:219], v[88:91]
    v_mfma_f32_16x16x32_bf16 v[92:95], a[0:3], v[216:219], v[92:95]
    v_mfma_f32_16x16x32_bf16 v[76:79], a[4:7], v[220:223], v[76:79]
    buffer_load_dwordx4 v[144:147], v9, s[40:43], s34 offen sc1
    v_mfma_f32_16x16x32_bf16 v[80:83], a[8:11], v[220:223], v[80:83]
    v_mfma_f32_16x16x32_bf16 v[84:87], a[12:15], v[220:223], v[84:87]
    v_mfma_f32_16x16x32_bf16 v[88:91], a[16:19], v[220:223], v[88:91]
    v_mfma_f32_16x16x32_bf16 v[92:95], a[20:23], v[220:223], v[92:95]
    v_mfma_f32_16x16x32_bf16 v[76:79], a[24:27], v[44:47], v[76:79]
    v_mfma_f32_16x16x32_bf16 v[80:83], a[28:31], v[44:47], v[80:83]
    s_waitcnt vmcnt(16)
    v_swap_b32 v226, v228
    v_swap_b32 v227, v229
    v_mfma_f32_16x16x32_bf16 v[84:87], a[32:35], v[44:47], v[84:87]
    v_mfma_f32_16x16x32_bf16 v[88:91], a[36:39], v[44:47], v[88:91]
    v_mfma_f32_16x16x32_bf16 v[92:95], a[40:43], v[44:47], v[92:95]
    v_mfma_f32_16x16x32_bf16 v[76:79], a[204:207], v[224:227], v[76:79]
    v_mfma_f32_16x16x32_bf16 v[80:83], a[208:211], v[224:227], v[80:83]
    s_waitcnt vmcnt(14)
    v_swap_b32 v234, v236
    v_swap_b32 v235, v237
    v_mfma_f32_16x16x32_bf16 v[84:87], a[212:215], v[224:227], v[84:87]
    v_mfma_f32_16x16x32_bf16 v[88:91], a[216:219], v[224:227], v[88:91]
    v_mfma_f32_16x16x32_bf16 v[92:95], a[220:223], v[224:227], v[92:95]
    v_mfma_f32_16x16x32_bf16 v[76:79], a[224:227], v[232:235], v[76:79]
    v_mfma_f32_16x16x32_bf16 v[80:83], a[228:231], v[232:235], v[80:83]
    s_waitcnt vmcnt(12)
    v_swap_b32 v242, v244
    v_swap_b32 v243, v245
    v_mfma_f32_16x16x32_bf16 v[84:87], a[232:235], v[232:235], v[84:87]
    v_mfma_f32_16x16x32_bf16 v[88:91], a[236:239], v[232:235], v[88:91]
    v_mfma_f32_16x16x32_bf16 v[92:95], a[240:243], v[232:235], v[92:95]
    s_waitcnt vmcnt(2)
    v_sub_u32 v21, v21, v22
    v_subrev_u32 v21, 3, v21
    v_cmp_lt_u32 vcc, 0, v21
    s_cbranch_vccz L_SC3
    s_mov_b32 s59, 0
L_SL3:
    buffer_load_dword v21, v7, s[40:43], s13 offen sc1
    s_add_u32 s59, s59, 1
    s_cmp_gt_u32 s59, 0x100000
    s_waitcnt vmcnt(0)
    s_cbranch_scc1 L_SC3
    v_sub_u32 v21, v21, v22
    v_subrev_u32 v21, 3, v21
    v_cmp_lt_u32 vcc, 0, v21
    s_cbranch_vccnz L_SL3
L_SC3:
    v_mfma_f32_16x16x32_bf16 v[76:79], a[44:47], v[240:243], v[76:79]
    buffer_load_dwordx4 v[180:183], v18, s[40:43], s8 offen sc1
    v_mfma_f32_16x16x32_bf16 v[80:83], a[48:51], v[240:243], v[80:83]
    v_swap_b32 v250, v252
    v_swap_b32 v251, v253
    v_mfma_f32_16x16x32_bf16 v[84:87], a[52:55], v[240:243], v[84:87]
    v_mfma_f32_16x16x32_bf16 v[88:91], a[56:59], v[240:243], v[88:91]
    v_mfma_f32_16x16x32_bf16 v[92:95], a[60:63], v[240:243], v[92:95]
    v_mfma_f32_16x16x32_bf16 v[76:79], a[64:67], v[248:251], v[76:79]
    buffer_load_dwordx4 v[184:187], v18, s[40:43], s9 offen sc1
    v_mfma_f32_16x16x32_bf16 v[80:83], a[68:71], v[248:251], v[80:83]
    v_mfma_f32_16x16x32_bf16 v[84:87], a[72:75], v[248:251], v[84:87]
    v_mfma_f32_16x16x32_bf16 v[88:91], a[76:79], v[248:251], v[88:91]
    buffer_load_dwordx4 v[188:191], v18, s[40:43], s10 offen sc1
    v_mfma_f32_16x16x32_bf16 v[92:95], a[80:83], v[248:251], v[92:95]
    v_mfma_f32_16x16x32_bf16 v[96:99], a[124:127], v[116:119], 0
    buffer_load_dwordx4 v[192:195], v18, s[40:43], s11 offen sc1
    v_mfma_f32_16x16x32_bf16 v[100:103], a[128:131], v[116:119], 0
    v_mfma_f32_16x16x32_bf16 v[104:107], a[132:135], v[116:119], 0
    v_mfma_f32_16x16x32_bf16 v[108:111], a[136:139], v[116:119], 0
    v_mfma_f32_16x16x32_bf16 v[112:115], a[140:143], v[116:119], 0
    v_mfma_f32_16x16x32_bf16 v[96:99], a[144:147], v[120:123], v[96:99]
    buffer_load_dwordx4 a[84:87], v18, s[40:43], s24 offen sc1
    v_mfma_f32_16x16x32_bf16 v[100:103], a[148:151], v[120:123], v[100:103]
    v_mfma_f32_16x16x32_bf16 v[104:107], a[152:155], v[120:123], v[104:107]
    ds_write_b128 v13, v[76:79] offset:0
    v_mfma_f32_16x16x32_bf16 v[108:111], a[156:159], v[120:123], v[108:111]
    v_mfma_f32_16x16x32_bf16 v[112:115], a[160:163], v[120:123], v[112:115]
    v_mfma_f32_16x16x32_bf16 v[96:99], a[164:167], v[124:127], v[96:99]
    buffer_load_dwordx4 a[88:91], v18, s[40:43], s25 offen sc1
    v_mfma_f32_16x16x32_bf16 v[100:103], a[168:171], v[124:127], v[100:103]
    v_mfma_f32_16x16x32_bf16 v[104:107], a[172:175], v[124:127], v[104:107]
    ds_write_b128 v13, v[80:83] offset:1024
    v_mfma_f32_16x16x32_bf16 v[108:111], a[176:179], v[124:127], v[108:111]
    v_mfma_f32_16x16x32_bf16 v[112:115], a[180:183], v[124:127], v[112:115]
    v_mfma_f32_16x16x32_bf16 v[96:99], a[184:187], v[128:131], v[96:99]
    buffer_load_dwordx4 a[92:95], v18, s[40:43], s28 offen sc1
    v_mfma_f32_16x16x32_bf16 v[100:103], a[188:191], v[128:131], v[100:103]
    v_mfma_f32_16x16x32_bf16 v[104:107], a[192:195], v[128:131], v[104:107]
    ds_write_b128 v13, v[84:87] offset:2048
    v_mfma_f32_16x16x32_bf16 v[108:111], a[196:199], v[128:131], v[108:111]
    buffer_load_dwordx4 a[96:99], v18, s[40:43], s34 offen sc1
    v_mfma_f32_16x16x32_bf16 v[112:115], a[200:203], v[128:131], v[112:115]
    v_mfma_f32_16x16x32_bf16 v[96:99], a[244:247], v[132:135], v[96:99]
    buffer_load_dwordx4 v[148:151], v12, s[40:43], s55 offen offset:0 sc1
    v_mfma_f32_16x16x32_bf16 v[100:103], a[248:251], v[132:135], v[100:103]
    v_mfma_f32_16x16x32_bf16 v[104:107], a[252:255], v[132:135], v[104:107]
    ds_write_b128 v13, v[88:91] offset:3072
    v_mfma_f32_16x16x32_bf16 v[108:111], a[100:103], v[132:135], v[108:111]
    v_mfma_f32_16x16x32_bf16 v[112:115], a[104:107], v[132:135], v[112:115]
    v_mfma_f32_16x16x32_bf16 v[96:99], a[108:111], v[136:139], v[96:99]
    buffer_load_dwordx4 v[152:155], v12, s[40:43], s55 offen offset:2048 sc1
    v_mfma_f32_16x16x32_bf16 v[100:103], a[112:115], v[136:139], v[100:103]
    v_mfma_f32_16x16x32_bf16 v[104:107], a[116:119], v[136:139], v[104:107]
    ds_write_b128 v13, v[92:95] offset:4096
    v_mfma_f32_16x16x32_bf16 v[108:111], a[120:123], v[136:139], v[108:111]
    v_mfma_f32_16x16x32_bf16 v[112:115], a[0:3], v[136:139], v[112:115]
    s_waitcnt vmcnt(11)
    v_mfma_f32_16x16x32_bf16 v[96:99], a[4:7], v[140:143], v[96:99]
    buffer_load_dwordx4 v[156:159], v12, s[40:43], s56 offen offset:0 sc1
    v_mfma_f32_16x16x32_bf16 v[100:103], a[8:11], v[140:143], v[100:103]
    v_mfma_f32_16x16x32_bf16 v[104:107], a[12:15], v[140:143], v[104:107]
    v_mfma_f32_16x16x32_bf16 v[108:111], a[16:19], v[140:143], v[108:111]
    v_mfma_f32_16x16x32_bf16 v[112:115], a[20:23], v[140:143], v[112:115]
    s_waitcnt vmcnt(11)
    v_mfma_f32_16x16x32_bf16 v[96:99], a[24:27], v[144:147], v[96:99]
    buffer_load_dwordx4 v[160:163], v12, s[40:43], s56 offen offset:2048 sc1
    v_mfma_f32_16x16x32_bf16 v[100:103], a[28:31], v[144:147], v[100:103]
    v_mfma_f32_16x16x32_bf16 v[104:107], a[32:35], v[144:147], v[104:107]
    v_mfma_f32_16x16x32_bf16 v[108:111], a[36:39], v[144:147], v[108:111]
    buffer_load_dwordx4 v[164:167], v12, s[40:43], s57 offen offset:0 sc1
    v_mfma_f32_16x16x32_bf16 v[112:115], a[40:43], v[144:147], v[112:115]
    v_mfma_f32_16x16x32_bf16 v[96:99], a[204:207], v[228:231], v[96:99]
    buffer_load_dwordx4 v[168:171], v12, s[40:43], s57 offen offset:2048 sc1
    v_mfma_f32_16x16x32_bf16 v[100:103], a[208:211], v[228:231], v[100:103]
    v_mfma_f32_16x16x32_bf16 v[104:107], a[212:215], v[228:231], v[104:107]
    v_mfma_f32_16x16x32_bf16 v[108:111], a[216:219], v[228:231], v[108:111]
    v_mfma_f32_16x16x32_bf16 v[112:115], a[220:223], v[228:231], v[112:115]
    v_mfma_f32_16x16x32_bf16 v[96:99], a[224:227], v[236:239], v[96:99]
    buffer_load_dwordx4 v[172:175], v12, s[40:43], s58 offen offset:0 sc1
    v_mfma_f32_16x16x32_bf16 v[100:103], a[228:231], v[236:239], v[100:103]
    v_mfma_f32_16x16x32_bf16 v[104:107], a[232:235], v[236:239], v[104:107]
    v_mfma_f32_16x16x32_bf16 v[108:111], a[236:239], v[236:239], v[108:111]
    v_mfma_f32_16x16x32_bf16 v[112:115], a[240:243], v[236:239], v[112:115]
    v_mfma_f32_16x16x32_bf16 v[96:99], a[44:47], v[244:247], v[96:99]
    buffer_load_dwordx4 v[176:179], v12, s[40:43], s58 offen offset:2048 sc1
    v_mfma_f32_16x16x32_bf16 v[100:103], a[48:51], v[244:247], v[100:103]
    v_mfma_f32_16x16x32_bf16 v[104:107], a[52:55], v[244:247], v[104:107]
    v_mfma_f32_16x16x32_bf16 v[108:111], a[56:59], v[244:247], v[108:111]
    v_mfma_f32_16x16x32_bf16 v[112:115], a[60:63], v[244:247], v[112:115]
    v_mfma_f32_16x16x32_bf16 v[96:99], a[64:67], v[252:255], v[96:99]
    buffer_load_dwordx4 v[196:199], v19, s[40:43], s8 offen sc1
    v_mfma_f32_16x16x32_bf16 v[100:103], a[68:71], v[252:255], v[100:103]
    v_mfma_f32_16x16x32_bf16 v[104:107], a[72:75], v[252:255], v[104:107]
    v_mfma_f32_16x16x32_bf16 v[108:111], a[76:79], v[252:255], v[108:111]
    buffer_load_dwordx4 v[200:203], v19, s[40:43], s9 offen sc1
    v_mfma_f32_16x16x32_bf16 v[112:115], a[80:83], v[252:255], v[112:115]
    s_waitcnt vmcnt(17)
    v_mfma_f32_16x16x32_bf16 v[76:79], a[124:127], v[180:183], 0
    buffer_load_dwordx4 v[204:207], v19, s[40:43], s10 offen sc1
    v_mfma_f32_16x16x32_bf16 v[80:83], a[128:131], v[180:183], 0
    v_mfma_f32_16x16x32_bf16 v[84:87], a[132:135], v[180:183], 0
    v_mfma_f32_16x16x32_bf16 v[88:91], a[136:139], v[180:183], 0
    v_mfma_f32_16x16x32_bf16 v[92:95], a[140:143], v[180:183], 0
    s_waitcnt vmcnt(17)
    v_mfma_f32_16x16x32_bf16 v[76:79], a[144:147], v[184:187], v[76:79]
    buffer_load_dwordx4 v[208:211], v19, s[40:43], s11 offen sc1
    v_mfma_f32_16x16x32_bf16 v[80:83], a[148:151], v[184:187], v[80:83]
    v_mfma_f32_16x16x32_bf16 v[84:87], a[152:155], v[184:187], v[84:87]
    ds_write_b128 v14, v[96:99] offset:0
    v_mfma_f32_16x16x32_bf16 v[88:91], a[156:159], v[184:187], v[88:91]
    v_mfma_f32_16x16x32_bf16 v[92:95], a[160:163], v[184:187], v[92:95]
    s_waitcnt vmcnt(17)
    v_mfma_f32_16x16x32_bf16 v[76:79], a[164:167], v[188:191], v[76:79]
    buffer_load_dwordx4 v[212:215], v19, s[40:43], s24 offen sc1
    v_mfma_f32_16x16x32_bf16 v[80:83], a[168:171], v[188:191], v[80:83]
    v_mfma_f32_16x16x32_bf16 v[84:87], a[172:175], v[188:191], v[84:87]
    ds_write_b128 v14, v[100:103] offset:1024
    v_mfma_f32_16x16x32_bf16 v[88:91], a[176:179], v[188:191], v[88:91]
    v_mfma_f32_16x16x32_bf16 v[92:95], a[180:183], v[188:191], v[92:95]
    s_waitcnt vmcnt(17)
    v_mfma_f32_16x16x32_bf16 v[76:79], a[184:187], v[192:195], v[76:79]
    buffer_load_dwordx4 v[216:219], v19, s[40:43], s25 offen sc1
    v_mfma_f32_16x16x32_bf16 v[80:83], a[188:191], v[192:195], v[80:83]
    v_mfma_f32_16x16x32_bf16 v[84:87], a[192:195], v[192:195], v[84:87]
    ds_write_b128 v14, v[104:107] offset:2048
    v_mfma_f32_16x16x32_bf16 v[88:91], a[196:199], v[192:195], v[88:91]
    buffer_load_dwordx4 v[220:223], v19, s[40:43], s28 offen sc1
    v_mfma_f32_16x16x32_bf16 v[92:95], a[200:203], v[192:195], v[92:95]
    s_waitcnt vmcnt(18)
    v_mfma_f32_16x16x32_bf16 v[76:79], a[244:247], a[84:87], v[76:79]
    buffer_load_dwordx4 v[44:47], v19, s[40:43], s34 offen sc1
    v_mfma_f32_16x16x32_bf16 v[80:83], a[248:251], a[84:87], v[80:83]
    v_mfma_f32_16x16x32_bf16 v[84:87], a[252:255], a[84:87], v[84:87]
    ds_write_b128 v14, v[108:111] offset:3072
    v_mfma_f32_16x16x32_bf16 v[88:91], a[100:103], a[84:87], v[88:91]
    v_mfma_f32_16x16x32_bf16 v[92:95], a[104:107], a[84:87], v[92:95]
    s_waitcnt vmcnt(18)
    v_mfma_f32_16x16x32_bf16 v[76:79], a[108:111], a[88:91], v[76:79]
    v_mfma_f32_16x16x32_bf16 v[80:83], a[112:115], a[88:91], v[80:83]
    v_mfma_f32_16x16x32_bf16 v[84:87], a[116:119], a[88:91], v[84:87]
    ds_write_b128 v14, v[112:115] offset:4096
    v_mfma_f32_16x16x32_bf16 v[88:91], a[120:123], a[88:91], v[88:91]
    v_mfma_f32_16x16x32_bf16 v[92:95], a[0:3], a[88:91], v[92:95]
    s_waitcnt vmcnt(17)
    v_mfma_f32_16x16x32_bf16 v[76:79], a[4:7], a[92:95], v[76:79]
    v_mfma_f32_16x16x32_bf16 v[80:83], a[8:11], a[92:95], v[80:83]
    v_mfma_f32_16x16x32_bf16 v[84:87], a[12:15], a[92:95], v[84:87]
    v_mfma_f32_16x16x32_bf16 v[88:91], a[16:19], a[92:95], v[88:91]
    v_mfma_f32_16x16x32_bf16 v[92:95], a[20:23], a[92:95], v[92:95]
    s_waitcnt vmcnt(16)
    v_mfma_f32_16x16x32_bf16 v[76:79], a[24:27], a[96:99], v[76:79]
    v_mfma_f32_16x16x32_bf16 v[80:83], a[28:31], a[96:99], v[80:83]
    s_waitcnt vmcnt(14)
    v_swap_b32 v150, v152
    v_swap_b32 v151, v153
    v_mfma_f32_16x16x32_bf16 v[84:87], a[32:35], a[96:99], v[84:87]
    v_mfma_f32_16x16x32_bf16 v[88:91], a[36:39], a[96:99], v[88:91]
    v_mfma_f32_16x16x32_bf16 v[92:95], a[40:43], a[96:99], v[92:95]
    v_mfma_f32_16x16x32_bf16 v[76:79], a[204:207], v[148:151], v[76:79]
    v_mfma_f32_16x16x32_bf16 v[80:83], a[208:211], v[148:151], v[80:83]
    s_waitcnt vmcnt(12)
    v_swap_b32 v158, v160
    v_swap_b32 v159, v161
    v_mfma_f32_16x16x32_bf16 v[84:87], a[212:215], v[148:151], v[84:87]
    v_mfma_f32_16x16x32_bf16 v[88:91], a[216:219], v[148:151], v[88:91]
    v_mfma_f32_16x16x32_bf16 v[92:95], a[220:223], v[148:151], v[92:95]
    v_mfma_f32_16x16x32_bf16 v[76:79], a[224:227], v[156:159], v[76:79]
    v_mfma_f32_16x16x32_bf16 v[80:83], a[228:231], v[156:159], v[80:83]
    s_waitcnt vmcnt(10)
    v_swap_b32 v166, v168
    v_swap_b32 v167, v169
    v_mfma_f32_16x16x32_bf16 v[84:87], a[232:235], v[156:159], v[84:87]
    v_mfma_f32_16x16x32_bf16 v[88:91], a[236:239], v[156:159], v[88:91]
    v_mfma_f32_16x16x32_bf16 v[92:95], a[240:243], v[156:159], v[92:95]
    v_mfma_f32_16x16x32_bf16 v[76:79], a[44:47], v[164:167], v[76:79]
    v_mfma_f32_16x16x32_bf16 v[80:83], a[48:51], v[164:167], v[80:83]
    s_waitcnt vmcnt(8)
    v_swap_b32 v174, v176
    v_swap_b32 v175, v177
    v_mfma_f32_16x16x32_bf16 v[84:87], a[52:55], v[164:167], v[84:87]
    v_mfma_f32_16x16x32_bf16 v[88:91], a[56:59], v[164:167], v[88:91]
    v_mfma_f32_16x16x32_bf16 v[92:95], a[60:63], v[164:167], v[92:95]
    v_mfma_f32_16x16x32_bf16 v[76:79], a[64:67], v[172:175], v[76:79]
    v_mfma_f32_16x16x32_bf16 v[80:83], a[68:71], v[172:175], v[80:83]
    v_mfma_f32_16x16x32_bf16 v[84:87], a[72:75], v[172:175], v[84:87]
    v_mfma_f32_16x16x32_bf16 v[88:91], a[76:79], v[172:175], v[88:91]
    v_mfma_f32_16x16x32_bf16 v[92:95], a[80:83], v[172:175], v[92:95]
    s_lshr_b32 s39, s2, 3
    s_add_u32 s39, s39, s52
    s_cmp_lg_u32 s39, 0
    s_cbranch_scc1 L_NWB
    buffer_wbl2 sc1
L_NWB:
    s_waitcnt vmcnt(7)
    v_mfma_f32_16x16x32_bf16 v[96:99], a[124:127], v[196:199], 0
    v_mfma_f32_16x16x32_bf16 v[100:103], a[128:131], v[196:199], 0
    v_mfma_f32_16x16x32_bf16 v[104:107], a[132:135], v[196:199], 0
    v_mfma_f32_16x16x32_bf16 v[108:111], a[136:139], v[196:199], 0
    v_mfma_f32_16x16x32_bf16 v[112:115], a[140:143], v[196:199], 0
    s_waitcnt vmcnt(6)
    v_mfma_f32_16x16x32_bf16 v[96:99], a[144:147], v[200:203], v[96:99]
    v_mfma_f32_16x16x32_bf16 v[100:103], a[148:151], v[200:203], v[100:103]
    v_mfma_f32_16x16x32_bf16 v[104:107], a[152:155], v[200:203], v[104:107]
    ds_write_b128 v15, v[76:79] offset:0
    v_mfma_f32_16x16x32_bf16 v[108:111], a[156:159], v[200:203], v[108:111]
    v_mfma_f32_16x16x32_bf16 v[112:115], a[160:163], v[200:203], v[112:115]
    s_waitcnt vmcnt(5)
    v_mfma_f32_16x16x32_bf16 v[96:99], a[164:167], v[204:207], v[96:99]
    v_mfma_f32_16x16x32_bf16 v[100:103], a[168:171], v[204:207], v[100:103]
    v_mfma_f32_16x16x32_bf16 v[104:107], a[172:175], v[204:207], v[104:107]
    ds_write_b128 v15, v[80:83] offset:1024
    v_mfma_f32_16x16x32_bf16 v[108:111], a[176:179], v[204:207], v[108:111]
    v_mfma_f32_16x16x32_bf16 v[112:115], a[180:183], v[204:207], v[112:115]
    s_waitcnt vmcnt(4)
    v_mfma_f32_16x16x32_bf16 v[96:99], a[184:187], v[208:211], v[96:99]
    v_mfma_f32_16x16x32_bf16 v[100:103], a[188:191], v[208:211], v[100:103]
    v_mfma_f32_16x16x32_bf16 v[104:107], a[192:195], v[208:211], v[104:107]
    ds_write_b128 v15, v[84:87] offset:2048
    v_mfma_f32_16x16x32_bf16 v[108:111], a[196:199], v[208:211], v[108:111]
    v_mfma_f32_16x16x32_bf16 v[112:115], a[200:203], v[208:211], v[112:115]
    s_waitcnt vmcnt(3)
    v_mfma_f32_16x16x32_bf16 v[96:99], a[244:247], v[212:215], v[96:99]
    v_mfma_f32_16x16x32_bf16 v[100:103], a[248:251], v[212:215], v[100:103]
    v_mfma_f32_16x16x32_bf16 v[104:107], a[252:255], v[212:215], v[104:107]
    ds_write_b128 v15, v[88:91] offset:3072
    v_mfma_f32_16x16x32_bf16 v[108:111], a[100:103], v[212:215], v[108:111]
    v_mfma_f32_16x16x32_bf16 v[112:115], a[104:107], v[212:215], v[112:115]
    s_waitcnt vmcnt(2)
    v_mfma_f32_16x16x32_bf16 v[96:99], a[108:111], v[216:219], v[96:99]
    v_mfma_f32_16x16x32_bf16 v[100:103], a[112:115], v[216:219], v[100:103]
    v_mfma_f32_16x16x32_bf16 v[104:107], a[116:119], v[216:219], v[104:107]
    ds_write_b128 v15, v[92:95] offset:4096
    v_mfma_f32_16x16x32_bf16 v[108:111], a[120:123], v[216:219], v[108:111]
    v_mfma_f32_16x16x32_bf16 v[112:115], a[0:3], v[216:219], v[112:115]
    s_waitcnt vmcnt(1)
    v_mfma_f32_16x16x32_bf16 v[96:99], a[4:7], v[220:223], v[96:99]
    v_mfma_f32_16x16x32_bf16 v[100:103], a[8:11], v[220:223], v[100:103]
    v_mfma_f32_16x16x32_bf16 v[104:107], a[12:15], v[220:223], v[104:107]
    v_mfma_f32_16x16x32_bf16 v[108:111], a[16:19], v[220:223], v[108:111]
    v_mfma_f32_16x16x32_bf16 v[112:115], a[20:23], v[220:223], v[112:115]
    s_waitcnt vmcnt(0)
    v_mfma_f32_16x16x32_bf16 v[96:99], a[24:27], v[44:47], v[96:99]
    v_mfma_f32_16x16x32_bf16 v[100:103], a[28:31], v[44:47], v[100:103]
    v_mfma_f32_16x16x32_bf16 v[104:107], a[32:35], v[44:47], v[104:107]
    v_mfma_f32_16x16x32_bf16 v[108:111], a[36:39], v[44:47], v[108:111]
    v_mfma_f32_16x16x32_bf16 v[112:115], a[40:43], v[44:47], v[112:115]
    v_mfma_f32_16x16x32_bf16 v[96:99], a[204:207], v[152:155], v[96:99]
    v_mfma_f32_16x16x32_bf16 v[100:103], a[208:211], v[152:155], v[100:103]
    v_mfma_f32_16x16x32_bf16 v[104:107], a[212:215], v[152:155], v[104:107]
    v_mfma_f32_16x16x32_bf16 v[108:111], a[216:219], v[152:155], v[108:111]
    v_mfma_f32_16x16x32_bf16 v[112:115], a[220:223], v[152:155], v[112:115]
    v_mfma_f32_16x16x32_bf16 v[96:99], a[224:227], v[160:163], v[96:99]
    v_mfma_f32_16x16x32_bf16 v[100:103], a[228:231], v[160:163], v[100:103]
    v_mfma_f32_16x16x32_bf16 v[104:107], a[232:235], v[160:163], v[104:107]
    v_mfma_f32_16x16x32_bf16 v[108:111], a[236:239], v[160:163], v[108:111]
    v_mfma_f32_16x16x32_bf16 v[112:115], a[240:243], v[160:163], v[112:115]
    v_mfma_f32_16x16x32_bf16 v[96:99], a[44:47], v[168:171], v[96:99]
    v_mfma_f32_16x16x32_bf16 v[100:103], a[48:51], v[168:171], v[100:103]
    v_mfma_f32_16x16x32_bf16 v[104:107], a[52:55], v[168:171], v[104:107]
    v_mfma_f32_16x16x32_bf16 v[108:111], a[56:59], v[168:171], v[108:111]
    v_mfma_f32_16x16x32_bf16 v[112:115], a[60:63], v[168:171], v[112:115]
    v_mfma_f32_16x16x32_bf16 v[96:99], a[64:67], v[176:179], v[96:99]
    v_mfma_f32_16x16x32_bf16 v[100:103], a[68:71], v[176:179], v[100:103]
    v_mfma_f32_16x16x32_bf16 v[104:107], a[72:75], v[176:179], v[104:107]
    v_mfma_f32_16x16x32_bf16 v[108:111], a[76:79], v[176:179], v[108:111]
    v_mfma_f32_16x16x32_bf16 v[112:115], a[80:83], v[176:179], v[112:115]
    s_waitcnt lgkmcnt(0)
    s_barrier
    ds_read_b128 v[116:119], v16 offset:0
    ds_read_b128 v[120:123], v16 offset:1024
    ds_read_b128 v[124:127], v16 offset:2048
    ds_read_b128 v[128:131], v16 offset:3072
    ds_read_b128 v[132:135], v16 offset:4096
    ds_read_b128 v[136:139], v16 offset:5120
    ds_read_b128 v[140:143], v16 offset:6144
    ds_read_b128 v[144:147], v16 offset:7168
    ds_read_b128 v[148:151], v16 offset:8192
    ds_read_b128 v[152:155], v16 offset:9216
    ds_read_b128 v[76:79], v16 offset:10240
    ds_read_b128 v[80:83], v16 offset:11264
    ds_read_b128 v[84:87], v16 offset:12288
    ds_read_b128 v[88:91], v16 offset:13312
    ds_read_b128 v[92:95], v16 offset:14336
    s_waitcnt lgkmcnt(10)
    v_pk_add_f32 v[96:97], v[96:97], v[116:117]
    v_pk_add_f32 v[98:99], v[98:99], v[118:119]
    v_pk_add_f32 v[100:101], v[100:101], v[120:121]
    v_pk_add_f32 v[102:103], v[102:103], v[122:123]
    v_pk_add_f32 v[104:105], v[104:105], v[124:125]
    v_pk_add_f32 v[106:107], v[106:107], v[126:127]
    v_pk_add_f32 v[108:109], v[108:109], v[128:129]
    v_pk_add_f32 v[110:111], v[110:111], v[130:131]
    v_pk_add_f32 v[112:113], v[112:113], v[132:133]
    v_pk_add_f32 v[114:115], v[114:115], v[134:135]
    s_waitcnt lgkmcnt(5)
    v_pk_add_f32 v[96:97], v[96:97], v[136:137]
    v_pk_add_f32 v[98:99], v[98:99], v[138:139]
    v_pk_add_f32 v[100:101], v[100:101], v[140:141]
    v_pk_add_f32 v[102:103], v[102:103], v[142:143]
    v_pk_add_f32 v[104:105], v[104:105], v[144:145]
    v_pk_add_f32 v[106:107], v[106:107], v[146:147]
    v_pk_add_f32 v[108:109], v[108:109], v[148:149]
    v_pk_add_f32 v[110:111], v[110:111], v[150:151]
    v_pk_add_f32 v[112:113], v[112:113], v[152:153]
    v_pk_add_f32 v[114:115], v[114:115], v[154:155]
    s_waitcnt lgkmcnt(0)
    v_pk_add_f32 v[96:97], v[96:97], v[76:77]
    v_pk_add_f32 v[98:99], v[98:99], v[78:79]
    v_pk_add_f32 v[100:101], v[100:101], v[80:81]
    v_pk_add_f32 v[102:103], v[102:103], v[82:83]
    v_pk_add_f32 v[104:105], v[104:105], v[84:85]
    v_pk_add_f32 v[106:107], v[106:107], v[86:87]
    v_pk_add_f32 v[108:109], v[108:109], v[88:89]
    v_pk_add_f32 v[110:111], v[110:111], v[90:91]
    v_pk_add_f32 v[112:113], v[112:113], v[92:93]
    v_pk_add_f32 v[114:115], v[114:115], v[94:95]
    v_pk_fma_f32 v[96:97], v[96:97], v[54:55], v[24:25]
    v_pk_fma_f32 v[98:99], v[98:99], v[56:57], v[26:27]
    v_pk_fma_f32 v[100:101], v[100:101], v[58:59], v[28:29]
    v_pk_fma_f32 v[102:103], v[102:103], v[60:61], v[30:31]
    v_pk_fma_f32 v[104:105], v[104:105], v[62:63], v[32:33]
    v_pk_fma_f32 v[106:107], v[106:107], v[64:65], v[34:35]
    v_pk_fma_f32 v[108:109], v[108:109], v[66:67], v[36:37]
    v_pk_fma_f32 v[110:111], v[110:111], v[68:69], v[38:39]
    v_pk_fma_f32 v[112:113], v[112:113], v[70:71], v[40:41]
    v_pk_fma_f32 v[114:115], v[114:115], v[72:73], v[42:43]
    v_cvt_pk_bf16_f32 v76, v96, v97
    v_cvt_pk_bf16_f32 v77, v98, v99
    v_cvt_pk_bf16_f32 v78, v100, v101
    v_cvt_pk_bf16_f32 v79, v102, v103
    v_cvt_pk_bf16_f32 v80, v104, v105
    v_cvt_pk_bf16_f32 v81, v106, v107
    v_cvt_pk_bf16_f32 v82, v108, v109
    v_cvt_pk_bf16_f32 v83, v110, v111
    v_cvt_pk_bf16_f32 v84, v112, v113
    v_cvt_pk_bf16_f32 v85, v114, v115
    s_bitcmp1_b32 s36, 0
    s_cbranch_scc1 L_DF16
    buffer_store_dwordx2 v[76:77], v17, s[44:47], s29 offen offset:0 sc1
    buffer_store_dwordx2 v[78:79], v17, s[44:47], s29 offen offset:32 sc1
    buffer_store_dwordx2 v[80:81], v17, s[44:47], s29 offen offset:64 sc1
    buffer_store_dwordx2 v[82:83], v17, s[44:47], s29 offen offset:96 sc1
    buffer_store_dwordx2 v[84:85], v17, s[44:47], s29 offen offset:128 sc1
    s_branch L_DE16
L_DF16:
    buffer_store_dwordx2 v[76:77], v17, s[44:47], s29 offen offset:0
    buffer_store_dwordx2 v[78:79], v17, s[44:47], s29 offen offset:32
    buffer_store_dwordx2 v[80:81], v17, s[44:47], s29 offen offset:64
    buffer_store_dwordx2 v[82:83], v17, s[44:47], s29 offen offset:96
    buffer_store_dwordx2 v[84:85], v17, s[44:47], s29 offen offset:128
L_DE16:
L_END:
    s_endpgm
CODE_END:
.section .rodata,"a"
.p2align 6
.amdhsa_kernel adaLN_cond__ssm_conv_s4d__mixer_s_mlp__prompt_kernel
  .amdhsa_next_free_vgpr 512
  .amdhsa_next_free_sgpr 62
  .amdhsa_accum_offset 256
  .amdhsa_group_segment_fixed_size 0
  .amdhsa_kernarg_size 136
  .amdhsa_user_sgpr_count 2
  .amdhsa_user_sgpr_kernarg_segment_ptr 1
  .amdhsa_system_sgpr_workgroup_id_x 1
.end_amdhsa_kernel
```
